```python
import torch

def _softmax(x, axis=-1):
    return torch.softmax(x, dim=axis)
def _gelu(x):
    return torch.nn.functional.gelu(x, approximate="tanh")
def _silu(x):
    return torch.nn.functional.silu(x)
def _sigmoid(x):
    return torch.sigmoid(x)
def _layernorm(x, axis=-1, eps=1e-5):
    m = x.mean(dim=axis, keepdim=True)
    v = x.var(dim=axis, keepdim=True, unbiased=False)
    return (x - m) / torch.sqrt(v + eps)
def _scatter_add(tgt, idx, src, axis=0):
    return tgt.clone().index_add_(axis, idx, src)
def _segment_sum(src, seg, n):
    out = torch.zeros((n,) + src.shape[1:], dtype=src.dtype)
    return out.index_add_(0, seg, src)
def _pad(x, pw):
    flat = tuple(v for pair in reversed(pw) for v in pair)
    return torch.nn.functional.pad(x, flat)

kernel_name = 'parallel_sum__mha_block__glu_gated_geglu__prompt'

def setup_inputs():

    _w = (lambda a: (lambda t: t.to(torch.bfloat16) if t.is_floating_point() else t)(torch.as_tensor(a)))
    def _A_setup():
        B, S, D, H = 1, 2048, 512, 32
        return {
            "x": _w((lambda *s: torch.randn(*s, dtype=torch.bfloat16) * 0.05)(B, S, D)),
            "wqkv": _w((lambda *s: torch.randn(*s, dtype=torch.bfloat16) * 0.05)(D, 3 * D)),
            "wo": _w((lambda *s: torch.randn(*s, dtype=torch.bfloat16) * 0.05)(D, D)),
        }
    _A_in = _A_setup()

    def _B_setup():
        B, S, Dm, Df = 1, 2048, 512, 1792
        return {
            "x": _w((lambda *s: torch.randn(*s, dtype=torch.bfloat16) * 0.05)(B, S, Dm)),
            "w_gate": _w((lambda *s: torch.randn(*s, dtype=torch.bfloat16) * 0.4)(Dm, Df) * (Dm ** -0.5)),
            "w_up": _w((lambda *s: torch.randn(*s, dtype=torch.bfloat16) * 0.4)(Dm, Df) * (Dm ** -0.5)),
            "w_down": _w((lambda *s: torch.randn(*s, dtype=torch.bfloat16) * 0.4)(Df, Dm) * (Df ** -0.5)),
        }
    _B_in = _B_setup()

    return {
        "A_x": _A_in["x"],
        "A_wqkv": _A_in["wqkv"],
        "A_wo": _A_in["wo"],
        "B_x": _B_in["x"],
        "B_w_gate": _B_in["w_gate"],
        "B_w_up": _B_in["w_up"],
        "B_w_down": _B_in["w_down"],
    }

def reference(A_x, A_wqkv, A_wo, B_x, B_w_gate, B_w_up, B_w_down):
    def _A_ref(x, wqkv, wo):
        B, S, D = x.shape
        H = 32
        Dh = D // H
        qkv = (lambda x, *d: x.permute(*d))((x @ wqkv).reshape(B, S, 3, H, Dh), 2, 0, 3, 1, 4)
        q, k, v = qkv[0], qkv[1], qkv[2]
        scores = torch.einsum("bhqd,bhkd->bhqk", q, k) * (Dh ** -0.5)
        p = _softmax(scores, axis=-1)
        o = torch.einsum("bhqk,bhkd->bhqd", p, v)
        return (lambda x, *d: x.permute(*d))(o, 0, 2, 1, 3).reshape(B, S, D) @ wo

    def _B_ref(x, w_gate, w_up, w_down):
        g = torch.einsum("bsd,df->bsf", x, w_gate)
        u = torch.einsum("bsd,df->bsf", x, w_up)
        h = _gelu(g) * u
        return torch.einsum("bsf,fd->bsd", h, w_down)

    x = A_x
    xn = _layernorm(x, axis=-1)
    return x + _A_ref(xn, A_wqkv, A_wo) + _B_ref(xn, B_w_gate, B_w_up, B_w_down)
```

```asm
; @launch grid=(256,1,1) block=(512,1,1) lds=163840
.amdgcn_target "amdgcn-amd-amdhsa--gfx950"
.text
.globl parallel_sum__mha_block__glu_gated_geglu__prompt_kernel
.p2align 8
.type parallel_sum__mha_block__glu_gated_geglu__prompt_kernel,@function
parallel_sum__mha_block__glu_gated_geglu__prompt_kernel:
    s_cmp_ge_u32 s2, 256
    s_cbranch_scc1 parallel_sum__mha_block__glu_gated_geglu__prompt_kernel_end
    s_load_dwordx4 s[4:7], s[0:1], 0
    s_getpc_b64 s[96:97]
parallel_sum__mha_block__glu_gated_geglu__prompt_kernel_pc:
    v_lshrrev_b32 v1, 5, v0
    s_lshl_b32 s57, s2, 8
    v_lshlrev_b32 v1, 7, v1
    s_and_b32 s57, s57, 0xf800
    s_and_b32 s97, s97, 0xffff
    s_mov_b32 s98, parallel_sum__mha_block__glu_gated_geglu__prompt_kernel_codeend-parallel_sum__mha_block__glu_gated_geglu__prompt_kernel_pc
    s_mov_b32 s99, 0x00020000
    buffer_load_dword v255, v1, s[96:99], s57 offen
    s_load_dwordx8 s[16:23], s[0:1], 48
    s_load_dwordx4 s[12:15], s[0:1], 32
    s_load_dwordx2 s[8:9], s[0:1], 16
    v_lshrrev_b32 v1, 6, v0
    s_and_b32 s56, s2, 7
    v_readfirstlane_b32 s58, v1
    s_lshr_b32 s63, s2, 3
    s_lshr_b32 s62, s56, 1
    s_and_b32 s53, s56, 1
    s_lshl_b32 s53, s53, 3
    s_and_b32 s57, s63, 7
    s_add_u32 s53, s53, s57
    s_lshl_b32 s54, s62, 2
    s_lshr_b32 s57, s63, 3
    s_add_u32 s54, s54, s57
    s_add_u32 s48, s57, s63
    s_and_b32 s48, s48, 1
    s_and_b32 s52, s58, 3
    s_cmp_lt_u32 s58, 4
    s_cbranch_scc1 parallel_sum__mha_block__glu_gated_geglu__prompt_kernel_g0
    s_branch parallel_sum__mha_block__glu_gated_geglu__prompt_kernel_a
parallel_sum__mha_block__glu_gated_geglu__prompt_kernel_g0:
    s_branch parallel_sum__mha_block__glu_gated_geglu__prompt_kernel_g
parallel_sum__mha_block__glu_gated_geglu__prompt_kernel_a:
    v_and_b32 v3, 63, v0
    s_lshl_b32 s55, s53, 2
    s_add_u32 s55, s55, s52
    v_lshrrev_b32 v42, 4, v3
    v_and_b32 v43, 15, v3
    v_add_u32 v44, 0, v42
    v_xor_b32 v45, v43, v44
    v_lshlrev_b32 v45, 4, v45
    v_lshl_add_u32 v32, v44, 10, v45
    v_add_u32 v44, 4, v42
    v_xor_b32 v45, v43, v44
    v_lshlrev_b32 v45, 4, v45
    v_lshl_add_u32 v33, v44, 10, v45
    v_subrev_u32 v33, 1024, v33
    v_add_u32 v44, 8, v42
    v_xor_b32 v45, v43, v44
    v_lshlrev_b32 v45, 4, v45
    v_lshl_add_u32 v34, v44, 10, v45
    v_subrev_u32 v34, 2048, v34
    v_add_u32 v44, 12, v42
    v_xor_b32 v45, v43, v44
    v_lshlrev_b32 v45, 4, v45
    v_lshl_add_u32 v35, v44, 10, v45
    v_subrev_u32 v35, 3072, v35
    s_waitcnt lgkmcnt(0)
    s_mov_b32 s24, s4
    s_and_b32 s25, s5, 0xffff
    s_mov_b32 s26, 0x00200000
    s_mov_b32 s27, 0x00020000
    s_lshl_b32 s4, s55, 15
    s_lshl_b32 s5, s52, 13
    s_xor_b32 s57, s48, 0
    s_lshl_b32 s57, s57, 8
    s_add_u32 s57, s57, s4
    s_add_u32 m0, s5, 0
    s_add_u32 s56, s57, 0
    buffer_load_dwordx4 v32, s[24:27], s56 offen offset:0 lds
    buffer_load_dwordx4 v33, s[24:27], s56 offen offset:1024 lds
    buffer_load_dwordx4 v34, s[24:27], s56 offen offset:2048 lds
    buffer_load_dwordx4 v35, s[24:27], s56 offen offset:3072 lds
    s_add_u32 m0, s5, 4096
    s_add_u32 s56, s57, 16384
    buffer_load_dwordx4 v32, s[24:27], s56 offen offset:0 lds
    buffer_load_dwordx4 v33, s[24:27], s56 offen offset:1024 lds
    buffer_load_dwordx4 v34, s[24:27], s56 offen offset:2048 lds
    buffer_load_dwordx4 v35, s[24:27], s56 offen offset:3072 lds
    s_mov_b32 s32, s6
    s_and_b32 s33, s7, 0xffff
    s_mov_b32 s34, 0x00180000
    s_mov_b32 s35, 0x00020000
    s_lshr_b32 s57, s54, 1
    s_lshl_b32 s57, s57, 7
    s_and_b32 s58, s54, 1
    s_lshl_b32 s68, s58, 10
    s_add_u32 s68, s68, s57
    s_mul_i32 s56, s52, 98304
    s_add_u32 s68, s68, s56
    s_lshl_b32 s69, s58, 6
    s_add_u32 s69, s69, s57
    s_mul_i32 s56, s52, 49152
    s_add_u32 s69, s69, s56
    s_add_u32 s69, s69, 2048
    v_bfe_u32 v48, v0, 2, 3
    v_bfe_u32 v49, v0, 5, 1
    v_mul_u32_u24 v237, 3072, v48
    v_lshl_add_u32 v237, v49, 6, v237
    v_and_b32 v48, 3, v0
    v_lshl_add_u32 v237, v48, 4, v237
    v_bfe_u32 v48, v0, 2, 3
    v_bfe_u32 v49, v0, 5, 1
    v_lshl_add_u32 v48, v49, 6, v48
    v_mul_u32_u24 v240, 3072, v48
    v_and_b32 v48, 3, v0
    v_lshl_add_u32 v240, v48, 4, v240
    s_xor_b32 s57, s48, 0
    s_mul_i32 s57, s57, 393216
    s_add_u32 s58, s57, s68
    s_lshl_b32 s56, s52, 12
    s_add_u32 m0, s56, 98304
    s_add_u32 s56, s58, 0
    buffer_load_dwordx4 v237, s[32:35], s56 offen offset:0 lds
    s_add_u32 s56, s58, 23552
    buffer_load_dwordx4 v237, s[32:35], s56 offen offset:1024 lds
    s_add_u32 s56, s58, 47104
    buffer_load_dwordx4 v237, s[32:35], s56 offen offset:2048 lds
    s_add_u32 s56, s58, 70656
    buffer_load_dwordx4 v237, s[32:35], s56 offen offset:3072 lds
    s_add_u32 s58, s57, s69
    s_lshl_b32 s56, s52, 11
    s_add_u32 m0, s56, 114688
    s_add_u32 s56, s58, 0
    buffer_load_dwordx4 v240, s[32:35], s56 offen offset:0 lds
    s_add_u32 s56, s58, 23552
    buffer_load_dwordx4 v240, s[32:35], s56 offen offset:1024 lds
    s_mov_b32 s44, s20
    s_and_b32 s45, s21, 0xffff
    s_mov_b32 s46, 0x00000100
    s_mov_b32 s47, 0x00020000
    s_or_b32 s56, s2, s52
    s_cmp_lg_u32 s56, 3
    s_cbranch_scc1 parallel_sum__mha_block__glu_gated_geglu__prompt_kernel_nonon
    s_cmp_lg_u32 s2, 0
    s_cbranch_scc1 parallel_sum__mha_block__glu_gated_geglu__prompt_kernel_nonon
    s_memrealtime s[100:101]
    s_waitcnt lgkmcnt(0)
    s_or_b32 s56, s100, 1
    v_mov_b32 v50, s56
    v_mov_b32 v51, 0
    buffer_store_dword v50, v51, s[44:47], 0 offen sc1
parallel_sum__mha_block__glu_gated_geglu__prompt_kernel_nonon:
    s_waitcnt vmcnt(6)
    s_barrier
    s_xor_b32 s57, s48, 1
    s_lshl_b32 s57, s57, 8
    s_add_u32 s57, s57, s4
    s_add_u32 m0, s5, 32768
    s_add_u32 s56, s57, 0
    buffer_load_dwordx4 v32, s[24:27], s56 offen offset:0 lds
    buffer_load_dwordx4 v33, s[24:27], s56 offen offset:1024 lds
    buffer_load_dwordx4 v34, s[24:27], s56 offen offset:2048 lds
    buffer_load_dwordx4 v35, s[24:27], s56 offen offset:3072 lds
    s_add_u32 m0, s5, 36864
    s_add_u32 s56, s57, 16384
    buffer_load_dwordx4 v32, s[24:27], s56 offen offset:0 lds
    buffer_load_dwordx4 v33, s[24:27], s56 offen offset:1024 lds
    buffer_load_dwordx4 v34, s[24:27], s56 offen offset:2048 lds
    buffer_load_dwordx4 v35, s[24:27], s56 offen offset:3072 lds
    s_waitcnt vmcnt(8)
    s_barrier
    s_lshl_b32 s56, s52, 2
    s_add_u32 s56, s56, 161520
    v_mov_b32 v53, s56
    s_xor_b32 s57, s48, 1
    s_mul_i32 s57, s57, 393216
    s_add_u32 s58, s57, s68
    s_lshl_b32 s56, s52, 12
    s_add_u32 m0, s56, 122880
    s_add_u32 s56, s58, 0
    buffer_load_dwordx4 v237, s[32:35], s56 offen offset:0 lds
    s_add_u32 s56, s58, 23552
    buffer_load_dwordx4 v237, s[32:35], s56 offen offset:1024 lds
    s_add_u32 s56, s58, 47104
    buffer_load_dwordx4 v237, s[32:35], s56 offen offset:2048 lds
    s_add_u32 s56, s58, 70656
    buffer_load_dwordx4 v237, s[32:35], s56 offen offset:3072 lds
    s_add_u32 s58, s57, s69
    s_lshl_b32 s56, s52, 11
    s_add_u32 m0, s56, 139264
    s_add_u32 s56, s58, 0
    buffer_load_dwordx4 v240, s[32:35], s56 offen offset:0 lds
    s_add_u32 s56, s58, 23552
    buffer_load_dwordx4 v240, s[32:35], s56 offen offset:1024 lds
    s_xor_b32 s57, s48, 2
    s_lshl_b32 s57, s57, 8
    s_add_u32 s57, s57, s4
    s_add_u32 m0, s5, 65536
    s_add_u32 s56, s57, 0
    buffer_load_dwordx4 v32, s[24:27], s56 offen offset:0 lds
    buffer_load_dwordx4 v33, s[24:27], s56 offen offset:1024 lds
    buffer_load_dwordx4 v34, s[24:27], s56 offen offset:2048 lds
    buffer_load_dwordx4 v35, s[24:27], s56 offen offset:3072 lds
    s_add_u32 m0, s5, 69632
    s_add_u32 s56, s57, 16384
    buffer_load_dwordx4 v32, s[24:27], s56 offen offset:0 lds
    buffer_load_dwordx4 v33, s[24:27], s56 offen offset:1024 lds
    buffer_load_dwordx4 v34, s[24:27], s56 offen offset:2048 lds
    buffer_load_dwordx4 v35, s[24:27], s56 offen offset:3072 lds
    s_waitcnt vmcnt(8)
    s_barrier
    s_mov_b32 s36, s22
    s_and_b32 s37, s23, 0xffff
    s_mov_b32 s38, 0x01000000
    s_mov_b32 s39, 0x00020000
    s_cmp_ge_u32 s52, 2
    s_cselect_b32 s28, s14, s12
    s_cselect_b32 s29, s15, s13
    s_cselect_b32 s65, 1, 0
    s_and_b32 s29, s29, 0xffff
    s_mov_b32 s30, 1835008
    s_mov_b32 s31, 0x00020000
    s_and_b32 s66, s52, 1
    s_mul_i32 s56, s54, 224
    s_and_b32 s57, s54, 3
    s_lshl_b32 s57, s57, 5
    s_add_u32 s64, s56, s57
    s_bitcmp1_b32 s54, 0
    s_cselect_b32 s49, 0, 192
    s_cselect_b32 s50, 32, 0
    s_add_u32 s49, s49, s56
    s_add_u32 s50, s50, s56
    s_bitcmp1_b32 s54, 1
    s_cselect_b32 s57, 0, 128
    s_add_u32 s50, s50, s57
    s_mul_i32 s14, s65, 8224
    s_lshl_b32 s57, s66, 12
    s_add_u32 s14, s14, s57
    s_mul_i32 s15, s66, 114688
    s_xor_b32 s57, s48, 0
    s_mul_i32 s57, s57, 458752
    s_add_u32 s96, s57, s15
    s_xor_b32 s57, s48, 1
    s_mul_i32 s57, s57, 458752
    s_add_u32 s97, s57, s15
    s_xor_b32 s57, s48, 2
    s_mul_i32 s57, s57, 458752
    s_add_u32 s98, s57, s15
    s_xor_b32 s57, s48, 3
    s_mul_i32 s57, s57, 458752
    s_add_u32 s99, s57, s15
    s_lshl_b32 s67, s62, 3
    s_and_b32 s56, s2, 1
    s_lshl_b32 s56, s56, 2
    s_add_u32 s67, s67, s56
    s_and_b32 s56, s63, 3
    s_add_u32 s67, s67, s56
    v_bfe_u32 v48, v0, 2, 3
    v_bfe_u32 v49, v0, 5, 1
    v_mul_u32_u24 v236, 3584, v48
    v_lshl_add_u32 v236, v49, 6, v236
    v_and_b32 v48, 3, v0
    v_lshl_add_u32 v236, v48, 4, v236
    v_lshrrev_b32 v48, 3, v3
    v_mul_u32_u24 v48, 3584, v48
    v_and_b32 v49, 7, v3
    v_min_u32 v49, 6, v49
    v_lshl_add_u32 v48, v49, 7, v48
    s_lshl_b32 s10, s63, 1
    s_add_u32 s10, s10, s66
    s_mul_i32 s10, s10, 28672
    s_mul_i32 s57, s62, 896
    s_add_u32 s10, s10, s57
    s_xor_b32 s57, s48, 2
    s_mul_i32 s57, s57, 393216
    s_add_u32 s58, s57, s68
    s_lshl_b32 s56, s52, 12
    s_add_u32 m0, s56, 0
    s_add_u32 s56, s58, 0
    buffer_load_dwordx4 v237, s[32:35], s56 offen offset:0 lds
    s_add_u32 s56, s58, 23552
    buffer_load_dwordx4 v237, s[32:35], s56 offen offset:1024 lds
    s_add_u32 s56, s58, 47104
    buffer_load_dwordx4 v237, s[32:35], s56 offen offset:2048 lds
    s_add_u32 s56, s58, 70656
    buffer_load_dwordx4 v237, s[32:35], s56 offen offset:3072 lds
    s_add_u32 s58, s57, s69
    s_lshl_b32 s56, s52, 11
    s_add_u32 m0, s56, 16384
    s_add_u32 s56, s58, 0
    buffer_load_dwordx4 v240, s[32:35], s56 offen offset:0 lds
    s_add_u32 s56, s58, 23552
    buffer_load_dwordx4 v240, s[32:35], s56 offen offset:1024 lds
    s_barrier
    s_xor_b32 s57, s48, 3
    s_lshl_b32 s57, s57, 8
    s_add_u32 s57, s57, s4
    s_add_u32 m0, s5, 32768
    s_add_u32 s56, s57, 0
    buffer_load_dwordx4 v32, s[24:27], s56 offen offset:0 lds
    buffer_load_dwordx4 v33, s[24:27], s56 offen offset:1024 lds
    buffer_load_dwordx4 v34, s[24:27], s56 offen offset:2048 lds
    buffer_load_dwordx4 v35, s[24:27], s56 offen offset:3072 lds
    s_add_u32 m0, s5, 36864
    s_add_u32 s56, s57, 16384
    buffer_load_dwordx4 v32, s[24:27], s56 offen offset:0 lds
    buffer_load_dwordx4 v33, s[24:27], s56 offen offset:1024 lds
    buffer_load_dwordx4 v34, s[24:27], s56 offen offset:2048 lds
    buffer_load_dwordx4 v35, s[24:27], s56 offen offset:3072 lds
    s_waitcnt vmcnt(8)
    s_barrier
    s_xor_b32 s57, s48, 3
    s_mul_i32 s57, s57, 393216
    s_add_u32 s58, s57, s68
    s_lshl_b32 s56, s52, 12
    s_add_u32 m0, s56, 98304
    s_add_u32 s56, s58, 0
    buffer_load_dwordx4 v237, s[32:35], s56 offen offset:0 lds
    s_add_u32 s56, s58, 23552
    buffer_load_dwordx4 v237, s[32:35], s56 offen offset:1024 lds
    s_add_u32 s56, s58, 47104
    buffer_load_dwordx4 v237, s[32:35], s56 offen offset:2048 lds
    s_add_u32 s56, s58, 70656
    buffer_load_dwordx4 v237, s[32:35], s56 offen offset:3072 lds
    s_add_u32 s58, s57, s69
    s_lshl_b32 s56, s52, 11
    s_add_u32 m0, s56, 114688
    s_add_u32 s56, s58, 0
    buffer_load_dwordx4 v240, s[32:35], s56 offen offset:0 lds
    s_add_u32 s56, s58, 23552
    buffer_load_dwordx4 v240, s[32:35], s56 offen offset:1024 lds
    v_mov_b32 v51, 0
    buffer_load_dword v50, v51, s[44:47], 0 offen sc1
    buffer_load_dword v46, v48, s[28:31], s10 offen
    v_and_b32 v52, 27, v3
    v_cmp_eq_u32 vcc, 16, v52
    v_mov_b32 v52, 0x3f803f80
    s_nop 0
    v_cndmask_b32 v52, 0, v52, vcc
    v_mov_b32 v164, v52
    v_mov_b32 v165, v52
    v_mov_b32 v166, v52
    v_mov_b32 v167, v52
    v_mov_b32 v168, v52
    v_mov_b32 v169, v52
    v_mov_b32 v170, v52
    v_mov_b32 v171, v52
    v_mov_b32 v172, v52
    v_mov_b32 v173, v52
    v_mov_b32 v174, v52
    v_mov_b32 v175, v52
    v_mov_b32 v176, v52
    v_mov_b32 v177, v52
    v_mov_b32 v178, v52
    v_mov_b32 v179, v52
    v_mov_b32 v180, v52
    v_mov_b32 v181, v52
    v_mov_b32 v182, v52
    v_mov_b32 v183, v52
    v_mov_b32 v184, v52
    v_mov_b32 v185, v52
    v_mov_b32 v186, v52
    v_mov_b32 v187, v52
    v_mov_b32 v188, v52
    v_mov_b32 v189, v52
    v_mov_b32 v190, v52
    v_mov_b32 v191, v52
    v_mov_b32 v192, v52
    v_mov_b32 v193, v52
    v_mov_b32 v194, v52
    v_mov_b32 v195, v52
    v_mov_b32 v196, v52
    v_mov_b32 v197, v52
    v_mov_b32 v198, v52
    v_mov_b32 v199, v52
    v_mov_b32 v200, v52
    v_mov_b32 v201, v52
    v_mov_b32 v202, v52
    v_mov_b32 v203, v52
    v_mov_b32 v204, v52
    v_mov_b32 v205, v52
    v_mov_b32 v206, v52
    v_mov_b32 v207, v52
    v_mov_b32 v208, v52
    v_mov_b32 v209, v52
    v_mov_b32 v210, v52
    v_mov_b32 v211, v52
    v_mov_b32 v212, v52
    v_mov_b32 v213, v52
    v_mov_b32 v214, v52
    v_mov_b32 v215, v52
    v_mov_b32 v216, v52
    v_mov_b32 v217, v52
    v_mov_b32 v218, v52
    v_mov_b32 v219, v52
    v_mov_b32 v220, v52
    v_mov_b32 v221, v52
    v_mov_b32 v222, v52
    v_mov_b32 v223, v52
    v_mov_b32 v224, v52
    v_mov_b32 v225, v52
    v_mov_b32 v226, v52
    v_mov_b32 v227, v52
    v_mov_b32 v68, 0
    v_mov_b32 v69, 0
    v_mov_b32 v70, 0
    v_mov_b32 v71, 0
    v_mov_b32 v72, 0
    v_mov_b32 v73, 0
    v_mov_b32 v74, 0
    v_mov_b32 v75, 0
    v_mov_b32 v76, 0
    v_mov_b32 v77, 0
    v_mov_b32 v78, 0
    v_mov_b32 v79, 0
    v_mov_b32 v80, 0
    v_mov_b32 v81, 0
    v_mov_b32 v82, 0
    v_mov_b32 v83, 0
    v_mov_b32 v84, 0
    v_mov_b32 v85, 0
    v_mov_b32 v86, 0
    v_mov_b32 v87, 0
    v_mov_b32 v88, 0
    v_mov_b32 v89, 0
    v_mov_b32 v90, 0
    v_mov_b32 v91, 0
    v_mov_b32 v92, 0
    v_mov_b32 v93, 0
    v_mov_b32 v94, 0
    v_mov_b32 v95, 0
    v_mov_b32 v96, 0
    v_mov_b32 v97, 0
    v_mov_b32 v98, 0
    v_mov_b32 v99, 0
    v_mov_b32 v100, 0
    v_mov_b32 v101, 0
    v_mov_b32 v102, 0
    v_mov_b32 v103, 0
    v_mov_b32 v104, 0
    v_mov_b32 v105, 0
    v_mov_b32 v106, 0
    v_mov_b32 v107, 0
    v_mov_b32 v108, 0
    v_mov_b32 v109, 0
    v_mov_b32 v110, 0
    v_mov_b32 v111, 0
    v_mov_b32 v112, 0
    v_mov_b32 v113, 0
    v_mov_b32 v114, 0
    v_mov_b32 v115, 0
    v_mov_b32 v116, 0
    v_mov_b32 v117, 0
    v_mov_b32 v118, 0
    v_mov_b32 v119, 0
    v_mov_b32 v120, 0
    v_mov_b32 v121, 0
    v_mov_b32 v122, 0
    v_mov_b32 v123, 0
    v_mov_b32 v124, 0
    v_mov_b32 v125, 0
    v_mov_b32 v126, 0
    v_mov_b32 v127, 0
    v_mov_b32 v128, 0
    v_mov_b32 v129, 0
    v_mov_b32 v130, 0
    v_mov_b32 v131, 0
    s_waitcnt vmcnt(2)
    s_barrier
    s_waitcnt vmcnt(1)
    v_readfirstlane_b32 s61, v50
    s_mov_b32 s59, 200000
parallel_sum__mha_block__glu_gated_geglu__prompt_kernel_nl:
    s_nop 0
    s_cmp_lg_u32 s61, 0
    s_cbranch_scc1 parallel_sum__mha_block__glu_gated_geglu__prompt_kernel_nx
    s_sub_u32 s59, s59, 1
    s_cmp_eq_u32 s59, 0
    s_cbranch_scc1 parallel_sum__mha_block__glu_gated_geglu__prompt_kernel_nx
    buffer_load_dword v50, v51, s[44:47], 0 offen sc1
    s_waitcnt vmcnt(0)
    v_readfirstlane_b32 s61, v50
    s_branch parallel_sum__mha_block__glu_gated_geglu__prompt_kernel_nl
parallel_sum__mha_block__glu_gated_geglu__prompt_kernel_nx:
    s_nop 0
    v_mov_b32 v50, s61
    v_mov_b32 v51, 161088
    ds_write_b32 v51, v50
    s_add_u32 m0, s14, 65536
    s_add_u32 s69, s96, s64
    s_add_u32 s56, s69, 0
    buffer_load_dwordx4 v236, s[28:31], s56 offen offset:0 lds
    s_add_u32 s56, s69, 27648
    buffer_load_dwordx4 v236, s[28:31], s56 offen offset:1024 lds
    s_add_u32 s56, s69, 55296
    buffer_load_dwordx4 v236, s[28:31], s56 offen offset:2048 lds
    s_add_u32 s56, s69, 82944
    buffer_load_dwordx4 v236, s[28:31], s56 offen offset:3072 lds
    s_add_u32 m0, s14, 122880
    s_add_u32 s69, s96, s64
    s_add_u32 s56, s69, 229376
    buffer_load_dwordx4 v236, s[28:31], s56 offen offset:0 lds
    s_add_u32 s56, s69, 257024
    buffer_load_dwordx4 v236, s[28:31], s56 offen offset:1024 lds
    s_add_u32 s56, s69, 284672
    buffer_load_dwordx4 v236, s[28:31], s56 offen offset:2048 lds
    s_add_u32 s56, s69, 312320
    buffer_load_dwordx4 v236, s[28:31], s56 offen offset:3072 lds
    s_add_u32 m0, s14, 139520
    s_add_u32 s69, s97, s64
    s_add_u32 s56, s69, 0
    buffer_load_dwordx4 v236, s[28:31], s56 offen offset:0 lds
    s_add_u32 s56, s69, 27648
    buffer_load_dwordx4 v236, s[28:31], s56 offen offset:1024 lds
    s_add_u32 s56, s69, 55296
    buffer_load_dwordx4 v236, s[28:31], s56 offen offset:2048 lds
    s_add_u32 s56, s69, 82944
    buffer_load_dwordx4 v236, s[28:31], s56 offen offset:3072 lds
    s_waitcnt vmcnt(0)
    v_mov_b32 v50, 161080
    v_mov_b32 v51, 1
    s_mov_b64 exec, 1
    ds_add_rtn_u32 v51, v50, v51
    s_mov_b64 exec, -1
    v_mov_b32 v50, 161120
    s_mov_b32 s59, 200000
parallel_sum__mha_block__glu_gated_geglu__prompt_kernel_csw:
    ds_read_b128 v[56:59], v50
    s_sub_u32 s59, s59, 1
    s_cmp_eq_u32 s59, 0
    s_waitcnt lgkmcnt(0)
    s_cbranch_scc1 parallel_sum__mha_block__glu_gated_geglu__prompt_kernel_csw_x
    v_min3_u32 v56, v56, v57, v58
    v_min_u32 v56, v56, v59
    s_nop 0
    v_readfirstlane_b32 s58, v56
    s_nop 1
    s_cmp_lg_u32 s58, 0
    s_cbranch_scc1 parallel_sum__mha_block__glu_gated_geglu__prompt_kernel_csw_x
    s_sleep 1
    s_branch parallel_sum__mha_block__glu_gated_geglu__prompt_kernel_csw
parallel_sum__mha_block__glu_gated_geglu__prompt_kernel_csw_x:
    s_cmp_lg_u32 s52, 0
    s_cbranch_scc1 parallel_sum__mha_block__glu_gated_geglu__prompt_kernel_np1
    s_lshl_b32 s58, s54, 4
    s_add_u32 s58, s58, s53
    s_lshl_b32 s58, s58, 8
    s_add_u32 s58, s58, 15728640
    v_mov_b32 v50, s61
    v_mov_b32 v51, 0
    s_mov_b64 exec, 1
    buffer_store_dword v50, v51, s[36:39], s58 offen sc1
    s_mov_b64 exec, -1
parallel_sum__mha_block__glu_gated_geglu__prompt_kernel_np1:
    s_add_u32 m0, s14, 0
    s_add_u32 s69, s97, s64
    s_add_u32 s56, s69, 229376
    buffer_load_dwordx4 v236, s[28:31], s56 offen offset:0 lds
    s_add_u32 s56, s69, 257024
    buffer_load_dwordx4 v236, s[28:31], s56 offen offset:1024 lds
    s_add_u32 s56, s69, 284672
    buffer_load_dwordx4 v236, s[28:31], s56 offen offset:2048 lds
    s_add_u32 s56, s69, 312320
    buffer_load_dwordx4 v236, s[28:31], s56 offen offset:3072 lds
    s_add_u32 m0, s14, 16640
    s_add_u32 s69, s98, s64
    s_add_u32 s56, s69, 0
    buffer_load_dwordx4 v236, s[28:31], s56 offen offset:0 lds
    s_add_u32 s56, s69, 27648
    buffer_load_dwordx4 v236, s[28:31], s56 offen offset:1024 lds
    s_add_u32 s56, s69, 55296
    buffer_load_dwordx4 v236, s[28:31], s56 offen offset:2048 lds
    s_add_u32 s56, s69, 82944
    buffer_load_dwordx4 v236, s[28:31], s56 offen offset:3072 lds
    s_add_u32 m0, s14, 98816
    s_add_u32 s69, s98, s64
    s_add_u32 s56, s69, 229376
    buffer_load_dwordx4 v236, s[28:31], s56 offen offset:0 lds
    s_add_u32 s56, s69, 257024
    buffer_load_dwordx4 v236, s[28:31], s56 offen offset:1024 lds
    s_add_u32 s56, s69, 284672
    buffer_load_dwordx4 v236, s[28:31], s56 offen offset:2048 lds
    s_add_u32 s56, s69, 312320
    buffer_load_dwordx4 v236, s[28:31], s56 offen offset:3072 lds
    s_lshr_b32 s5, s63, 2
    s_and_b32 s9, s52, 1
    s_lshr_b32 s10, s52, 1
    v_lshrrev_b32 v48, 5, v3
    v_and_b32 v2, 15, v0
    v_lshlrev_b32 v2, 4, v2
    v_lshl_add_u32 v2, v48, 8, v2
    v_lshlrev_b32 v1, 4, v3
    s_mov_b32 s60, 0x07060302
    s_mov_b32 s16, 0x0000ffff
    s_mov_b32 s17, 0x0000ffff
    s_mul_i32 s56, s10, 49152
    v_add_u32 v238, s56, v1
    s_add_u32 s56, s56, 24576
    v_add_u32 v239, s56, v2
    v_and_b32 v48, 31, v3
    v_lshlrev_b32 v48, 8, v48
    s_lshr_b32 s57, s67, 2
    s_lshl_b32 s57, s57, 13
    s_add_u32 s57, s57, 15728640
    s_lshl_b32 s56, s67, 16
    s_lshl_b32 s6, s10, 15
    s_add_u32 s6, s56, s6
    s_add_u32 s7, s6, 4194304
    s_add_u32 s6, s6, 2097152
    s_lshl_b32 s11, s5, 3
    s_lshl_b32 s58, s9, 2
    s_add_u32 s11, s11, s58
    s_lshl_b32 s58, s10, 1
    s_add_u32 s11, s11, s58
    s_waitcnt vmcnt(0) lgkmcnt(0)
    v_mov_b32 v50, 161084
    v_mov_b32 v51, 1
    s_mov_b64 exec, 1
    ds_add_rtn_u32 v51, v50, v51
    s_mov_b64 exec, -1
    s_waitcnt lgkmcnt(0)
    s_cmp_lg_u32 s52, 0
    s_cbranch_scc1 parallel_sum__mha_block__glu_gated_geglu__prompt_kernel_e1w
    s_mov_b32 s59, 200000
parallel_sum__mha_block__glu_gated_geglu__prompt_kernel_e1:
    buffer_load_dword v49, v48, s[36:39], s57 offen sc1
    s_sub_u32 s59, s59, 1
    s_cmp_eq_u32 s59, 0
    s_cbranch_scc1 parallel_sum__mha_block__glu_gated_geglu__prompt_kernel_e1_x
    s_waitcnt vmcnt(0)
    v_cmp_ne_u32 vcc, s61, v49
    s_nop 1
    s_cbranch_vccz parallel_sum__mha_block__glu_gated_geglu__prompt_kernel_e1_x
    s_sleep 1
    s_branch parallel_sum__mha_block__glu_gated_geglu__prompt_kernel_e1
parallel_sum__mha_block__glu_gated_geglu__prompt_kernel_e1_x:
    s_waitcnt vmcnt(0)
    v_mov_b32 v50, 161064
    v_mov_b32 v51, 1
    ds_write_b32 v50, v51
    s_branch parallel_sum__mha_block__glu_gated_geglu__prompt_kernel_e1d
parallel_sum__mha_block__glu_gated_geglu__prompt_kernel_e1w:
    v_mov_b32 v50, 161064
    s_mov_b32 s59, 200000
parallel_sum__mha_block__glu_gated_geglu__prompt_kernel_e1b:
    ds_read_b32 v51, v50
    s_sub_u32 s59, s59, 1
    s_cmp_eq_u32 s59, 0
    s_waitcnt lgkmcnt(0)
    s_cbranch_scc1 parallel_sum__mha_block__glu_gated_geglu__prompt_kernel_e1b_x
    v_readfirstlane_b32 s58, v51
    s_nop 1
    s_cmp_ge_u32 s58, 1
    s_cbranch_scc1 parallel_sum__mha_block__glu_gated_geglu__prompt_kernel_e1b_x
    s_sleep 1
    s_branch parallel_sum__mha_block__glu_gated_geglu__prompt_kernel_e1b
parallel_sum__mha_block__glu_gated_geglu__prompt_kernel_e1b_x:
parallel_sum__mha_block__glu_gated_geglu__prompt_kernel_e1d:
    s_lshl_b32 s58, s11, 10
    s_add_u32 s58, s58, s56
    s_xor_b32 s8, s11, 2
    s_lshl_b32 s8, s8, 10
    s_add_u32 s56, s56, s8
    buffer_load_dwordx4 v[4:7], v1, s[36:39], s56 offen sc1
    buffer_load_dwordx4 v[132:135], v1, s[36:39], s6 offen offset:0 sc1
    buffer_load_dwordx4 v[8:11], v1, s[36:39], s56 offen offset:1024 sc1
    s_mov_b64 exec, s[16:17]
    buffer_load_dwordx4 v[164:167], v2, s[36:39], s7 offen offset:0 sc1
    buffer_load_dwordx4 v[168:171], v2, s[36:39], s7 offen offset:512 sc1
    s_mov_b64 exec, -1
    buffer_load_dwordx4 v[12:15], v1, s[36:39], s58 offen sc1
    buffer_load_dwordx4 v[16:19], v1, s[36:39], s58 offen offset:1024 sc1
    buffer_load_dwordx4 v[136:139], v1, s[36:39], s6 offen offset:1024 sc1
    s_mov_b64 exec, s[16:17]
    buffer_load_dwordx4 v[172:175], v2, s[36:39], s7 offen offset:1024 sc1
    buffer_load_dwordx4 v[176:179], v2, s[36:39], s7 offen offset:1536 sc1
    s_mov_b64 exec, -1
    s_waitcnt vmcnt(8)
    s_setprio 2
    v_mfma_f32_32x32x16_bf16 v[36:51], v[132:135], v[4:7], 0
    s_waitcnt vmcnt(7)
    v_mfma_f32_32x32x16_bf16 v[52:67], v[132:135], v[8:11], 0
    s_nop 9
    v_exp_f32 v36, v36
    v_exp_f32 v37, v37
    v_exp_f32 v38, v38
    v_exp_f32 v39, v39
    v_exp_f32 v40, v40
    v_exp_f32 v41, v41
    v_cvt_pk_bf16_f32 v20, v36, v37
    v_exp_f32 v42, v42
    v_cvt_pk_bf16_f32 v21, v38, v39
    v_exp_f32 v43, v43
    buffer_load_dwordx4 v[140:143], v1, s[36:39], s6 offen offset:2048 sc1
    v_cvt_pk_bf16_f32 v22, v40, v41
    v_exp_f32 v44, v44
    v_exp_f32 v45, v45
    s_mov_b64 exec, s[16:17]
    buffer_load_dwordx4 v[180:183], v2, s[36:39], s7 offen offset:2048 sc1
    buffer_load_dwordx4 v[184:187], v2, s[36:39], s7 offen offset:2560 sc1
    s_mov_b64 exec, -1
    v_cvt_pk_bf16_f32 v23, v42, v43
    v_exp_f32 v46, v46
    v_exp_f32 v47, v47
    v_cvt_pk_bf16_f32 v24, v44, v45
    v_exp_f32 v48, v48
    v_exp_f32 v49, v49
    v_cvt_pk_bf16_f32 v25, v46, v47
    v_exp_f32 v50, v50
    v_exp_f32 v51, v51
    v_cvt_pk_bf16_f32 v26, v48, v49
    v_cvt_pk_bf16_f32 v27, v50, v51
    s_waitcnt vmcnt(7)
    v_mfma_f32_32x32x16_bf16 v[36:51], v[132:135], v[12:15], 0
    v_exp_f32 v52, v52
    v_exp_f32 v53, v53
    v_exp_f32 v54, v54
    v_mfma_f32_32x32x16_bf16 v[68:83], v[164:167], v[20:23], v[68:83]
    v_exp_f32 v55, v55
    v_exp_f32 v56, v56
    v_exp_f32 v57, v57
    v_mfma_f32_32x32x16_bf16 v[68:83], v[168:171], v[24:27], v[68:83]
    v_cvt_pk_bf16_f32 v28, v52, v53
    v_exp_f32 v58, v58
    v_cvt_pk_bf16_f32 v29, v54, v55
    v_exp_f32 v59, v59
    v_cvt_pk_bf16_f32 v30, v56, v57
    v_exp_f32 v60, v60
    v_exp_f32 v61, v61
    v_cvt_pk_bf16_f32 v31, v58, v59
    v_exp_f32 v62, v62
    v_exp_f32 v63, v63
    v_cvt_pk_bf16_f32 v32, v60, v61
    v_exp_f32 v64, v64
    v_exp_f32 v65, v65
    v_cvt_pk_bf16_f32 v33, v62, v63
    v_exp_f32 v66, v66
    v_exp_f32 v67, v67
    v_cvt_pk_bf16_f32 v34, v64, v65
    v_cvt_pk_bf16_f32 v35, v66, v67
    s_waitcnt vmcnt(6)
    v_mfma_f32_32x32x16_bf16 v[52:67], v[132:135], v[16:19], 0
    v_exp_f32 v36, v36
    v_exp_f32 v37, v37
    v_exp_f32 v38, v38
    v_mfma_f32_32x32x16_bf16 v[84:99], v[164:167], v[28:31], v[84:99]
    v_exp_f32 v39, v39
    v_exp_f32 v40, v40
    v_exp_f32 v41, v41
    v_mfma_f32_32x32x16_bf16 v[84:99], v[168:171], v[32:35], v[84:99]
    v_cvt_pk_bf16_f32 v20, v36, v37
    v_exp_f32 v42, v42
    v_cvt_pk_bf16_f32 v21, v38, v39
    v_exp_f32 v43, v43
    buffer_load_dwordx4 v[144:147], v1, s[36:39], s6 offen offset:3072 sc1
    v_cvt_pk_bf16_f32 v22, v40, v41
    v_exp_f32 v44, v44
    v_exp_f32 v45, v45
    s_mov_b64 exec, s[16:17]
    buffer_load_dwordx4 v[188:191], v2, s[36:39], s7 offen offset:3072 sc1
    buffer_load_dwordx4 v[192:195], v2, s[36:39], s7 offen offset:3584 sc1
    s_mov_b64 exec, -1
    v_cvt_pk_bf16_f32 v23, v42, v43
    v_exp_f32 v46, v46
    v_exp_f32 v47, v47
    v_cvt_pk_bf16_f32 v24, v44, v45
    v_exp_f32 v48, v48
    v_exp_f32 v49, v49
    v_cvt_pk_bf16_f32 v25, v46, v47
    v_exp_f32 v50, v50
    v_exp_f32 v51, v51
    v_cvt_pk_bf16_f32 v26, v48, v49
    v_cvt_pk_bf16_f32 v27, v50, v51
    s_waitcnt vmcnt(6)
    v_mfma_f32_32x32x16_bf16 v[36:51], v[136:139], v[4:7], 0
    v_exp_f32 v52, v52
    v_exp_f32 v53, v53
    v_exp_f32 v54, v54
    v_mfma_f32_32x32x16_bf16 v[100:115], v[164:167], v[20:23], v[100:115]
    v_exp_f32 v55, v55
    v_exp_f32 v56, v56
    v_exp_f32 v57, v57
    v_mfma_f32_32x32x16_bf16 v[100:115], v[168:171], v[24:27], v[100:115]
    v_cvt_pk_bf16_f32 v28, v52, v53
    v_exp_f32 v58, v58
    v_cvt_pk_bf16_f32 v29, v54, v55
    v_exp_f32 v59, v59
    v_cvt_pk_bf16_f32 v30, v56, v57
    v_exp_f32 v60, v60
    v_exp_f32 v61, v61
    v_cvt_pk_bf16_f32 v31, v58, v59
    v_exp_f32 v62, v62
    v_exp_f32 v63, v63
    v_cvt_pk_bf16_f32 v32, v60, v61
    v_exp_f32 v64, v64
    v_exp_f32 v65, v65
    v_cvt_pk_bf16_f32 v33, v62, v63
    v_exp_f32 v66, v66
    v_exp_f32 v67, v67
    v_cvt_pk_bf16_f32 v34, v64, v65
    v_cvt_pk_bf16_f32 v35, v66, v67
    v_mfma_f32_32x32x16_bf16 v[52:67], v[136:139], v[8:11], 0
    v_exp_f32 v36, v36
    v_exp_f32 v37, v37
    v_exp_f32 v38, v38
    v_mfma_f32_32x32x16_bf16 v[116:131], v[164:167], v[28:31], v[116:131]
    v_exp_f32 v39, v39
    v_exp_f32 v40, v40
    v_exp_f32 v41, v41
    v_mfma_f32_32x32x16_bf16 v[116:131], v[168:171], v[32:35], v[116:131]
    v_cvt_pk_bf16_f32 v20, v36, v37
    v_exp_f32 v42, v42
    v_cvt_pk_bf16_f32 v21, v38, v39
    v_exp_f32 v43, v43
    s_add_u32 s6, s6, 4096
    v_cvt_pk_bf16_f32 v22, v40, v41
    v_exp_f32 v44, v44
    v_exp_f32 v45, v45
    s_add_u32 s7, s7, 4096
    buffer_load_dwordx4 v[148:151], v1, s[36:39], s6 offen offset:0 sc1
    s_mov_b64 exec, s[16:17]
    buffer_load_dwordx4 v[196:199], v2, s[36:39], s7 offen offset:0 sc1
    buffer_load_dwordx4 v[200:203], v2, s[36:39], s7 offen offset:512 sc1
    s_mov_b64 exec, -1
    v_cvt_pk_bf16_f32 v23, v42, v43
    v_exp_f32 v46, v46
    v_exp_f32 v47, v47
    v_cvt_pk_bf16_f32 v24, v44, v45
    v_exp_f32 v48, v48
    v_exp_f32 v49, v49
    v_cvt_pk_bf16_f32 v25, v46, v47
    v_exp_f32 v50, v50
    v_exp_f32 v51, v51
    v_cvt_pk_bf16_f32 v26, v48, v49
    v_cvt_pk_bf16_f32 v27, v50, v51
    v_mfma_f32_32x32x16_bf16 v[36:51], v[136:139], v[12:15], 0
    v_exp_f32 v52, v52
    v_exp_f32 v53, v53
    v_exp_f32 v54, v54
    v_mfma_f32_32x32x16_bf16 v[68:83], v[172:175], v[20:23], v[68:83]
    v_exp_f32 v55, v55
    v_exp_f32 v56, v56
    v_exp_f32 v57, v57
    v_mfma_f32_32x32x16_bf16 v[68:83], v[176:179], v[24:27], v[68:83]
    v_cvt_pk_bf16_f32 v28, v52, v53
    v_exp_f32 v58, v58
    v_cvt_pk_bf16_f32 v29, v54, v55
    v_exp_f32 v59, v59
    v_cvt_pk_bf16_f32 v30, v56, v57
    v_exp_f32 v60, v60
    v_exp_f32 v61, v61
    v_cvt_pk_bf16_f32 v31, v58, v59
    v_exp_f32 v62, v62
    v_exp_f32 v63, v63
    v_cvt_pk_bf16_f32 v32, v60, v61
    v_exp_f32 v64, v64
    v_exp_f32 v65, v65
    v_cvt_pk_bf16_f32 v33, v62, v63
    v_exp_f32 v66, v66
    v_exp_f32 v67, v67
    v_cvt_pk_bf16_f32 v34, v64, v65
    v_cvt_pk_bf16_f32 v35, v66, v67
    v_mfma_f32_32x32x16_bf16 v[52:67], v[136:139], v[16:19], 0
    v_exp_f32 v36, v36
    v_exp_f32 v37, v37
    v_exp_f32 v38, v38
    v_mfma_f32_32x32x16_bf16 v[84:99], v[172:175], v[28:31], v[84:99]
    v_exp_f32 v39, v39
    v_exp_f32 v40, v40
    v_exp_f32 v41, v41
    v_mfma_f32_32x32x16_bf16 v[84:99], v[176:179], v[32:35], v[84:99]
    v_cvt_pk_bf16_f32 v20, v36, v37
    v_exp_f32 v42, v42
    v_cvt_pk_bf16_f32 v21, v38, v39
    v_exp_f32 v43, v43
    buffer_load_dwordx4 v[152:155], v1, s[36:39], s6 offen offset:1024 sc1
    v_cvt_pk_bf16_f32 v22, v40, v41
    v_exp_f32 v44, v44
    v_exp_f32 v45, v45
    s_mov_b64 exec, s[16:17]
    buffer_load_dwordx4 v[204:207], v2, s[36:39], s7 offen offset:1024 sc1
    buffer_load_dwordx4 v[208:211], v2, s[36:39], s7 offen offset:1536 sc1
    s_mov_b64 exec, -1
    v_cvt_pk_bf16_f32 v23, v42, v43
    v_exp_f32 v46, v46
    v_exp_f32 v47, v47
    v_cvt_pk_bf16_f32 v24, v44, v45
    v_exp_f32 v48, v48
    v_exp_f32 v49, v49
    v_cvt_pk_bf16_f32 v25, v46, v47
    v_exp_f32 v50, v50
    v_exp_f32 v51, v51
    v_cvt_pk_bf16_f32 v26, v48, v49
    v_cvt_pk_bf16_f32 v27, v50, v51
    s_waitcnt vmcnt(9)
    v_mfma_f32_32x32x16_bf16 v[36:51], v[140:143], v[4:7], 0
    v_exp_f32 v52, v52
    v_exp_f32 v53, v53
    v_exp_f32 v54, v54
    v_mfma_f32_32x32x16_bf16 v[100:115], v[172:175], v[20:23], v[100:115]
    v_exp_f32 v55, v55
    v_exp_f32 v56, v56
    v_exp_f32 v57, v57
    v_mfma_f32_32x32x16_bf16 v[100:115], v[176:179], v[24:27], v[100:115]
    v_cvt_pk_bf16_f32 v28, v52, v53
    v_exp_f32 v58, v58
    v_cvt_pk_bf16_f32 v29, v54, v55
    v_exp_f32 v59, v59
    v_cvt_pk_bf16_f32 v30, v56, v57
    v_exp_f32 v60, v60
    v_exp_f32 v61, v61
    v_cvt_pk_bf16_f32 v31, v58, v59
    v_exp_f32 v62, v62
    v_exp_f32 v63, v63
    v_cvt_pk_bf16_f32 v32, v60, v61
    v_exp_f32 v64, v64
    v_exp_f32 v65, v65
    v_cvt_pk_bf16_f32 v33, v62, v63
    v_exp_f32 v66, v66
    v_exp_f32 v67, v67
    v_cvt_pk_bf16_f32 v34, v64, v65
    v_cvt_pk_bf16_f32 v35, v66, v67
    v_mfma_f32_32x32x16_bf16 v[52:67], v[140:143], v[8:11], 0
    v_exp_f32 v36, v36
    v_exp_f32 v37, v37
    v_exp_f32 v38, v38
    v_mfma_f32_32x32x16_bf16 v[116:131], v[172:175], v[28:31], v[116:131]
    v_exp_f32 v39, v39
    v_exp_f32 v40, v40
    v_exp_f32 v41, v41
    v_mfma_f32_32x32x16_bf16 v[116:131], v[176:179], v[32:35], v[116:131]
    v_cvt_pk_bf16_f32 v20, v36, v37
    v_exp_f32 v42, v42
    v_cvt_pk_bf16_f32 v21, v38, v39
    v_exp_f32 v43, v43
    buffer_load_dwordx4 v[156:159], v1, s[36:39], s6 offen offset:2048 sc1
    v_cvt_pk_bf16_f32 v22, v40, v41
    v_exp_f32 v44, v44
    v_exp_f32 v45, v45
    s_mov_b64 exec, s[16:17]
    buffer_load_dwordx4 v[212:215], v2, s[36:39], s7 offen offset:2048 sc1
    buffer_load_dwordx4 v[216:219], v2, s[36:39], s7 offen offset:2560 sc1
    s_mov_b64 exec, -1
    v_cvt_pk_bf16_f32 v23, v42, v43
    v_exp_f32 v46, v46
    v_exp_f32 v47, v47
    v_cvt_pk_bf16_f32 v24, v44, v45
    v_exp_f32 v48, v48
    v_exp_f32 v49, v49
    v_cvt_pk_bf16_f32 v25, v46, v47
    v_exp_f32 v50, v50
    v_exp_f32 v51, v51
    v_cvt_pk_bf16_f32 v26, v48, v49
    v_cvt_pk_bf16_f32 v27, v50, v51
    v_mfma_f32_32x32x16_bf16 v[36:51], v[140:143], v[12:15], 0
    v_exp_f32 v52, v52
    v_exp_f32 v53, v53
    v_exp_f32 v54, v54
    v_mfma_f32_32x32x16_bf16 v[68:83], v[180:183], v[20:23], v[68:83]
    v_exp_f32 v55, v55
    v_exp_f32 v56, v56
    v_exp_f32 v57, v57
    v_mfma_f32_32x32x16_bf16 v[68:83], v[184:187], v[24:27], v[68:83]
    v_cvt_pk_bf16_f32 v28, v52, v53
    v_exp_f32 v58, v58
    v_cvt_pk_bf16_f32 v29, v54, v55
    v_exp_f32 v59, v59
    v_cvt_pk_bf16_f32 v30, v56, v57
    v_exp_f32 v60, v60
    v_exp_f32 v61, v61
    v_cvt_pk_bf16_f32 v31, v58, v59
    v_exp_f32 v62, v62
    v_exp_f32 v63, v63
    v_cvt_pk_bf16_f32 v32, v60, v61
    v_exp_f32 v64, v64
    v_exp_f32 v65, v65
    v_cvt_pk_bf16_f32 v33, v62, v63
    v_exp_f32 v66, v66
    v_exp_f32 v67, v67
    v_cvt_pk_bf16_f32 v34, v64, v65
    v_cvt_pk_bf16_f32 v35, v66, v67
    v_mfma_f32_32x32x16_bf16 v[52:67], v[140:143], v[16:19], 0
    v_exp_f32 v36, v36
    v_exp_f32 v37, v37
    v_exp_f32 v38, v38
    v_mfma_f32_32x32x16_bf16 v[84:99], v[180:183], v[28:31], v[84:99]
    v_exp_f32 v39, v39
    v_exp_f32 v40, v40
    v_exp_f32 v41, v41
    v_mfma_f32_32x32x16_bf16 v[84:99], v[184:187], v[32:35], v[84:99]
    v_cvt_pk_bf16_f32 v20, v36, v37
    v_exp_f32 v42, v42
    v_cvt_pk_bf16_f32 v21, v38, v39
    v_exp_f32 v43, v43
    buffer_load_dwordx4 v[160:163], v1, s[36:39], s6 offen offset:3072 sc1
    v_cvt_pk_bf16_f32 v22, v40, v41
    v_exp_f32 v44, v44
    v_exp_f32 v45, v45
    s_mov_b64 exec, s[16:17]
    buffer_load_dwordx4 v[220:223], v2, s[36:39], s7 offen offset:3072 sc1
    buffer_load_dwordx4 v[224:227], v2, s[36:39], s7 offen offset:3584 sc1
    s_mov_b64 exec, -1
    v_cvt_pk_bf16_f32 v23, v42, v43
    v_exp_f32 v46, v46
    v_exp_f32 v47, v47
    v_cvt_pk_bf16_f32 v24, v44, v45
    v_exp_f32 v48, v48
    v_exp_f32 v49, v49
    v_cvt_pk_bf16_f32 v25, v46, v47
    v_exp_f32 v50, v50
    v_exp_f32 v51, v51
    v_cvt_pk_bf16_f32 v26, v48, v49
    v_cvt_pk_bf16_f32 v27, v50, v51
    s_waitcnt vmcnt(12)
    v_mfma_f32_32x32x16_bf16 v[36:51], v[144:147], v[4:7], 0
    v_exp_f32 v52, v52
    v_exp_f32 v53, v53
    v_exp_f32 v54, v54
    v_mfma_f32_32x32x16_bf16 v[100:115], v[180:183], v[20:23], v[100:115]
    v_exp_f32 v55, v55
    v_exp_f32 v56, v56
    v_exp_f32 v57, v57
    v_mfma_f32_32x32x16_bf16 v[100:115], v[184:187], v[24:27], v[100:115]
    v_cvt_pk_bf16_f32 v28, v52, v53
    v_exp_f32 v58, v58
    v_cvt_pk_bf16_f32 v29, v54, v55
    v_exp_f32 v59, v59
    v_cvt_pk_bf16_f32 v30, v56, v57
    v_exp_f32 v60, v60
    v_exp_f32 v61, v61
    v_cvt_pk_bf16_f32 v31, v58, v59
    v_exp_f32 v62, v62
    v_exp_f32 v63, v63
    v_cvt_pk_bf16_f32 v32, v60, v61
    v_exp_f32 v64, v64
    v_exp_f32 v65, v65
    v_cvt_pk_bf16_f32 v33, v62, v63
    v_exp_f32 v66, v66
    v_exp_f32 v67, v67
    v_cvt_pk_bf16_f32 v34, v64, v65
    v_cvt_pk_bf16_f32 v35, v66, v67
    v_mfma_f32_32x32x16_bf16 v[52:67], v[144:147], v[8:11], 0
    v_exp_f32 v36, v36
    v_exp_f32 v37, v37
    v_exp_f32 v38, v38
    v_mfma_f32_32x32x16_bf16 v[116:131], v[180:183], v[28:31], v[116:131]
    v_exp_f32 v39, v39
    v_exp_f32 v40, v40
    v_exp_f32 v41, v41
    v_mfma_f32_32x32x16_bf16 v[116:131], v[184:187], v[32:35], v[116:131]
    v_cvt_pk_bf16_f32 v20, v36, v37
    v_exp_f32 v42, v42
    v_cvt_pk_bf16_f32 v21, v38, v39
    v_exp_f32 v43, v43
    v_cvt_pk_bf16_f32 v22, v40, v41
    v_exp_f32 v44, v44
    v_exp_f32 v45, v45
    v_cvt_pk_bf16_f32 v23, v42, v43
    v_exp_f32 v46, v46
    v_exp_f32 v47, v47
    v_cvt_pk_bf16_f32 v24, v44, v45
    v_exp_f32 v48, v48
    v_exp_f32 v49, v49
    v_cvt_pk_bf16_f32 v25, v46, v47
    v_exp_f32 v50, v50
    v_exp_f32 v51, v51
    v_cvt_pk_bf16_f32 v26, v48, v49
    v_cvt_pk_bf16_f32 v27, v50, v51
    v_mfma_f32_32x32x16_bf16 v[36:51], v[144:147], v[12:15], 0
    v_exp_f32 v52, v52
    v_exp_f32 v53, v53
    v_exp_f32 v54, v54
    v_mfma_f32_32x32x16_bf16 v[68:83], v[188:191], v[20:23], v[68:83]
    v_exp_f32 v55, v55
    v_exp_f32 v56, v56
    v_exp_f32 v57, v57
    v_mfma_f32_32x32x16_bf16 v[68:83], v[192:195], v[24:27], v[68:83]
    v_cvt_pk_bf16_f32 v28, v52, v53
    v_exp_f32 v58, v58
    v_cvt_pk_bf16_f32 v29, v54, v55
    v_exp_f32 v59, v59
    v_cvt_pk_bf16_f32 v30, v56, v57
    v_exp_f32 v60, v60
    v_exp_f32 v61, v61
    v_cvt_pk_bf16_f32 v31, v58, v59
    v_exp_f32 v62, v62
    v_exp_f32 v63, v63
    v_cvt_pk_bf16_f32 v32, v60, v61
    v_exp_f32 v64, v64
    v_exp_f32 v65, v65
    v_cvt_pk_bf16_f32 v33, v62, v63
    v_exp_f32 v66, v66
    v_exp_f32 v67, v67
    v_cvt_pk_bf16_f32 v34, v64, v65
    v_cvt_pk_bf16_f32 v35, v66, v67
    v_mfma_f32_32x32x16_bf16 v[52:67], v[144:147], v[16:19], 0
    v_exp_f32 v36, v36
    v_exp_f32 v37, v37
    v_exp_f32 v38, v38
    v_mfma_f32_32x32x16_bf16 v[84:99], v[188:191], v[28:31], v[84:99]
    v_exp_f32 v39, v39
    v_exp_f32 v40, v40
    v_exp_f32 v41, v41
    v_mfma_f32_32x32x16_bf16 v[84:99], v[192:195], v[32:35], v[84:99]
    v_cvt_pk_bf16_f32 v20, v36, v37
    v_exp_f32 v42, v42
    v_cvt_pk_bf16_f32 v21, v38, v39
    v_exp_f32 v43, v43
    v_cvt_pk_bf16_f32 v22, v40, v41
    v_exp_f32 v44, v44
    v_exp_f32 v45, v45
    v_cvt_pk_bf16_f32 v23, v42, v43
    v_exp_f32 v46, v46
    v_exp_f32 v47, v47
    v_cvt_pk_bf16_f32 v24, v44, v45
    v_exp_f32 v48, v48
    v_exp_f32 v49, v49
    v_cvt_pk_bf16_f32 v25, v46, v47
    v_exp_f32 v50, v50
    v_exp_f32 v51, v51
    v_cvt_pk_bf16_f32 v26, v48, v49
    v_cvt_pk_bf16_f32 v27, v50, v51
    s_waitcnt vmcnt(9)
    v_mfma_f32_32x32x16_bf16 v[36:51], v[148:151], v[4:7], 0
    v_exp_f32 v52, v52
    v_exp_f32 v53, v53
    v_exp_f32 v54, v54
    v_mfma_f32_32x32x16_bf16 v[100:115], v[188:191], v[20:23], v[100:115]
    v_exp_f32 v55, v55
    v_exp_f32 v56, v56
    v_exp_f32 v57, v57
    v_mfma_f32_32x32x16_bf16 v[100:115], v[192:195], v[24:27], v[100:115]
    v_cvt_pk_bf16_f32 v28, v52, v53
    v_exp_f32 v58, v58
    v_cvt_pk_bf16_f32 v29, v54, v55
    v_exp_f32 v59, v59
    v_cvt_pk_bf16_f32 v30, v56, v57
    v_exp_f32 v60, v60
    v_exp_f32 v61, v61
    v_cvt_pk_bf16_f32 v31, v58, v59
    v_exp_f32 v62, v62
    v_exp_f32 v63, v63
    v_cvt_pk_bf16_f32 v32, v60, v61
    v_exp_f32 v64, v64
    v_exp_f32 v65, v65
    v_cvt_pk_bf16_f32 v33, v62, v63
    v_exp_f32 v66, v66
    v_exp_f32 v67, v67
    v_cvt_pk_bf16_f32 v34, v64, v65
    v_cvt_pk_bf16_f32 v35, v66, v67
    v_mfma_f32_32x32x16_bf16 v[52:67], v[148:151], v[8:11], 0
    v_exp_f32 v36, v36
    v_exp_f32 v37, v37
    v_exp_f32 v38, v38
    v_mfma_f32_32x32x16_bf16 v[116:131], v[188:191], v[28:31], v[116:131]
    v_exp_f32 v39, v39
    v_exp_f32 v40, v40
    v_exp_f32 v41, v41
    v_mfma_f32_32x32x16_bf16 v[116:131], v[192:195], v[32:35], v[116:131]
    v_cvt_pk_bf16_f32 v20, v36, v37
    v_exp_f32 v42, v42
    v_cvt_pk_bf16_f32 v21, v38, v39
    v_exp_f32 v43, v43
    v_cvt_pk_bf16_f32 v22, v40, v41
    v_exp_f32 v44, v44
    v_exp_f32 v45, v45
    v_cvt_pk_bf16_f32 v23, v42, v43
    v_exp_f32 v46, v46
    v_exp_f32 v47, v47
    v_cvt_pk_bf16_f32 v24, v44, v45
    v_exp_f32 v48, v48
    v_exp_f32 v49, v49
    v_cvt_pk_bf16_f32 v25, v46, v47
    v_exp_f32 v50, v50
    v_exp_f32 v51, v51
    v_cvt_pk_bf16_f32 v26, v48, v49
    v_cvt_pk_bf16_f32 v27, v50, v51
    v_mfma_f32_32x32x16_bf16 v[36:51], v[148:151], v[12:15], 0
    v_exp_f32 v52, v52
    v_exp_f32 v53, v53
    v_exp_f32 v54, v54
    v_mfma_f32_32x32x16_bf16 v[68:83], v[196:199], v[20:23], v[68:83]
    v_exp_f32 v55, v55
    v_exp_f32 v56, v56
    v_exp_f32 v57, v57
    v_mfma_f32_32x32x16_bf16 v[68:83], v[200:203], v[24:27], v[68:83]
    v_cvt_pk_bf16_f32 v28, v52, v53
    v_exp_f32 v58, v58
    v_cvt_pk_bf16_f32 v29, v54, v55
    v_exp_f32 v59, v59
    v_cvt_pk_bf16_f32 v30, v56, v57
    v_exp_f32 v60, v60
    v_exp_f32 v61, v61
    v_cvt_pk_bf16_f32 v31, v58, v59
    v_exp_f32 v62, v62
    v_exp_f32 v63, v63
    v_cvt_pk_bf16_f32 v32, v60, v61
    v_exp_f32 v64, v64
    v_exp_f32 v65, v65
    v_cvt_pk_bf16_f32 v33, v62, v63
    v_exp_f32 v66, v66
    v_exp_f32 v67, v67
    v_cvt_pk_bf16_f32 v34, v64, v65
    v_cvt_pk_bf16_f32 v35, v66, v67
    v_mfma_f32_32x32x16_bf16 v[52:67], v[148:151], v[16:19], 0
    v_exp_f32 v36, v36
    v_exp_f32 v37, v37
    v_exp_f32 v38, v38
    v_mfma_f32_32x32x16_bf16 v[84:99], v[196:199], v[28:31], v[84:99]
    v_exp_f32 v39, v39
    v_exp_f32 v40, v40
    v_exp_f32 v41, v41
    v_mfma_f32_32x32x16_bf16 v[84:99], v[200:203], v[32:35], v[84:99]
    v_cvt_pk_bf16_f32 v20, v36, v37
    v_exp_f32 v42, v42
    v_cvt_pk_bf16_f32 v21, v38, v39
    v_exp_f32 v43, v43
    v_cvt_pk_bf16_f32 v22, v40, v41
    v_exp_f32 v44, v44
    v_exp_f32 v45, v45
    v_cvt_pk_bf16_f32 v23, v42, v43
    v_exp_f32 v46, v46
    v_exp_f32 v47, v47
    v_cvt_pk_bf16_f32 v24, v44, v45
    v_exp_f32 v48, v48
    v_exp_f32 v49, v49
    v_cvt_pk_bf16_f32 v25, v46, v47
    v_exp_f32 v50, v50
    v_exp_f32 v51, v51
    v_cvt_pk_bf16_f32 v26, v48, v49
    v_cvt_pk_bf16_f32 v27, v50, v51
    s_waitcnt vmcnt(6)
    v_mfma_f32_32x32x16_bf16 v[36:51], v[152:155], v[4:7], 0
    v_exp_f32 v52, v52
    v_exp_f32 v53, v53
    v_exp_f32 v54, v54
    v_mfma_f32_32x32x16_bf16 v[100:115], v[196:199], v[20:23], v[100:115]
    v_exp_f32 v55, v55
    v_exp_f32 v56, v56
    v_exp_f32 v57, v57
    v_mfma_f32_32x32x16_bf16 v[100:115], v[200:203], v[24:27], v[100:115]
    v_cvt_pk_bf16_f32 v28, v52, v53
    v_exp_f32 v58, v58
    v_cvt_pk_bf16_f32 v29, v54, v55
    v_exp_f32 v59, v59
    v_cvt_pk_bf16_f32 v30, v56, v57
    v_exp_f32 v60, v60
    v_exp_f32 v61, v61
    v_cvt_pk_bf16_f32 v31, v58, v59
    v_exp_f32 v62, v62
    v_exp_f32 v63, v63
    v_cvt_pk_bf16_f32 v32, v60, v61
    v_exp_f32 v64, v64
    v_exp_f32 v65, v65
    v_cvt_pk_bf16_f32 v33, v62, v63
    v_exp_f32 v66, v66
    v_exp_f32 v67, v67
    v_cvt_pk_bf16_f32 v34, v64, v65
    v_cvt_pk_bf16_f32 v35, v66, v67
    v_mfma_f32_32x32x16_bf16 v[52:67], v[152:155], v[8:11], 0
    v_exp_f32 v36, v36
    v_exp_f32 v37, v37
    v_exp_f32 v38, v38
    v_mfma_f32_32x32x16_bf16 v[116:131], v[196:199], v[28:31], v[116:131]
    v_exp_f32 v39, v39
    v_exp_f32 v40, v40
    v_exp_f32 v41, v41
    v_mfma_f32_32x32x16_bf16 v[116:131], v[200:203], v[32:35], v[116:131]
    v_cvt_pk_bf16_f32 v20, v36, v37
    v_exp_f32 v42, v42
    v_cvt_pk_bf16_f32 v21, v38, v39
    v_exp_f32 v43, v43
    v_cvt_pk_bf16_f32 v22, v40, v41
    v_exp_f32 v44, v44
    v_exp_f32 v45, v45
    v_cvt_pk_bf16_f32 v23, v42, v43
    v_exp_f32 v46, v46
    v_exp_f32 v47, v47
    v_cvt_pk_bf16_f32 v24, v44, v45
    v_exp_f32 v48, v48
    v_exp_f32 v49, v49
    v_cvt_pk_bf16_f32 v25, v46, v47
    v_exp_f32 v50, v50
    v_exp_f32 v51, v51
    v_cvt_pk_bf16_f32 v26, v48, v49
    v_cvt_pk_bf16_f32 v27, v50, v51
    v_mfma_f32_32x32x16_bf16 v[36:51], v[152:155], v[12:15], 0
    v_exp_f32 v52, v52
    v_exp_f32 v53, v53
    v_exp_f32 v54, v54
    v_mfma_f32_32x32x16_bf16 v[68:83], v[204:207], v[20:23], v[68:83]
    v_exp_f32 v55, v55
    v_exp_f32 v56, v56
    v_exp_f32 v57, v57
    v_mfma_f32_32x32x16_bf16 v[68:83], v[208:211], v[24:27], v[68:83]
    v_cvt_pk_bf16_f32 v28, v52, v53
    v_exp_f32 v58, v58
    v_cvt_pk_bf16_f32 v29, v54, v55
    v_exp_f32 v59, v59
    v_cvt_pk_bf16_f32 v30, v56, v57
    v_exp_f32 v60, v60
    v_exp_f32 v61, v61
    v_cvt_pk_bf16_f32 v31, v58, v59
    v_exp_f32 v62, v62
    v_exp_f32 v63, v63
    v_cvt_pk_bf16_f32 v32, v60, v61
    v_exp_f32 v64, v64
    v_exp_f32 v65, v65
    v_cvt_pk_bf16_f32 v33, v62, v63
    v_exp_f32 v66, v66
    v_exp_f32 v67, v67
    v_cvt_pk_bf16_f32 v34, v64, v65
    v_cvt_pk_bf16_f32 v35, v66, v67
    v_mfma_f32_32x32x16_bf16 v[52:67], v[152:155], v[16:19], 0
    v_exp_f32 v36, v36
    v_exp_f32 v37, v37
    v_exp_f32 v38, v38
    v_mfma_f32_32x32x16_bf16 v[84:99], v[204:207], v[28:31], v[84:99]
    v_exp_f32 v39, v39
    v_exp_f32 v40, v40
    v_exp_f32 v41, v41
    v_mfma_f32_32x32x16_bf16 v[84:99], v[208:211], v[32:35], v[84:99]
    v_cvt_pk_bf16_f32 v20, v36, v37
    v_exp_f32 v42, v42
    v_cvt_pk_bf16_f32 v21, v38, v39
    v_exp_f32 v43, v43
    v_cvt_pk_bf16_f32 v22, v40, v41
    v_exp_f32 v44, v44
    v_exp_f32 v45, v45
    v_cvt_pk_bf16_f32 v23, v42, v43
    v_exp_f32 v46, v46
    v_exp_f32 v47, v47
    v_cvt_pk_bf16_f32 v24, v44, v45
    v_exp_f32 v48, v48
    v_exp_f32 v49, v49
    v_cvt_pk_bf16_f32 v25, v46, v47
    v_exp_f32 v50, v50
    v_exp_f32 v51, v51
    v_cvt_pk_bf16_f32 v26, v48, v49
    v_cvt_pk_bf16_f32 v27, v50, v51
    s_waitcnt vmcnt(3)
    v_mfma_f32_32x32x16_bf16 v[36:51], v[156:159], v[4:7], 0
    v_exp_f32 v52, v52
    v_exp_f32 v53, v53
    v_exp_f32 v54, v54
    v_mfma_f32_32x32x16_bf16 v[100:115], v[204:207], v[20:23], v[100:115]
    v_exp_f32 v55, v55
    v_exp_f32 v56, v56
    v_exp_f32 v57, v57
    v_mfma_f32_32x32x16_bf16 v[100:115], v[208:211], v[24:27], v[100:115]
    v_cvt_pk_bf16_f32 v28, v52, v53
    v_exp_f32 v58, v58
    v_cvt_pk_bf16_f32 v29, v54, v55
    v_exp_f32 v59, v59
    v_cvt_pk_bf16_f32 v30, v56, v57
    v_exp_f32 v60, v60
    v_exp_f32 v61, v61
    v_cvt_pk_bf16_f32 v31, v58, v59
    v_exp_f32 v62, v62
    v_exp_f32 v63, v63
    v_cvt_pk_bf16_f32 v32, v60, v61
    v_exp_f32 v64, v64
    v_exp_f32 v65, v65
    v_cvt_pk_bf16_f32 v33, v62, v63
    v_exp_f32 v66, v66
    v_exp_f32 v67, v67
    v_cvt_pk_bf16_f32 v34, v64, v65
    v_cvt_pk_bf16_f32 v35, v66, v67
    v_mfma_f32_32x32x16_bf16 v[52:67], v[156:159], v[8:11], 0
    v_exp_f32 v36, v36
    v_exp_f32 v37, v37
    v_exp_f32 v38, v38
    v_mfma_f32_32x32x16_bf16 v[116:131], v[204:207], v[28:31], v[116:131]
    v_exp_f32 v39, v39
    v_exp_f32 v40, v40
    v_exp_f32 v41, v41
    v_mfma_f32_32x32x16_bf16 v[116:131], v[208:211], v[32:35], v[116:131]
    v_cvt_pk_bf16_f32 v20, v36, v37
    v_exp_f32 v42, v42
    v_cvt_pk_bf16_f32 v21, v38, v39
    v_exp_f32 v43, v43
    v_cvt_pk_bf16_f32 v22, v40, v41
    v_exp_f32 v44, v44
    v_exp_f32 v45, v45
    v_cvt_pk_bf16_f32 v23, v42, v43
    v_exp_f32 v46, v46
    v_exp_f32 v47, v47
    v_cvt_pk_bf16_f32 v24, v44, v45
    v_exp_f32 v48, v48
    v_exp_f32 v49, v49
    v_cvt_pk_bf16_f32 v25, v46, v47
    v_exp_f32 v50, v50
    v_exp_f32 v51, v51
    v_cvt_pk_bf16_f32 v26, v48, v49
    v_cvt_pk_bf16_f32 v27, v50, v51
    v_mfma_f32_32x32x16_bf16 v[36:51], v[156:159], v[12:15], 0
    v_exp_f32 v52, v52
    v_exp_f32 v53, v53
    v_exp_f32 v54, v54
    v_mfma_f32_32x32x16_bf16 v[68:83], v[212:215], v[20:23], v[68:83]
    v_exp_f32 v55, v55
    v_exp_f32 v56, v56
    v_exp_f32 v57, v57
    v_mfma_f32_32x32x16_bf16 v[68:83], v[216:219], v[24:27], v[68:83]
    v_cvt_pk_bf16_f32 v28, v52, v53
    v_exp_f32 v58, v58
    v_cvt_pk_bf16_f32 v29, v54, v55
    v_exp_f32 v59, v59
    v_cvt_pk_bf16_f32 v30, v56, v57
    v_exp_f32 v60, v60
    v_exp_f32 v61, v61
    v_cvt_pk_bf16_f32 v31, v58, v59
    v_exp_f32 v62, v62
    v_exp_f32 v63, v63
    v_cvt_pk_bf16_f32 v32, v60, v61
    v_exp_f32 v64, v64
    v_exp_f32 v65, v65
    v_cvt_pk_bf16_f32 v33, v62, v63
    v_exp_f32 v66, v66
    v_exp_f32 v67, v67
    v_cvt_pk_bf16_f32 v34, v64, v65
    v_cvt_pk_bf16_f32 v35, v66, v67
    v_mfma_f32_32x32x16_bf16 v[52:67], v[156:159], v[16:19], 0
    v_exp_f32 v36, v36
    v_exp_f32 v37, v37
    v_exp_f32 v38, v38
    v_mfma_f32_32x32x16_bf16 v[84:99], v[212:215], v[28:31], v[84:99]
    v_exp_f32 v39, v39
    v_exp_f32 v40, v40
    v_exp_f32 v41, v41
    v_mfma_f32_32x32x16_bf16 v[84:99], v[216:219], v[32:35], v[84:99]
    v_cvt_pk_bf16_f32 v20, v36, v37
    v_exp_f32 v42, v42
    v_cvt_pk_bf16_f32 v21, v38, v39
    v_exp_f32 v43, v43
    v_cvt_pk_bf16_f32 v22, v40, v41
    v_exp_f32 v44, v44
    v_exp_f32 v45, v45
    v_cvt_pk_bf16_f32 v23, v42, v43
    v_exp_f32 v46, v46
    v_exp_f32 v47, v47
    v_cvt_pk_bf16_f32 v24, v44, v45
    v_exp_f32 v48, v48
    v_exp_f32 v49, v49
    v_cvt_pk_bf16_f32 v25, v46, v47
    v_exp_f32 v50, v50
    v_exp_f32 v51, v51
    v_cvt_pk_bf16_f32 v26, v48, v49
    v_cvt_pk_bf16_f32 v27, v50, v51
    s_waitcnt vmcnt(0)
    v_mfma_f32_32x32x16_bf16 v[36:51], v[160:163], v[4:7], 0
    v_exp_f32 v52, v52
    v_exp_f32 v53, v53
    v_exp_f32 v54, v54
    v_mfma_f32_32x32x16_bf16 v[100:115], v[212:215], v[20:23], v[100:115]
    v_exp_f32 v55, v55
    v_exp_f32 v56, v56
    v_exp_f32 v57, v57
    v_mfma_f32_32x32x16_bf16 v[100:115], v[216:219], v[24:27], v[100:115]
    v_cvt_pk_bf16_f32 v28, v52, v53
    v_exp_f32 v58, v58
    v_cvt_pk_bf16_f32 v29, v54, v55
    v_exp_f32 v59, v59
    v_cvt_pk_bf16_f32 v30, v56, v57
    v_exp_f32 v60, v60
    v_exp_f32 v61, v61
    v_cvt_pk_bf16_f32 v31, v58, v59
    v_exp_f32 v62, v62
    v_exp_f32 v63, v63
    v_cvt_pk_bf16_f32 v32, v60, v61
    v_exp_f32 v64, v64
    v_exp_f32 v65, v65
    v_cvt_pk_bf16_f32 v33, v62, v63
    v_exp_f32 v66, v66
    v_exp_f32 v67, v67
    v_cvt_pk_bf16_f32 v34, v64, v65
    v_cvt_pk_bf16_f32 v35, v66, v67
    v_mfma_f32_32x32x16_bf16 v[52:67], v[160:163], v[8:11], 0
    v_exp_f32 v36, v36
    v_exp_f32 v37, v37
    v_exp_f32 v38, v38
    v_mfma_f32_32x32x16_bf16 v[116:131], v[212:215], v[28:31], v[116:131]
    v_exp_f32 v39, v39
    v_exp_f32 v40, v40
    v_exp_f32 v41, v41
    v_mfma_f32_32x32x16_bf16 v[116:131], v[216:219], v[32:35], v[116:131]
    v_cvt_pk_bf16_f32 v20, v36, v37
    v_exp_f32 v42, v42
    v_cvt_pk_bf16_f32 v21, v38, v39
    v_exp_f32 v43, v43
    v_cvt_pk_bf16_f32 v22, v40, v41
    v_exp_f32 v44, v44
    v_exp_f32 v45, v45
    v_cvt_pk_bf16_f32 v23, v42, v43
    v_exp_f32 v46, v46
    v_exp_f32 v47, v47
    v_cvt_pk_bf16_f32 v24, v44, v45
    v_exp_f32 v48, v48
    v_exp_f32 v49, v49
    v_cvt_pk_bf16_f32 v25, v46, v47
    v_exp_f32 v50, v50
    v_exp_f32 v51, v51
    v_cvt_pk_bf16_f32 v26, v48, v49
    v_cvt_pk_bf16_f32 v27, v50, v51
    v_mov_b32 v228, 161136
    s_mov_b32 s59, 200000
parallel_sum__mha_block__glu_gated_geglu__prompt_kernel_kvw2:
    ds_read_b128 v[232:235], v228
    s_sub_u32 s59, s59, 1
    s_cmp_eq_u32 s59, 0
    s_waitcnt lgkmcnt(0)
    s_cbranch_scc1 parallel_sum__mha_block__glu_gated_geglu__prompt_kernel_kvw2_x
    v_min3_u32 v232, v232, v233, v234
    v_min_u32 v232, v232, v235
    s_nop 0
    v_readfirstlane_b32 s58, v232
    s_nop 1
    s_cmp_lg_u32 s58, 0
    s_cbranch_scc1 parallel_sum__mha_block__glu_gated_geglu__prompt_kernel_kvw2_x
    s_sleep 1
    s_branch parallel_sum__mha_block__glu_gated_geglu__prompt_kernel_kvw2
parallel_sum__mha_block__glu_gated_geglu__prompt_kernel_kvw2_x:
    v_mfma_f32_32x32x16_bf16 v[36:51], v[160:163], v[12:15], 0
    v_exp_f32 v52, v52
    v_exp_f32 v53, v53
    v_exp_f32 v54, v54
    v_mfma_f32_32x32x16_bf16 v[68:83], v[220:223], v[20:23], v[68:83]
    v_exp_f32 v55, v55
    v_exp_f32 v56, v56
    v_exp_f32 v57, v57
    v_mfma_f32_32x32x16_bf16 v[68:83], v[224:227], v[24:27], v[68:83]
    v_cvt_pk_bf16_f32 v28, v52, v53
    v_exp_f32 v58, v58
    v_cvt_pk_bf16_f32 v29, v54, v55
    v_exp_f32 v59, v59
    ds_read_b128 v[132:135], v238 offset:0
    v_cvt_pk_bf16_f32 v30, v56, v57
    v_exp_f32 v60, v60
    v_exp_f32 v61, v61
    s_mov_b64 exec, s[16:17]
    ds_read_b128 v[164:167], v239 offset:0
    ds_read_b128 v[168:171], v239 offset:512
    s_mov_b64 exec, -1
    v_cvt_pk_bf16_f32 v31, v58, v59
    v_exp_f32 v62, v62
    v_exp_f32 v63, v63
    v_cvt_pk_bf16_f32 v32, v60, v61
    v_exp_f32 v64, v64
    v_exp_f32 v65, v65
    v_cvt_pk_bf16_f32 v33, v62, v63
    v_exp_f32 v66, v66
    v_exp_f32 v67, v67
    v_cvt_pk_bf16_f32 v34, v64, v65
    v_cvt_pk_bf16_f32 v35, v66, v67
    v_mfma_f32_32x32x16_bf16 v[52:67], v[160:163], v[16:19], 0
    v_exp_f32 v36, v36
    v_exp_f32 v37, v37
    v_exp_f32 v38, v38
    v_mfma_f32_32x32x16_bf16 v[84:99], v[220:223], v[28:31], v[84:99]
    v_exp_f32 v39, v39
    v_exp_f32 v40, v40
    v_exp_f32 v41, v41
    v_mfma_f32_32x32x16_bf16 v[84:99], v[224:227], v[32:35], v[84:99]
    v_cvt_pk_bf16_f32 v20, v36, v37
    v_exp_f32 v42, v42
    v_cvt_pk_bf16_f32 v21, v38, v39
    v_exp_f32 v43, v43
    v_cvt_pk_bf16_f32 v22, v40, v41
    v_exp_f32 v44, v44
    v_exp_f32 v45, v45
    v_cvt_pk_bf16_f32 v23, v42, v43
    v_exp_f32 v46, v46
    v_exp_f32 v47, v47
    v_cvt_pk_bf16_f32 v24, v44, v45
    v_exp_f32 v48, v48
    v_exp_f32 v49, v49
    v_cvt_pk_bf16_f32 v25, v46, v47
    v_exp_f32 v50, v50
    v_exp_f32 v51, v51
    v_cvt_pk_bf16_f32 v26, v48, v49
    v_cvt_pk_bf16_f32 v27, v50, v51
    s_waitcnt lgkmcnt(0)
    v_mfma_f32_32x32x16_bf16 v[36:51], v[132:135], v[4:7], 0
    v_exp_f32 v52, v52
    v_exp_f32 v53, v53
    v_exp_f32 v54, v54
    v_mfma_f32_32x32x16_bf16 v[100:115], v[220:223], v[20:23], v[100:115]
    v_exp_f32 v55, v55
    v_exp_f32 v56, v56
    v_exp_f32 v57, v57
    v_mfma_f32_32x32x16_bf16 v[100:115], v[224:227], v[24:27], v[100:115]
    v_cvt_pk_bf16_f32 v28, v52, v53
    v_exp_f32 v58, v58
    v_cvt_pk_bf16_f32 v29, v54, v55
    v_exp_f32 v59, v59
    v_cvt_pk_bf16_f32 v30, v56, v57
    v_exp_f32 v60, v60
    v_exp_f32 v61, v61
    v_cvt_pk_bf16_f32 v31, v58, v59
    v_exp_f32 v62, v62
    v_exp_f32 v63, v63
    v_cvt_pk_bf16_f32 v32, v60, v61
    v_exp_f32 v64, v64
    v_exp_f32 v65, v65
    v_cvt_pk_bf16_f32 v33, v62, v63
    v_exp_f32 v66, v66
    v_exp_f32 v67, v67
    v_cvt_pk_bf16_f32 v34, v64, v65
    v_cvt_pk_bf16_f32 v35, v66, v67
    v_mov_b32 v172, v220
    v_mov_b32 v173, v221
    v_mov_b32 v174, v222
    v_mov_b32 v175, v223
    v_mov_b32 v176, v224
    v_mov_b32 v177, v225
    v_mov_b32 v178, v226
    v_mov_b32 v179, v227
    s_mov_b32 s8, 5
.p2align 3
parallel_sum__mha_block__glu_gated_geglu__prompt_kernel_loop:
    v_mfma_f32_32x32x16_bf16 v[52:67], v[132:135], v[8:11], 0
    v_exp_f32 v36, v36
    v_exp_f32 v37, v37
    v_exp_f32 v38, v38
    v_mfma_f32_32x32x16_bf16 v[116:131], v[172:175], v[28:31], v[116:131]
    v_exp_f32 v39, v39
    v_exp_f32 v40, v40
    v_exp_f32 v41, v41
    v_mfma_f32_32x32x16_bf16 v[116:131], v[176:179], v[32:35], v[116:131]
    v_cvt_pk_bf16_f32 v20, v36, v37
    v_exp_f32 v42, v42
    v_cvt_pk_bf16_f32 v21, v38, v39
    v_exp_f32 v43, v43
    v_cvt_pk_bf16_f32 v22, v40, v41
    v_exp_f32 v44, v44
    v_exp_f32 v45, v45
    v_cvt_pk_bf16_f32 v23, v42, v43
    v_exp_f32 v46, v46
    v_exp_f32 v47, v47
    v_cvt_pk_bf16_f32 v24, v44, v45
    v_exp_f32 v48, v48
    v_exp_f32 v49, v49
    v_cvt_pk_bf16_f32 v25, v46, v47
    v_exp_f32 v50, v50
    v_exp_f32 v51, v51
    v_cvt_pk_bf16_f32 v26, v48, v49
    v_cvt_pk_bf16_f32 v27, v50, v51
    v_mfma_f32_32x32x16_bf16 v[36:51], v[132:135], v[12:15], 0
    v_exp_f32 v52, v52
    v_exp_f32 v53, v53
    v_exp_f32 v54, v54
    v_mfma_f32_32x32x16_bf16 v[68:83], v[164:167], v[20:23], v[68:83]
    v_exp_f32 v55, v55
    v_exp_f32 v56, v56
    v_exp_f32 v57, v57
    v_mfma_f32_32x32x16_bf16 v[68:83], v[168:171], v[24:27], v[68:83]
    v_cvt_pk_bf16_f32 v28, v52, v53
    v_exp_f32 v58, v58
    v_cvt_pk_bf16_f32 v29, v54, v55
    v_exp_f32 v59, v59
    ds_read_b128 v[136:139], v238 offset:1024
    v_cvt_pk_bf16_f32 v30, v56, v57
    v_exp_f32 v60, v60
    v_exp_f32 v61, v61
    s_mov_b64 exec, s[16:17]
    ds_read_b128 v[172:175], v239 offset:1024
    ds_read_b128 v[176:179], v239 offset:1536
    s_mov_b64 exec, -1
    v_cvt_pk_bf16_f32 v31, v58, v59
    v_exp_f32 v62, v62
    v_exp_f32 v63, v63
    v_cvt_pk_bf16_f32 v32, v60, v61
    v_exp_f32 v64, v64
    v_exp_f32 v65, v65
    v_cvt_pk_bf16_f32 v33, v62, v63
    v_exp_f32 v66, v66
    v_exp_f32 v67, v67
    v_cvt_pk_bf16_f32 v34, v64, v65
    v_cvt_pk_bf16_f32 v35, v66, v67
    v_mfma_f32_32x32x16_bf16 v[52:67], v[132:135], v[16:19], 0
    v_exp_f32 v36, v36
    v_exp_f32 v37, v37
    v_exp_f32 v38, v38
    v_mfma_f32_32x32x16_bf16 v[84:99], v[164:167], v[28:31], v[84:99]
    v_exp_f32 v39, v39
    v_exp_f32 v40, v40
    v_exp_f32 v41, v41
    v_mfma_f32_32x32x16_bf16 v[84:99], v[168:171], v[32:35], v[84:99]
    v_cvt_pk_bf16_f32 v20, v36, v37
    v_exp_f32 v42, v42
    v_cvt_pk_bf16_f32 v21, v38, v39
    v_exp_f32 v43, v43
    v_cvt_pk_bf16_f32 v22, v40, v41
    v_exp_f32 v44, v44
    v_exp_f32 v45, v45
    v_cvt_pk_bf16_f32 v23, v42, v43
    v_exp_f32 v46, v46
    v_exp_f32 v47, v47
    v_cvt_pk_bf16_f32 v24, v44, v45
    v_exp_f32 v48, v48
    v_exp_f32 v49, v49
    v_cvt_pk_bf16_f32 v25, v46, v47
    v_exp_f32 v50, v50
    v_exp_f32 v51, v51
    v_cvt_pk_bf16_f32 v26, v48, v49
    v_cvt_pk_bf16_f32 v27, v50, v51
    s_waitcnt lgkmcnt(0)
    v_mfma_f32_32x32x16_bf16 v[36:51], v[136:139], v[4:7], 0
    v_exp_f32 v52, v52
    v_exp_f32 v53, v53
    v_exp_f32 v54, v54
    v_mfma_f32_32x32x16_bf16 v[100:115], v[164:167], v[20:23], v[100:115]
    v_exp_f32 v55, v55
    v_exp_f32 v56, v56
    v_exp_f32 v57, v57
    v_mfma_f32_32x32x16_bf16 v[100:115], v[168:171], v[24:27], v[100:115]
    v_cvt_pk_bf16_f32 v28, v52, v53
    v_exp_f32 v58, v58
    v_cvt_pk_bf16_f32 v29, v54, v55
    v_exp_f32 v59, v59
    v_cvt_pk_bf16_f32 v30, v56, v57
    v_exp_f32 v60, v60
    v_exp_f32 v61, v61
    v_cvt_pk_bf16_f32 v31, v58, v59
    v_exp_f32 v62, v62
    v_exp_f32 v63, v63
    v_cvt_pk_bf16_f32 v32, v60, v61
    v_exp_f32 v64, v64
    v_exp_f32 v65, v65
    v_cvt_pk_bf16_f32 v33, v62, v63
    v_exp_f32 v66, v66
    v_exp_f32 v67, v67
    v_cvt_pk_bf16_f32 v34, v64, v65
    v_cvt_pk_bf16_f32 v35, v66, v67
    v_mfma_f32_32x32x16_bf16 v[52:67], v[136:139], v[8:11], 0
    v_exp_f32 v36, v36
    v_exp_f32 v37, v37
    v_exp_f32 v38, v38
    v_mfma_f32_32x32x16_bf16 v[116:131], v[164:167], v[28:31], v[116:131]
    v_exp_f32 v39, v39
    v_exp_f32 v40, v40
    v_exp_f32 v41, v41
    v_mfma_f32_32x32x16_bf16 v[116:131], v[168:171], v[32:35], v[116:131]
    v_cvt_pk_bf16_f32 v20, v36, v37
    v_exp_f32 v42, v42
    v_cvt_pk_bf16_f32 v21, v38, v39
    v_exp_f32 v43, v43
    v_cvt_pk_bf16_f32 v22, v40, v41
    v_exp_f32 v44, v44
    v_exp_f32 v45, v45
    v_cvt_pk_bf16_f32 v23, v42, v43
    v_exp_f32 v46, v46
    v_exp_f32 v47, v47
    v_cvt_pk_bf16_f32 v24, v44, v45
    v_exp_f32 v48, v48
    v_exp_f32 v49, v49
    v_cvt_pk_bf16_f32 v25, v46, v47
    v_exp_f32 v50, v50
    v_exp_f32 v51, v51
    v_cvt_pk_bf16_f32 v26, v48, v49
    v_cvt_pk_bf16_f32 v27, v50, v51
    v_mfma_f32_32x32x16_bf16 v[36:51], v[136:139], v[12:15], 0
    v_exp_f32 v52, v52
    v_exp_f32 v53, v53
    v_exp_f32 v54, v54
    v_mfma_f32_32x32x16_bf16 v[68:83], v[172:175], v[20:23], v[68:83]
    v_exp_f32 v55, v55
    v_exp_f32 v56, v56
    v_exp_f32 v57, v57
    v_mfma_f32_32x32x16_bf16 v[68:83], v[176:179], v[24:27], v[68:83]
    v_cvt_pk_bf16_f32 v28, v52, v53
    v_exp_f32 v58, v58
    v_cvt_pk_bf16_f32 v29, v54, v55
    v_exp_f32 v59, v59
    ds_read_b128 v[132:135], v238 offset:2048
    v_cvt_pk_bf16_f32 v30, v56, v57
    v_exp_f32 v60, v60
    v_exp_f32 v61, v61
    s_mov_b64 exec, s[16:17]
    ds_read_b128 v[164:167], v239 offset:2048
    ds_read_b128 v[168:171], v239 offset:2560
    s_mov_b64 exec, -1
    v_cvt_pk_bf16_f32 v31, v58, v59
    v_exp_f32 v62, v62
    v_exp_f32 v63, v63
    v_cvt_pk_bf16_f32 v32, v60, v61
    v_exp_f32 v64, v64
    v_exp_f32 v65, v65
    v_cvt_pk_bf16_f32 v33, v62, v63
    v_exp_f32 v66, v66
    v_exp_f32 v67, v67
    v_cvt_pk_bf16_f32 v34, v64, v65
    v_cvt_pk_bf16_f32 v35, v66, v67
    v_mfma_f32_32x32x16_bf16 v[52:67], v[136:139], v[16:19], 0
    v_exp_f32 v36, v36
    v_exp_f32 v37, v37
    v_exp_f32 v38, v38
    v_mfma_f32_32x32x16_bf16 v[84:99], v[172:175], v[28:31], v[84:99]
    v_exp_f32 v39, v39
    v_exp_f32 v40, v40
    v_exp_f32 v41, v41
    v_mfma_f32_32x32x16_bf16 v[84:99], v[176:179], v[32:35], v[84:99]
    v_cvt_pk_bf16_f32 v20, v36, v37
    v_exp_f32 v42, v42
    v_cvt_pk_bf16_f32 v21, v38, v39
    v_exp_f32 v43, v43
    v_cvt_pk_bf16_f32 v22, v40, v41
    v_exp_f32 v44, v44
    v_exp_f32 v45, v45
    v_cvt_pk_bf16_f32 v23, v42, v43
    v_exp_f32 v46, v46
    v_exp_f32 v47, v47
    v_cvt_pk_bf16_f32 v24, v44, v45
    v_exp_f32 v48, v48
    v_exp_f32 v49, v49
    v_cvt_pk_bf16_f32 v25, v46, v47
    v_exp_f32 v50, v50
    v_exp_f32 v51, v51
    v_cvt_pk_bf16_f32 v26, v48, v49
    v_cvt_pk_bf16_f32 v27, v50, v51
    s_waitcnt lgkmcnt(0)
    v_mfma_f32_32x32x16_bf16 v[36:51], v[132:135], v[4:7], 0
    v_exp_f32 v52, v52
    v_exp_f32 v53, v53
    v_exp_f32 v54, v54
    v_mfma_f32_32x32x16_bf16 v[100:115], v[172:175], v[20:23], v[100:115]
    v_exp_f32 v55, v55
    v_exp_f32 v56, v56
    v_exp_f32 v57, v57
    v_mfma_f32_32x32x16_bf16 v[100:115], v[176:179], v[24:27], v[100:115]
    v_cvt_pk_bf16_f32 v28, v52, v53
    v_exp_f32 v58, v58
    v_cvt_pk_bf16_f32 v29, v54, v55
    v_exp_f32 v59, v59
    v_cvt_pk_bf16_f32 v30, v56, v57
    v_exp_f32 v60, v60
    v_exp_f32 v61, v61
    v_cvt_pk_bf16_f32 v31, v58, v59
    v_exp_f32 v62, v62
    v_exp_f32 v63, v63
    v_cvt_pk_bf16_f32 v32, v60, v61
    v_exp_f32 v64, v64
    v_exp_f32 v65, v65
    v_cvt_pk_bf16_f32 v33, v62, v63
    v_exp_f32 v66, v66
    v_exp_f32 v67, v67
    v_cvt_pk_bf16_f32 v34, v64, v65
    v_cvt_pk_bf16_f32 v35, v66, v67
    v_mfma_f32_32x32x16_bf16 v[52:67], v[132:135], v[8:11], 0
    v_exp_f32 v36, v36
    v_exp_f32 v37, v37
    v_exp_f32 v38, v38
    v_mfma_f32_32x32x16_bf16 v[116:131], v[172:175], v[28:31], v[116:131]
    v_exp_f32 v39, v39
    v_exp_f32 v40, v40
    v_exp_f32 v41, v41
    v_mfma_f32_32x32x16_bf16 v[116:131], v[176:179], v[32:35], v[116:131]
    v_cvt_pk_bf16_f32 v20, v36, v37
    v_exp_f32 v42, v42
    v_cvt_pk_bf16_f32 v21, v38, v39
    v_exp_f32 v43, v43
    v_cvt_pk_bf16_f32 v22, v40, v41
    v_exp_f32 v44, v44
    v_exp_f32 v45, v45
    v_cvt_pk_bf16_f32 v23, v42, v43
    v_exp_f32 v46, v46
    v_exp_f32 v47, v47
    v_cvt_pk_bf16_f32 v24, v44, v45
    v_exp_f32 v48, v48
    v_exp_f32 v49, v49
    v_cvt_pk_bf16_f32 v25, v46, v47
    v_exp_f32 v50, v50
    v_exp_f32 v51, v51
    v_cvt_pk_bf16_f32 v26, v48, v49
    v_cvt_pk_bf16_f32 v27, v50, v51
    v_mfma_f32_32x32x16_bf16 v[36:51], v[132:135], v[12:15], 0
    v_exp_f32 v52, v52
    v_exp_f32 v53, v53
    v_exp_f32 v54, v54
    v_mfma_f32_32x32x16_bf16 v[68:83], v[164:167], v[20:23], v[68:83]
    v_exp_f32 v55, v55
    v_exp_f32 v56, v56
    v_exp_f32 v57, v57
    v_mfma_f32_32x32x16_bf16 v[68:83], v[168:171], v[24:27], v[68:83]
    v_cvt_pk_bf16_f32 v28, v52, v53
    v_exp_f32 v58, v58
    v_cvt_pk_bf16_f32 v29, v54, v55
    v_exp_f32 v59, v59
    ds_read_b128 v[136:139], v238 offset:3072
    v_cvt_pk_bf16_f32 v30, v56, v57
    v_exp_f32 v60, v60
    v_exp_f32 v61, v61
    s_mov_b64 exec, s[16:17]
    ds_read_b128 v[172:175], v239 offset:3072
    ds_read_b128 v[176:179], v239 offset:3584
    s_mov_b64 exec, -1
    v_cvt_pk_bf16_f32 v31, v58, v59
    v_exp_f32 v62, v62
    v_exp_f32 v63, v63
    v_cvt_pk_bf16_f32 v32, v60, v61
    v_exp_f32 v64, v64
    v_exp_f32 v65, v65
    v_cvt_pk_bf16_f32 v33, v62, v63
    v_exp_f32 v66, v66
    v_exp_f32 v67, v67
    v_cvt_pk_bf16_f32 v34, v64, v65
    v_cvt_pk_bf16_f32 v35, v66, v67
    v_mfma_f32_32x32x16_bf16 v[52:67], v[132:135], v[16:19], 0
    v_exp_f32 v36, v36
    v_exp_f32 v37, v37
    v_exp_f32 v38, v38
    v_mfma_f32_32x32x16_bf16 v[84:99], v[164:167], v[28:31], v[84:99]
    v_exp_f32 v39, v39
    v_exp_f32 v40, v40
    v_exp_f32 v41, v41
    v_mfma_f32_32x32x16_bf16 v[84:99], v[168:171], v[32:35], v[84:99]
    v_cvt_pk_bf16_f32 v20, v36, v37
    v_exp_f32 v42, v42
    v_cvt_pk_bf16_f32 v21, v38, v39
    v_exp_f32 v43, v43
    v_cvt_pk_bf16_f32 v22, v40, v41
    v_exp_f32 v44, v44
    v_exp_f32 v45, v45
    v_cvt_pk_bf16_f32 v23, v42, v43
    v_exp_f32 v46, v46
    v_exp_f32 v47, v47
    v_cvt_pk_bf16_f32 v24, v44, v45
    v_exp_f32 v48, v48
    v_exp_f32 v49, v49
    v_cvt_pk_bf16_f32 v25, v46, v47
    v_exp_f32 v50, v50
    v_exp_f32 v51, v51
    v_cvt_pk_bf16_f32 v26, v48, v49
    v_cvt_pk_bf16_f32 v27, v50, v51
    s_waitcnt lgkmcnt(0)
    v_mfma_f32_32x32x16_bf16 v[36:51], v[136:139], v[4:7], 0
    v_exp_f32 v52, v52
    v_exp_f32 v53, v53
    v_exp_f32 v54, v54
    v_mfma_f32_32x32x16_bf16 v[100:115], v[164:167], v[20:23], v[100:115]
    v_exp_f32 v55, v55
    v_exp_f32 v56, v56
    v_exp_f32 v57, v57
    v_mfma_f32_32x32x16_bf16 v[100:115], v[168:171], v[24:27], v[100:115]
    v_cvt_pk_bf16_f32 v28, v52, v53
    v_exp_f32 v58, v58
    v_cvt_pk_bf16_f32 v29, v54, v55
    v_exp_f32 v59, v59
    v_cvt_pk_bf16_f32 v30, v56, v57
    v_exp_f32 v60, v60
    v_exp_f32 v61, v61
    v_cvt_pk_bf16_f32 v31, v58, v59
    v_exp_f32 v62, v62
    v_exp_f32 v63, v63
    v_cvt_pk_bf16_f32 v32, v60, v61
    v_exp_f32 v64, v64
    v_exp_f32 v65, v65
    v_cvt_pk_bf16_f32 v33, v62, v63
    v_exp_f32 v66, v66
    v_exp_f32 v67, v67
    v_cvt_pk_bf16_f32 v34, v64, v65
    v_cvt_pk_bf16_f32 v35, v66, v67
    v_mfma_f32_32x32x16_bf16 v[52:67], v[136:139], v[8:11], 0
    v_exp_f32 v36, v36
    v_exp_f32 v37, v37
    v_exp_f32 v38, v38
    v_mfma_f32_32x32x16_bf16 v[116:131], v[164:167], v[28:31], v[116:131]
    v_exp_f32 v39, v39
    v_exp_f32 v40, v40
    v_exp_f32 v41, v41
    v_mfma_f32_32x32x16_bf16 v[116:131], v[168:171], v[32:35], v[116:131]
    v_cvt_pk_bf16_f32 v20, v36, v37
    v_exp_f32 v42, v42
    v_cvt_pk_bf16_f32 v21, v38, v39
    v_exp_f32 v43, v43
    v_cvt_pk_bf16_f32 v22, v40, v41
    v_exp_f32 v44, v44
    v_exp_f32 v45, v45
    v_cvt_pk_bf16_f32 v23, v42, v43
    v_exp_f32 v46, v46
    v_exp_f32 v47, v47
    v_cvt_pk_bf16_f32 v24, v44, v45
    v_exp_f32 v48, v48
    v_exp_f32 v49, v49
    v_cvt_pk_bf16_f32 v25, v46, v47
    v_exp_f32 v50, v50
    v_exp_f32 v51, v51
    v_cvt_pk_bf16_f32 v26, v48, v49
    v_cvt_pk_bf16_f32 v27, v50, v51
    v_mfma_f32_32x32x16_bf16 v[36:51], v[136:139], v[12:15], 0
    v_exp_f32 v52, v52
    v_exp_f32 v53, v53
    v_exp_f32 v54, v54
    v_mfma_f32_32x32x16_bf16 v[68:83], v[172:175], v[20:23], v[68:83]
    v_exp_f32 v55, v55
    v_exp_f32 v56, v56
    v_exp_f32 v57, v57
    v_mfma_f32_32x32x16_bf16 v[68:83], v[176:179], v[24:27], v[68:83]
    v_cvt_pk_bf16_f32 v28, v52, v53
    v_exp_f32 v58, v58
    v_cvt_pk_bf16_f32 v29, v54, v55
    v_exp_f32 v59, v59
    ds_read_b128 v[132:135], v238 offset:4096
    v_cvt_pk_bf16_f32 v30, v56, v57
    v_exp_f32 v60, v60
    v_exp_f32 v61, v61
    s_mov_b64 exec, s[16:17]
    ds_read_b128 v[164:167], v239 offset:4096
    ds_read_b128 v[168:171], v239 offset:4608
    s_mov_b64 exec, -1
    v_cvt_pk_bf16_f32 v31, v58, v59
    v_exp_f32 v62, v62
    v_exp_f32 v63, v63
    v_cvt_pk_bf16_f32 v32, v60, v61
    v_exp_f32 v64, v64
    v_exp_f32 v65, v65
    v_cvt_pk_bf16_f32 v33, v62, v63
    v_exp_f32 v66, v66
    v_exp_f32 v67, v67
    v_cvt_pk_bf16_f32 v34, v64, v65
    v_cvt_pk_bf16_f32 v35, v66, v67
    v_mfma_f32_32x32x16_bf16 v[52:67], v[136:139], v[16:19], 0
    v_exp_f32 v36, v36
    v_exp_f32 v37, v37
    v_exp_f32 v38, v38
    v_mfma_f32_32x32x16_bf16 v[84:99], v[172:175], v[28:31], v[84:99]
    v_exp_f32 v39, v39
    v_exp_f32 v40, v40
    v_exp_f32 v41, v41
    v_mfma_f32_32x32x16_bf16 v[84:99], v[176:179], v[32:35], v[84:99]
    v_cvt_pk_bf16_f32 v20, v36, v37
    v_exp_f32 v42, v42
    v_cvt_pk_bf16_f32 v21, v38, v39
    v_exp_f32 v43, v43
    v_cvt_pk_bf16_f32 v22, v40, v41
    v_exp_f32 v44, v44
    v_exp_f32 v45, v45
    v_cvt_pk_bf16_f32 v23, v42, v43
    v_exp_f32 v46, v46
    v_exp_f32 v47, v47
    v_cvt_pk_bf16_f32 v24, v44, v45
    v_exp_f32 v48, v48
    v_add_u32 v238, 4096, v238
    v_exp_f32 v49, v49
    v_cvt_pk_bf16_f32 v25, v46, v47
    v_exp_f32 v50, v50
    v_add_u32 v239, 4096, v239
    v_exp_f32 v51, v51
    v_cvt_pk_bf16_f32 v26, v48, v49
    v_cvt_pk_bf16_f32 v27, v50, v51
    s_waitcnt lgkmcnt(0)
    v_mfma_f32_32x32x16_bf16 v[36:51], v[132:135], v[4:7], 0
    v_exp_f32 v52, v52
    v_exp_f32 v53, v53
    v_exp_f32 v54, v54
    v_mfma_f32_32x32x16_bf16 v[100:115], v[172:175], v[20:23], v[100:115]
    v_exp_f32 v55, v55
    v_exp_f32 v56, v56
    v_exp_f32 v57, v57
    v_mfma_f32_32x32x16_bf16 v[100:115], v[176:179], v[24:27], v[100:115]
    v_cvt_pk_bf16_f32 v28, v52, v53
    v_exp_f32 v58, v58
    v_cvt_pk_bf16_f32 v29, v54, v55
    v_exp_f32 v59, v59
    v_cvt_pk_bf16_f32 v30, v56, v57
    v_exp_f32 v60, v60
    v_exp_f32 v61, v61
    v_cvt_pk_bf16_f32 v31, v58, v59
    v_exp_f32 v62, v62
    v_exp_f32 v63, v63
    v_cvt_pk_bf16_f32 v32, v60, v61
    v_exp_f32 v64, v64
    s_sub_u32 s8, s8, 1
    v_exp_f32 v65, v65
    v_cvt_pk_bf16_f32 v33, v62, v63
    v_exp_f32 v66, v66
    s_cmp_lg_u32 s8, 0
    v_exp_f32 v67, v67
    v_cvt_pk_bf16_f32 v34, v64, v65
    v_cvt_pk_bf16_f32 v35, v66, v67
    s_cbranch_scc1 parallel_sum__mha_block__glu_gated_geglu__prompt_kernel_loop
    v_mfma_f32_32x32x16_bf16 v[52:67], v[132:135], v[8:11], 0
    v_exp_f32 v36, v36
    v_exp_f32 v37, v37
    v_exp_f32 v38, v38
    v_mfma_f32_32x32x16_bf16 v[116:131], v[172:175], v[28:31], v[116:131]
    v_exp_f32 v39, v39
    v_exp_f32 v40, v40
    v_exp_f32 v41, v41
    v_mfma_f32_32x32x16_bf16 v[116:131], v[176:179], v[32:35], v[116:131]
    v_cvt_pk_bf16_f32 v20, v36, v37
    v_exp_f32 v42, v42
    v_cvt_pk_bf16_f32 v21, v38, v39
    v_exp_f32 v43, v43
    v_cvt_pk_bf16_f32 v22, v40, v41
    v_exp_f32 v44, v44
    v_exp_f32 v45, v45
    v_cvt_pk_bf16_f32 v23, v42, v43
    v_exp_f32 v46, v46
    v_exp_f32 v47, v47
    v_cvt_pk_bf16_f32 v24, v44, v45
    v_exp_f32 v48, v48
    v_exp_f32 v49, v49
    v_cvt_pk_bf16_f32 v25, v46, v47
    v_exp_f32 v50, v50
    v_exp_f32 v51, v51
    v_cvt_pk_bf16_f32 v26, v48, v49
    v_cvt_pk_bf16_f32 v27, v50, v51
    v_mfma_f32_32x32x16_bf16 v[36:51], v[132:135], v[12:15], 0
    v_exp_f32 v52, v52
    v_exp_f32 v53, v53
    v_exp_f32 v54, v54
    v_mfma_f32_32x32x16_bf16 v[68:83], v[164:167], v[20:23], v[68:83]
    v_exp_f32 v55, v55
    v_exp_f32 v56, v56
    v_exp_f32 v57, v57
    v_mfma_f32_32x32x16_bf16 v[68:83], v[168:171], v[24:27], v[68:83]
    v_cvt_pk_bf16_f32 v28, v52, v53
    v_exp_f32 v58, v58
    v_cvt_pk_bf16_f32 v29, v54, v55
    v_exp_f32 v59, v59
    ds_read_b128 v[136:139], v238 offset:1024
    v_cvt_pk_bf16_f32 v30, v56, v57
    v_exp_f32 v60, v60
    v_exp_f32 v61, v61
    s_mov_b64 exec, s[16:17]
    ds_read_b128 v[172:175], v239 offset:1024
    ds_read_b128 v[176:179], v239 offset:1536
    s_mov_b64 exec, -1
    v_cvt_pk_bf16_f32 v31, v58, v59
    v_exp_f32 v62, v62
    v_exp_f32 v63, v63
    v_cvt_pk_bf16_f32 v32, v60, v61
    v_exp_f32 v64, v64
    v_exp_f32 v65, v65
    v_cvt_pk_bf16_f32 v33, v62, v63
    v_exp_f32 v66, v66
    v_exp_f32 v67, v67
    v_cvt_pk_bf16_f32 v34, v64, v65
    v_cvt_pk_bf16_f32 v35, v66, v67
    v_mfma_f32_32x32x16_bf16 v[52:67], v[132:135], v[16:19], 0
    v_exp_f32 v36, v36
    v_exp_f32 v37, v37
    v_exp_f32 v38, v38
    v_mfma_f32_32x32x16_bf16 v[84:99], v[164:167], v[28:31], v[84:99]
    v_exp_f32 v39, v39
    v_exp_f32 v40, v40
    v_exp_f32 v41, v41
    v_mfma_f32_32x32x16_bf16 v[84:99], v[168:171], v[32:35], v[84:99]
    v_cvt_pk_bf16_f32 v20, v36, v37
    v_exp_f32 v42, v42
    v_cvt_pk_bf16_f32 v21, v38, v39
    v_exp_f32 v43, v43
    v_cvt_pk_bf16_f32 v22, v40, v41
    v_exp_f32 v44, v44
    v_exp_f32 v45, v45
    v_cvt_pk_bf16_f32 v23, v42, v43
    v_exp_f32 v46, v46
    v_exp_f32 v47, v47
    v_cvt_pk_bf16_f32 v24, v44, v45
    v_exp_f32 v48, v48
    v_exp_f32 v49, v49
    v_cvt_pk_bf16_f32 v25, v46, v47
    v_exp_f32 v50, v50
    v_exp_f32 v51, v51
    v_cvt_pk_bf16_f32 v26, v48, v49
    v_cvt_pk_bf16_f32 v27, v50, v51
    s_waitcnt lgkmcnt(0)
    v_mfma_f32_32x32x16_bf16 v[36:51], v[136:139], v[4:7], 0
    v_exp_f32 v52, v52
    v_exp_f32 v53, v53
    v_exp_f32 v54, v54
    v_mfma_f32_32x32x16_bf16 v[100:115], v[164:167], v[20:23], v[100:115]
    v_exp_f32 v55, v55
    v_exp_f32 v56, v56
    v_exp_f32 v57, v57
    v_mfma_f32_32x32x16_bf16 v[100:115], v[168:171], v[24:27], v[100:115]
    v_cvt_pk_bf16_f32 v28, v52, v53
    v_exp_f32 v58, v58
    v_cvt_pk_bf16_f32 v29, v54, v55
    v_exp_f32 v59, v59
    v_cvt_pk_bf16_f32 v30, v56, v57
    v_exp_f32 v60, v60
    v_exp_f32 v61, v61
    v_cvt_pk_bf16_f32 v31, v58, v59
    v_exp_f32 v62, v62
    v_exp_f32 v63, v63
    v_cvt_pk_bf16_f32 v32, v60, v61
    v_exp_f32 v64, v64
    v_exp_f32 v65, v65
    v_cvt_pk_bf16_f32 v33, v62, v63
    v_exp_f32 v66, v66
    v_exp_f32 v67, v67
    v_cvt_pk_bf16_f32 v34, v64, v65
    v_cvt_pk_bf16_f32 v35, v66, v67
    v_mfma_f32_32x32x16_bf16 v[52:67], v[136:139], v[8:11], 0
    v_exp_f32 v36, v36
    v_exp_f32 v37, v37
    v_exp_f32 v38, v38
    v_mfma_f32_32x32x16_bf16 v[116:131], v[164:167], v[28:31], v[116:131]
    v_exp_f32 v39, v39
    v_exp_f32 v40, v40
    v_exp_f32 v41, v41
    v_mfma_f32_32x32x16_bf16 v[116:131], v[168:171], v[32:35], v[116:131]
    v_cvt_pk_bf16_f32 v20, v36, v37
    v_exp_f32 v42, v42
    v_cvt_pk_bf16_f32 v21, v38, v39
    v_exp_f32 v43, v43
    v_cvt_pk_bf16_f32 v22, v40, v41
    v_exp_f32 v44, v44
    v_exp_f32 v45, v45
    v_cvt_pk_bf16_f32 v23, v42, v43
    v_exp_f32 v46, v46
    v_exp_f32 v47, v47
    v_cvt_pk_bf16_f32 v24, v44, v45
    v_exp_f32 v48, v48
    v_exp_f32 v49, v49
    v_cvt_pk_bf16_f32 v25, v46, v47
    v_exp_f32 v50, v50
    v_exp_f32 v51, v51
    v_cvt_pk_bf16_f32 v26, v48, v49
    v_cvt_pk_bf16_f32 v27, v50, v51
    v_mfma_f32_32x32x16_bf16 v[36:51], v[136:139], v[12:15], 0
    v_exp_f32 v52, v52
    v_exp_f32 v53, v53
    v_exp_f32 v54, v54
    v_mfma_f32_32x32x16_bf16 v[68:83], v[172:175], v[20:23], v[68:83]
    v_exp_f32 v55, v55
    v_exp_f32 v56, v56
    v_exp_f32 v57, v57
    v_mfma_f32_32x32x16_bf16 v[68:83], v[176:179], v[24:27], v[68:83]
    v_cvt_pk_bf16_f32 v28, v52, v53
    v_exp_f32 v58, v58
    v_cvt_pk_bf16_f32 v29, v54, v55
    v_exp_f32 v59, v59
    ds_read_b128 v[132:135], v238 offset:2048
    v_cvt_pk_bf16_f32 v30, v56, v57
    v_exp_f32 v60, v60
    v_exp_f32 v61, v61
    s_mov_b64 exec, s[16:17]
    ds_read_b128 v[164:167], v239 offset:2048
    ds_read_b128 v[168:171], v239 offset:2560
    s_mov_b64 exec, -1
    v_cvt_pk_bf16_f32 v31, v58, v59
    v_exp_f32 v62, v62
    v_exp_f32 v63, v63
    v_cvt_pk_bf16_f32 v32, v60, v61
    v_exp_f32 v64, v64
    v_exp_f32 v65, v65
    v_cvt_pk_bf16_f32 v33, v62, v63
    v_exp_f32 v66, v66
    v_exp_f32 v67, v67
    v_cvt_pk_bf16_f32 v34, v64, v65
    v_cvt_pk_bf16_f32 v35, v66, v67
    v_mfma_f32_32x32x16_bf16 v[52:67], v[136:139], v[16:19], 0
    v_exp_f32 v36, v36
    v_exp_f32 v37, v37
    v_exp_f32 v38, v38
    v_mfma_f32_32x32x16_bf16 v[84:99], v[172:175], v[28:31], v[84:99]
    v_exp_f32 v39, v39
    v_exp_f32 v40, v40
    v_exp_f32 v41, v41
    v_mfma_f32_32x32x16_bf16 v[84:99], v[176:179], v[32:35], v[84:99]
    v_cvt_pk_bf16_f32 v20, v36, v37
    v_exp_f32 v42, v42
    v_cvt_pk_bf16_f32 v21, v38, v39
    v_exp_f32 v43, v43
    v_cvt_pk_bf16_f32 v22, v40, v41
    v_exp_f32 v44, v44
    v_exp_f32 v45, v45
    v_cvt_pk_bf16_f32 v23, v42, v43
    v_exp_f32 v46, v46
    v_exp_f32 v47, v47
    v_cvt_pk_bf16_f32 v24, v44, v45
    v_exp_f32 v48, v48
    v_exp_f32 v49, v49
    v_cvt_pk_bf16_f32 v25, v46, v47
    v_exp_f32 v50, v50
    v_exp_f32 v51, v51
    v_cvt_pk_bf16_f32 v26, v48, v49
    v_cvt_pk_bf16_f32 v27, v50, v51
    s_waitcnt lgkmcnt(0)
    v_mfma_f32_32x32x16_bf16 v[36:51], v[132:135], v[4:7], 0
    v_exp_f32 v52, v52
    v_exp_f32 v53, v53
    v_exp_f32 v54, v54
    v_mfma_f32_32x32x16_bf16 v[100:115], v[172:175], v[20:23], v[100:115]
    v_exp_f32 v55, v55
    v_exp_f32 v56, v56
    v_exp_f32 v57, v57
    v_mfma_f32_32x32x16_bf16 v[100:115], v[176:179], v[24:27], v[100:115]
    v_cvt_pk_bf16_f32 v28, v52, v53
    v_exp_f32 v58, v58
    v_cvt_pk_bf16_f32 v29, v54, v55
    v_exp_f32 v59, v59
    v_cvt_pk_bf16_f32 v30, v56, v57
    v_exp_f32 v60, v60
    v_exp_f32 v61, v61
    v_cvt_pk_bf16_f32 v31, v58, v59
    v_exp_f32 v62, v62
    v_exp_f32 v63, v63
    v_cvt_pk_bf16_f32 v32, v60, v61
    v_exp_f32 v64, v64
    v_exp_f32 v65, v65
    v_cvt_pk_bf16_f32 v33, v62, v63
    v_exp_f32 v66, v66
    v_exp_f32 v67, v67
    v_cvt_pk_bf16_f32 v34, v64, v65
    v_cvt_pk_bf16_f32 v35, v66, v67
    v_mfma_f32_32x32x16_bf16 v[52:67], v[132:135], v[8:11], 0
    v_exp_f32 v36, v36
    v_exp_f32 v37, v37
    v_exp_f32 v38, v38
    v_mfma_f32_32x32x16_bf16 v[116:131], v[172:175], v[28:31], v[116:131]
    v_exp_f32 v39, v39
    v_exp_f32 v40, v40
    v_exp_f32 v41, v41
    v_mfma_f32_32x32x16_bf16 v[116:131], v[176:179], v[32:35], v[116:131]
    v_cvt_pk_bf16_f32 v20, v36, v37
    v_exp_f32 v42, v42
    v_cvt_pk_bf16_f32 v21, v38, v39
    v_exp_f32 v43, v43
    v_cvt_pk_bf16_f32 v22, v40, v41
    v_exp_f32 v44, v44
    v_exp_f32 v45, v45
    v_cvt_pk_bf16_f32 v23, v42, v43
    v_exp_f32 v46, v46
    v_exp_f32 v47, v47
    v_cvt_pk_bf16_f32 v24, v44, v45
    v_exp_f32 v48, v48
    v_exp_f32 v49, v49
    v_cvt_pk_bf16_f32 v25, v46, v47
    v_exp_f32 v50, v50
    v_exp_f32 v51, v51
    v_cvt_pk_bf16_f32 v26, v48, v49
    v_cvt_pk_bf16_f32 v27, v50, v51
    v_mfma_f32_32x32x16_bf16 v[36:51], v[132:135], v[12:15], 0
    v_exp_f32 v52, v52
    v_exp_f32 v53, v53
    v_exp_f32 v54, v54
    v_mfma_f32_32x32x16_bf16 v[68:83], v[164:167], v[20:23], v[68:83]
    v_exp_f32 v55, v55
    v_exp_f32 v56, v56
    v_exp_f32 v57, v57
    v_mfma_f32_32x32x16_bf16 v[68:83], v[168:171], v[24:27], v[68:83]
    v_cvt_pk_bf16_f32 v28, v52, v53
    v_exp_f32 v58, v58
    v_cvt_pk_bf16_f32 v29, v54, v55
    v_exp_f32 v59, v59
    ds_read_b128 v[136:139], v238 offset:3072
    v_cvt_pk_bf16_f32 v30, v56, v57
    v_exp_f32 v60, v60
    v_exp_f32 v61, v61
    s_mov_b64 exec, s[16:17]
    ds_read_b128 v[172:175], v239 offset:3072
    ds_read_b128 v[176:179], v239 offset:3584
    s_mov_b64 exec, -1
    v_cvt_pk_bf16_f32 v31, v58, v59
    v_exp_f32 v62, v62
    v_exp_f32 v63, v63
    v_cvt_pk_bf16_f32 v32, v60, v61
    v_exp_f32 v64, v64
    v_exp_f32 v65, v65
    v_cvt_pk_bf16_f32 v33, v62, v63
    v_exp_f32 v66, v66
    v_exp_f32 v67, v67
    v_cvt_pk_bf16_f32 v34, v64, v65
    v_cvt_pk_bf16_f32 v35, v66, v67
    v_mfma_f32_32x32x16_bf16 v[52:67], v[132:135], v[16:19], 0
    v_exp_f32 v36, v36
    v_exp_f32 v37, v37
    v_exp_f32 v38, v38
    v_mfma_f32_32x32x16_bf16 v[84:99], v[164:167], v[28:31], v[84:99]
    v_exp_f32 v39, v39
    v_exp_f32 v40, v40
    v_exp_f32 v41, v41
    v_mfma_f32_32x32x16_bf16 v[84:99], v[168:171], v[32:35], v[84:99]
    v_cvt_pk_bf16_f32 v20, v36, v37
    v_exp_f32 v42, v42
    v_cvt_pk_bf16_f32 v21, v38, v39
    v_exp_f32 v43, v43
    v_cvt_pk_bf16_f32 v22, v40, v41
    v_exp_f32 v44, v44
    v_exp_f32 v45, v45
    v_cvt_pk_bf16_f32 v23, v42, v43
    v_exp_f32 v46, v46
    v_exp_f32 v47, v47
    v_cvt_pk_bf16_f32 v24, v44, v45
    v_exp_f32 v48, v48
    v_exp_f32 v49, v49
    v_cvt_pk_bf16_f32 v25, v46, v47
    v_exp_f32 v50, v50
    v_exp_f32 v51, v51
    v_cvt_pk_bf16_f32 v26, v48, v49
    v_cvt_pk_bf16_f32 v27, v50, v51
    v_mov_b32 v228, 161024
    s_mov_b32 s59, 200000
parallel_sum__mha_block__glu_gated_geglu__prompt_kernel_gw:
    ds_read_b128 v[232:235], v228
    s_sub_u32 s59, s59, 1
    s_cmp_eq_u32 s59, 0
    s_waitcnt lgkmcnt(0)
    s_cbranch_scc1 parallel_sum__mha_block__glu_gated_geglu__prompt_kernel_gwx
    v_min3_u32 v232, v232, v233, v234
    v_min_u32 v232, v232, v235
    s_nop 0
    v_readfirstlane_b32 s58, v232
    s_nop 1
    s_cmp_le_u32 s58, 14
    s_cbranch_scc1 parallel_sum__mha_block__glu_gated_geglu__prompt_kernel_gw
parallel_sum__mha_block__glu_gated_geglu__prompt_kernel_gwx:
    v_mfma_f32_32x32x16_bf16 v[36:51], v[136:139], v[4:7], 0
    v_exp_f32 v52, v52
    v_exp_f32 v53, v53
    v_exp_f32 v54, v54
    v_mfma_f32_32x32x16_bf16 v[100:115], v[164:167], v[20:23], v[100:115]
    v_exp_f32 v55, v55
    v_exp_f32 v56, v56
    v_exp_f32 v57, v57
    v_mfma_f32_32x32x16_bf16 v[100:115], v[168:171], v[24:27], v[100:115]
    v_cvt_pk_bf16_f32 v28, v52, v53
    v_exp_f32 v58, v58
    v_cvt_pk_bf16_f32 v29, v54, v55
    v_exp_f32 v59, v59
    v_cvt_pk_bf16_f32 v30, v56, v57
    v_exp_f32 v60, v60
    v_exp_f32 v61, v61
    v_cvt_pk_bf16_f32 v31, v58, v59
    v_exp_f32 v62, v62
    v_exp_f32 v63, v63
    v_cvt_pk_bf16_f32 v32, v60, v61
    v_exp_f32 v64, v64
    v_exp_f32 v65, v65
    v_cvt_pk_bf16_f32 v33, v62, v63
    v_exp_f32 v66, v66
    v_exp_f32 v67, v67
    v_cvt_pk_bf16_f32 v34, v64, v65
    v_cvt_pk_bf16_f32 v35, v66, v67
    v_mfma_f32_32x32x16_bf16 v[52:67], v[136:139], v[8:11], 0
    v_exp_f32 v36, v36
    v_exp_f32 v37, v37
    v_exp_f32 v38, v38
    v_mfma_f32_32x32x16_bf16 v[116:131], v[164:167], v[28:31], v[116:131]
    v_exp_f32 v39, v39
    v_exp_f32 v40, v40
    v_exp_f32 v41, v41
    v_mfma_f32_32x32x16_bf16 v[116:131], v[168:171], v[32:35], v[116:131]
    v_cvt_pk_bf16_f32 v20, v36, v37
    v_exp_f32 v42, v42
    v_cvt_pk_bf16_f32 v21, v38, v39
    v_exp_f32 v43, v43
    s_mul_i32 s56, s52, 4608
    v_cvt_pk_bf16_f32 v22, v40, v41
    v_exp_f32 v44, v44
    v_exp_f32 v45, v45
    s_add_u32 s56, s56, 142080
    s_xor_b32 s58, s52, 2
    s_mul_i32 s57, s58, 4608
    s_add_u32 s57, s57, 142080
    v_add_u32 v228, s56, v1
    v_lshrrev_b32 v229, 2, v1
    v_add_u32 v230, s57, v229
    v_add_u32 v229, s56, v229
    s_lshl_b32 s56, s52, 2
    s_add_u32 s56, s56, 161040
    s_lshl_b32 s58, s58, 2
    s_add_u32 s58, s58, 161040
    v_mov_b32 v232, s56
    v_mov_b32 v234, s58
    v_add_u32 v231, s57, v1
    v_cvt_pk_bf16_f32 v23, v42, v43
    v_exp_f32 v46, v46
    v_exp_f32 v47, v47
    v_cvt_pk_bf16_f32 v24, v44, v45
    v_exp_f32 v48, v48
    v_exp_f32 v49, v49
    v_cvt_pk_bf16_f32 v25, v46, v47
    v_exp_f32 v50, v50
    v_exp_f32 v51, v51
    v_cvt_pk_bf16_f32 v26, v48, v49
    v_cvt_pk_bf16_f32 v27, v50, v51
    v_mfma_f32_32x32x16_bf16 v[36:51], v[136:139], v[12:15], 0
    v_exp_f32 v52, v52
    v_exp_f32 v53, v53
    v_exp_f32 v54, v54
    v_mfma_f32_32x32x16_bf16 v[68:83], v[172:175], v[20:23], v[68:83]
    v_exp_f32 v55, v55
    v_exp_f32 v56, v56
    v_exp_f32 v57, v57
    v_mfma_f32_32x32x16_bf16 v[68:83], v[176:179], v[24:27], v[68:83]
    v_cvt_pk_bf16_f32 v28, v52, v53
    v_exp_f32 v58, v58
    v_cvt_pk_bf16_f32 v29, v54, v55
    v_exp_f32 v59, v59
    s_lshl_b32 s96, s11, 5
    v_cvt_pk_bf16_f32 v30, v56, v57
    v_exp_f32 v60, v60
    v_exp_f32 v61, v61
    s_add_u32 s96, s96, s67
    s_lshl_b32 s96, s96, 10
    s_add_u32 s96, s96, 6291456
    s_add_u32 s97, s96, 32768
    s_lshr_b32 s98, s11, 1
    s_lshl_b32 s98, s98, 5
    s_add_u32 s98, s98, s67
    s_lshl_b32 s98, s98, 8
    s_add_u32 s98, s98, 15859712
    s_mov_b32 s56, 0x2b800000
    s_mov_b32 s57, 0x53800000
    s_mov_b32 s59, 200000
    v_cvt_pk_bf16_f32 v31, v58, v59
    v_exp_f32 v62, v62
    v_exp_f32 v63, v63
    v_cvt_pk_bf16_f32 v32, v60, v61
    v_exp_f32 v64, v64
    v_exp_f32 v65, v65
    v_cvt_pk_bf16_f32 v33, v62, v63
    v_exp_f32 v66, v66
    v_exp_f32 v67, v67
    v_cvt_pk_bf16_f32 v34, v64, v65
    v_cvt_pk_bf16_f32 v35, v66, v67
    v_mfma_f32_32x32x16_bf16 v[52:67], v[136:139], v[16:19], 0
    v_exp_f32 v36, v36
    v_exp_f32 v37, v37
    v_exp_f32 v38, v38
    v_mfma_f32_32x32x16_bf16 v[84:99], v[172:175], v[28:31], v[84:99]
    v_exp_f32 v39, v39
    v_exp_f32 v40, v40
    v_exp_f32 v41, v41
    v_mfma_f32_32x32x16_bf16 v[84:99], v[176:179], v[32:35], v[84:99]
    v_cvt_pk_bf16_f32 v20, v36, v37
    v_exp_f32 v42, v42
    v_cvt_pk_bf16_f32 v21, v38, v39
    v_exp_f32 v43, v43
    ds_write_b128 v228, v[68:71] offset:0
    v_cvt_pk_bf16_f32 v22, v40, v41
    v_exp_f32 v44, v44
    v_exp_f32 v45, v45
    ds_write_b128 v228, v[72:75] offset:1024
    ds_write_b32 v229, v76 offset:2048
    v_cvt_pk_bf16_f32 v23, v42, v43
    v_exp_f32 v46, v46
    v_exp_f32 v47, v47
    v_cvt_pk_bf16_f32 v24, v44, v45
    v_exp_f32 v48, v48
    v_exp_f32 v49, v49
    v_cvt_pk_bf16_f32 v25, v46, v47
    v_exp_f32 v50, v50
    v_exp_f32 v51, v51
    v_cvt_pk_bf16_f32 v26, v48, v49
    v_cvt_pk_bf16_f32 v27, v50, v51
    v_exp_f32 v52, v52
    v_exp_f32 v53, v53
    v_exp_f32 v54, v54
    v_mfma_f32_32x32x16_bf16 v[100:115], v[172:175], v[20:23], v[100:115]
    v_exp_f32 v55, v55
    v_exp_f32 v56, v56
    v_exp_f32 v57, v57
    v_mfma_f32_32x32x16_bf16 v[100:115], v[176:179], v[24:27], v[100:115]
    v_cvt_pk_bf16_f32 v28, v52, v53
    v_exp_f32 v58, v58
    v_cvt_pk_bf16_f32 v29, v54, v55
    v_exp_f32 v59, v59
    ds_write_b128 v228, v[84:87] offset:2304
    v_cvt_pk_bf16_f32 v30, v56, v57
    v_exp_f32 v60, v60
    v_exp_f32 v61, v61
    ds_write_b128 v228, v[88:91] offset:3328
    ds_write_b32 v229, v92 offset:4352
    v_cvt_pk_bf16_f32 v31, v58, v59
    v_exp_f32 v62, v62
    v_exp_f32 v63, v63
    v_cvt_pk_bf16_f32 v32, v60, v61
    v_exp_f32 v64, v64
    v_exp_f32 v65, v65
    v_cvt_pk_bf16_f32 v33, v62, v63
    v_exp_f32 v66, v66
    v_exp_f32 v67, v67
    v_cvt_pk_bf16_f32 v34, v64, v65
    v_cvt_pk_bf16_f32 v35, v66, v67
    ds_write_b32 v232, v232
    v_mfma_f32_32x32x16_bf16 v[116:131], v[172:175], v[28:31], v[116:131]
    v_mfma_f32_32x32x16_bf16 v[116:131], v[176:179], v[32:35], v[116:131]
    s_setprio 3
parallel_sum__mha_block__glu_gated_geglu__prompt_kernel_cw:
    ds_read_b32 v233, v234
    ds_read_b128 v[36:39], v231 offset:0
    ds_read_b128 v[40:43], v231 offset:1024
    ds_read_b32 v44, v230 offset:2048
    ds_read_b128 v[52:55], v231 offset:2304
    ds_read_b128 v[56:59], v231 offset:3328
    ds_read_b32 v60, v230 offset:4352
    s_sub_u32 s59, s59, 1
    s_cmp_eq_u32 s59, 0
    s_waitcnt lgkmcnt(6)
    s_cbranch_scc1 parallel_sum__mha_block__glu_gated_geglu__prompt_kernel_cx
    v_readfirstlane_b32 s58, v233
    s_nop 1
    s_cmp_eq_u32 s58, 0
    s_cbranch_scc1 parallel_sum__mha_block__glu_gated_geglu__prompt_kernel_cw2
parallel_sum__mha_block__glu_gated_geglu__prompt_kernel_cx:
    s_waitcnt vmcnt(0) lgkmcnt(0)
    v_add_f32 v108, v108, v44
    v_add_f32 v124, v124, v60
    v_cmp_le_f32 s[18:19], s56, v108
    v_cmp_ge_f32 s[12:13], s57, v108
    v_cmp_le_f32 s[14:15], s56, v124
    v_cmp_ge_f32 vcc, s57, v124
    v_add_f32 v100, v100, v36
    v_add_f32 v101, v101, v37
    v_add_f32 v102, v102, v38
    v_add_f32 v103, v103, v39
    v_add_f32 v104, v104, v40
    v_add_f32 v105, v105, v41
    v_add_f32 v106, v106, v42
    v_add_f32 v107, v107, v43
    v_add_f32 v116, v116, v52
    v_add_f32 v117, v117, v53
    v_add_f32 v118, v118, v54
    v_add_f32 v119, v119, v55
    v_add_f32 v120, v120, v56
    v_add_f32 v121, v121, v57
    v_add_f32 v122, v122, v58
    v_add_f32 v123, v123, v59
    s_and_b64 s[18:19], s[18:19], s[12:13]
    s_and_b64 s[14:15], s[14:15], vcc
    s_and_b64 s[18:19], s[18:19], s[14:15]
    s_cmp_eq_u64 s[18:19], -1
    s_cbranch_scc1 parallel_sum__mha_block__glu_gated_geglu__prompt_kernel_fin
    s_lshl_b32 s6, s67, 16
    s_add_u32 s7, s6, 4194304
    s_add_u32 s6, s6, 2097152
    s_mov_b32 s8, 64
    v_mov_b32 v100, 0
    v_mov_b32 v101, 0
    v_mov_b32 v102, 0
    v_mov_b32 v103, 0
    v_mov_b32 v104, 0
    v_mov_b32 v105, 0
    v_mov_b32 v106, 0
    v_mov_b32 v107, 0
    v_mov_b32 v108, 0
    v_mov_b32 v109, 0
    v_mov_b32 v110, 0
    v_mov_b32 v111, 0
    v_mov_b32 v112, 0
    v_mov_b32 v113, 0
    v_mov_b32 v114, 0
    v_mov_b32 v115, 0
    v_mov_b32 v228, 0xff61b1e6
parallel_sum__mha_block__glu_gated_geglu__prompt_kernel_slow0:
    buffer_load_dwordx4 v[132:135], v1, s[36:39], s6 offen offset:0 sc1
    s_mov_b64 exec, s[16:17]
    buffer_load_dwordx4 v[164:167], v2, s[36:39], s7 offen offset:0 sc1
    buffer_load_dwordx4 v[168:171], v2, s[36:39], s7 offen offset:512 sc1
    s_mov_b64 exec, -1
    s_add_u32 s6, s6, 1024
    s_add_u32 s7, s7, 1024
    s_waitcnt vmcnt(0)
    v_mfma_f32_32x32x16_bf16 v[36:51], v[132:135], v[12:15], 0
    s_nop 11
    v_max3_f32 v229, v36, v37, v228
    v_max3_f32 v229, v38, v39, v229
    v_max3_f32 v229, v40, v41, v229
    v_max3_f32 v229, v42, v43, v229
    v_max3_f32 v229, v44, v45, v229
    v_max3_f32 v229, v46, v47, v229
    v_max3_f32 v229, v48, v49, v229
    v_max3_f32 v229, v50, v51, v229
    v_mov_b32 v230, v229
    s_nop 1
    v_permlane32_swap_b32 v229, v230
    v_max_f32 v229, v229, v230
    v_sub_f32 v230, v228, v229
    v_exp_f32 v230, v230
    v_mov_b32 v228, v229
    v_mul_f32 v100, v230, v100
    v_mul_f32 v101, v230, v101
    v_mul_f32 v102, v230, v102
    v_mul_f32 v103, v230, v103
    v_mul_f32 v104, v230, v104
    v_mul_f32 v105, v230, v105
    v_mul_f32 v106, v230, v106
    v_mul_f32 v107, v230, v107
    v_mul_f32 v108, v230, v108
    v_mul_f32 v109, v230, v109
    v_mul_f32 v110, v230, v110
    v_mul_f32 v111, v230, v111
    v_mul_f32 v112, v230, v112
    v_mul_f32 v113, v230, v113
    v_mul_f32 v114, v230, v114
    v_mul_f32 v115, v230, v115
    v_sub_f32 v36, v36, v228
    v_sub_f32 v37, v37, v228
    v_sub_f32 v38, v38, v228
    v_sub_f32 v39, v39, v228
    v_sub_f32 v40, v40, v228
    v_sub_f32 v41, v41, v228
    v_sub_f32 v42, v42, v228
    v_sub_f32 v43, v43, v228
    v_sub_f32 v44, v44, v228
    v_sub_f32 v45, v45, v228
    v_sub_f32 v46, v46, v228
    v_sub_f32 v47, v47, v228
    v_sub_f32 v48, v48, v228
    v_sub_f32 v49, v49, v228
    v_sub_f32 v50, v50, v228
    v_sub_f32 v51, v51, v228
    v_exp_f32 v36, v36
    v_exp_f32 v37, v37
    v_exp_f32 v38, v38
    v_exp_f32 v39, v39
    v_exp_f32 v40, v40
    v_exp_f32 v41, v41
    v_exp_f32 v42, v42
    v_exp_f32 v43, v43
    v_exp_f32 v44, v44
    v_exp_f32 v45, v45
    v_exp_f32 v46, v46
    v_exp_f32 v47, v47
    v_exp_f32 v48, v48
    v_exp_f32 v49, v49
    v_exp_f32 v50, v50
    v_exp_f32 v51, v51
    v_cvt_pk_bf16_f32 v20, v36, v37
    v_cvt_pk_bf16_f32 v21, v38, v39
    v_cvt_pk_bf16_f32 v22, v40, v41
    v_cvt_pk_bf16_f32 v23, v42, v43
    v_cvt_pk_bf16_f32 v24, v44, v45
    v_cvt_pk_bf16_f32 v25, v46, v47
    v_cvt_pk_bf16_f32 v26, v48, v49
    v_cvt_pk_bf16_f32 v27, v50, v51
    v_mfma_f32_32x32x16_bf16 v[100:115], v[164:167], v[20:23], v[100:115]
    s_nop 0
    v_mfma_f32_32x32x16_bf16 v[100:115], v[168:171], v[24:27], v[100:115]
    s_sub_u32 s8, s8, 1
    s_cmp_lg_u32 s8, 0
    s_cbranch_scc1 parallel_sum__mha_block__glu_gated_geglu__prompt_kernel_slow0
    s_nop 15
    s_lshl_b32 s6, s67, 16
    s_add_u32 s7, s6, 4194304
    s_add_u32 s6, s6, 2097152
    s_mov_b32 s8, 64
    v_mov_b32 v116, 0
    v_mov_b32 v117, 0
    v_mov_b32 v118, 0
    v_mov_b32 v119, 0
    v_mov_b32 v120, 0
    v_mov_b32 v121, 0
    v_mov_b32 v122, 0
    v_mov_b32 v123, 0
    v_mov_b32 v124, 0
    v_mov_b32 v125, 0
    v_mov_b32 v126, 0
    v_mov_b32 v127, 0
    v_mov_b32 v128, 0
    v_mov_b32 v129, 0
    v_mov_b32 v130, 0
    v_mov_b32 v131, 0
    v_mov_b32 v228, 0xff61b1e6
parallel_sum__mha_block__glu_gated_geglu__prompt_kernel_slow1:
    buffer_load_dwordx4 v[132:135], v1, s[36:39], s6 offen offset:0 sc1
    s_mov_b64 exec, s[16:17]
    buffer_load_dwordx4 v[164:167], v2, s[36:39], s7 offen offset:0 sc1
    buffer_load_dwordx4 v[168:171], v2, s[36:39], s7 offen offset:512 sc1
    s_mov_b64 exec, -1
    s_add_u32 s6, s6, 1024
    s_add_u32 s7, s7, 1024
    s_waitcnt vmcnt(0)
    v_mfma_f32_32x32x16_bf16 v[36:51], v[132:135], v[16:19], 0
    s_nop 11
    v_max3_f32 v229, v36, v37, v228
    v_max3_f32 v229, v38, v39, v229
    v_max3_f32 v229, v40, v41, v229
    v_max3_f32 v229, v42, v43, v229
    v_max3_f32 v229, v44, v45, v229
    v_max3_f32 v229, v46, v47, v229
    v_max3_f32 v229, v48, v49, v229
    v_max3_f32 v229, v50, v51, v229
    v_mov_b32 v230, v229
    s_nop 1
    v_permlane32_swap_b32 v229, v230
    v_max_f32 v229, v229, v230
    v_sub_f32 v230, v228, v229
    v_exp_f32 v230, v230
    v_mov_b32 v228, v229
    v_mul_f32 v116, v230, v116
    v_mul_f32 v117, v230, v117
    v_mul_f32 v118, v230, v118
    v_mul_f32 v119, v230, v119
    v_mul_f32 v120, v230, v120
    v_mul_f32 v121, v230, v121
    v_mul_f32 v122, v230, v122
    v_mul_f32 v123, v230, v123
    v_mul_f32 v124, v230, v124
    v_mul_f32 v125, v230, v125
    v_mul_f32 v126, v230, v126
    v_mul_f32 v127, v230, v127
    v_mul_f32 v128, v230, v128
    v_mul_f32 v129, v230, v129
    v_mul_f32 v130, v230, v130
    v_mul_f32 v131, v230, v131
    v_sub_f32 v36, v36, v228
    v_sub_f32 v37, v37, v228
    v_sub_f32 v38, v38, v228
    v_sub_f32 v39, v39, v228
    v_sub_f32 v40, v40, v228
    v_sub_f32 v41, v41, v228
    v_sub_f32 v42, v42, v228
    v_sub_f32 v43, v43, v228
    v_sub_f32 v44, v44, v228
    v_sub_f32 v45, v45, v228
    v_sub_f32 v46, v46, v228
    v_sub_f32 v47, v47, v228
    v_sub_f32 v48, v48, v228
    v_sub_f32 v49, v49, v228
    v_sub_f32 v50, v50, v228
    v_sub_f32 v51, v51, v228
    v_exp_f32 v36, v36
    v_exp_f32 v37, v37
    v_exp_f32 v38, v38
    v_exp_f32 v39, v39
    v_exp_f32 v40, v40
    v_exp_f32 v41, v41
    v_exp_f32 v42, v42
    v_exp_f32 v43, v43
    v_exp_f32 v44, v44
    v_exp_f32 v45, v45
    v_exp_f32 v46, v46
    v_exp_f32 v47, v47
    v_exp_f32 v48, v48
    v_exp_f32 v49, v49
    v_exp_f32 v50, v50
    v_exp_f32 v51, v51
    v_cvt_pk_bf16_f32 v20, v36, v37
    v_cvt_pk_bf16_f32 v21, v38, v39
    v_cvt_pk_bf16_f32 v22, v40, v41
    v_cvt_pk_bf16_f32 v23, v42, v43
    v_cvt_pk_bf16_f32 v24, v44, v45
    v_cvt_pk_bf16_f32 v25, v46, v47
    v_cvt_pk_bf16_f32 v26, v48, v49
    v_cvt_pk_bf16_f32 v27, v50, v51
    v_mfma_f32_32x32x16_bf16 v[116:131], v[164:167], v[20:23], v[116:131]
    s_nop 0
    v_mfma_f32_32x32x16_bf16 v[116:131], v[168:171], v[24:27], v[116:131]
    s_sub_u32 s8, s8, 1
    s_cmp_lg_u32 s8, 0
    s_cbranch_scc1 parallel_sum__mha_block__glu_gated_geglu__prompt_kernel_slow1
    s_nop 15
parallel_sum__mha_block__glu_gated_geglu__prompt_kernel_fin:
    v_rcp_f32 v108, v108
    v_rcp_f32 v124, v124
    v_mul_f32 v100, v108, v100
    v_mul_f32 v101, v108, v101
    v_mul_f32 v102, v108, v102
    v_mul_f32 v103, v108, v103
    v_mul_f32 v104, v108, v104
    v_mul_f32 v105, v108, v105
    v_mul_f32 v106, v108, v106
    v_mul_f32 v107, v108, v107
    v_cvt_pk_bf16_f32 v100, v100, v101
    v_cvt_pk_bf16_f32 v101, v102, v103
    v_cvt_pk_bf16_f32 v102, v104, v105
    v_cvt_pk_bf16_f32 v103, v106, v107
    buffer_store_dwordx4 v[100:103], v1, s[36:39], s96 offen sc1
    v_mul_f32 v116, v124, v116
    v_mul_f32 v117, v124, v117
    v_mul_f32 v118, v124, v118
    v_mul_f32 v119, v124, v119
    v_mul_f32 v120, v124, v120
    v_mul_f32 v121, v124, v121
    v_mul_f32 v122, v124, v122
    v_mul_f32 v123, v124, v123
    v_cvt_pk_bf16_f32 v116, v116, v117
    v_cvt_pk_bf16_f32 v117, v118, v119
    v_cvt_pk_bf16_f32 v118, v120, v121
    v_cvt_pk_bf16_f32 v119, v122, v123
    buffer_store_dwordx4 v[116:119], v1, s[36:39], s97 offen sc1
    v_mov_b32 v229, s61
    v_mov_b32 v228, 0
    v_mov_b32 v230, 161068
    v_mov_b32 v231, 1
    s_mov_b64 exec, 1
    ds_add_rtn_u32 v231, v230, v231
    s_mov_b64 exec, -1
    s_waitcnt vmcnt(0)
    s_mov_b64 exec, 1
    buffer_store_dword v229, v228, s[36:39], s98 offen sc1
    s_mov_b64 exec, -1
    s_waitcnt lgkmcnt(0)
    s_endpgm
parallel_sum__mha_block__glu_gated_geglu__prompt_kernel_cw2:
    s_waitcnt lgkmcnt(0)
    s_branch parallel_sum__mha_block__glu_gated_geglu__prompt_kernel_cw
parallel_sum__mha_block__glu_gated_geglu__prompt_kernel_g:
    v_and_b32 v17, 63, v0
    s_waitcnt lgkmcnt(0)
    s_mov_b32 s24, s4
    s_and_b32 s25, s5, 0xffff
    s_mov_b32 s26, 0x00200000
    s_mov_b32 s27, 0x00020000
    s_setprio 1
    s_lshl_b32 s55, s53, 2
    s_add_u32 s55, s55, s52
    v_lshlrev_b32 v18, 3, v17
    v_add_u32 v18, 161024, v18
    v_mov_b32 v20, 0
    v_mov_b32 v21, 0
    ds_write_b64 v18, v[20:21]
    s_mov_b32 s36, s22
    s_and_b32 s37, s23, 0xffff
    s_mov_b32 s38, 0x01000000
    s_mov_b32 s39, 0x00020000
    s_mov_b32 s32, s8
    s_and_b32 s33, s9, 0xffff
    s_mov_b32 s34, 0x00080000
    s_mov_b32 s35, 0x00020000
    s_mov_b32 s40, s18
    s_and_b32 s41, s19, 0xffff
    s_mov_b32 s42, 0x00200000
    s_mov_b32 s43, 0x00020000
    s_cmp_ge_u32 s52, 2
    s_cselect_b32 s28, s14, s12
    s_cselect_b32 s29, s15, s13
    s_cselect_b32 s65, 1, 0
    s_and_b32 s29, s29, 0xffff
    s_mov_b32 s30, 1835008
    s_mov_b32 s31, 0x00020000
    s_and_b32 s66, s52, 1
    s_mul_i32 s56, s54, 224
    s_and_b32 s57, s54, 3
    s_lshl_b32 s57, s57, 5
    s_add_u32 s64, s56, s57
    s_bitcmp1_b32 s54, 0
    s_cselect_b32 s49, 0, 192
    s_cselect_b32 s50, 32, 0
    s_add_u32 s49, s49, s56
    s_add_u32 s50, s50, s56
    s_bitcmp1_b32 s54, 1
    s_cselect_b32 s57, 0, 128
    s_add_u32 s50, s50, s57
    s_mul_i32 s14, s65, 8224
    s_lshl_b32 s57, s66, 12
    s_add_u32 s14, s14, s57
    s_mul_i32 s15, s66, 114688
    s_xor_b32 s57, s48, 0
    s_mul_i32 s57, s57, 458752
    s_add_u32 s96, s57, s15
    s_xor_b32 s57, s48, 1
    s_mul_i32 s57, s57, 458752
    s_add_u32 s97, s57, s15
    s_xor_b32 s57, s48, 2
    s_mul_i32 s57, s57, 458752
    s_add_u32 s98, s57, s15
    s_xor_b32 s57, s48, 3
    s_mul_i32 s57, s57, 458752
    s_add_u32 s99, s57, s15
    s_lshl_b32 s67, s62, 3
    s_and_b32 s56, s2, 1
    s_lshl_b32 s56, s56, 2
    s_add_u32 s67, s67, s56
    s_and_b32 s56, s63, 3
    s_add_u32 s67, s67, s56
    s_mov_b32 s60, 0xffff0000
    v_and_b32 v18, 31, v17
    v_lshrrev_b32 v19, 5, v17
    v_and_b32 v22, 15, v17
    v_xor_b32 v22, v22, v19
    s_lshl_b32 s56, s52, 1
    v_xor_b32 v22, s56, v22
    s_lshl_b32 s57, s52, 13
    v_lshlrev_b32 v23, 8, v18
    v_add_u32 v23, s57, v23
    v_xor_b32 v1, 0, v22
    v_lshl_add_u32 v1, v1, 4, v23
    v_xor_b32 v2, 2, v22
    v_lshl_add_u32 v2, v2, 4, v23
    v_xor_b32 v3, 4, v22
    v_lshl_add_u32 v3, v3, 4, v23
    v_xor_b32 v4, 6, v22
    v_lshl_add_u32 v4, v4, 4, v23
    v_xor_b32 v5, 8, v22
    v_lshl_add_u32 v5, v5, 4, v23
    v_xor_b32 v6, 10, v22
    v_lshl_add_u32 v6, v6, 4, v23
    v_xor_b32 v7, 12, v22
    v_lshl_add_u32 v7, v7, 4, v23
    v_xor_b32 v8, 14, v22
    v_lshl_add_u32 v8, v8, 4, v23
    v_bfe_u32 v24, v0, 2, 2
    v_bfe_u32 v25, v0, 5, 1
    v_lshl_add_u32 v24, v25, 4, v24
    v_lshlrev_b32 v24, 6, v24
    v_and_b32 v25, 3, v0
    v_lshl_add_u32 v24, v25, 3, v24
    v_bfe_u32 v25, v0, 4, 1
    v_lshl_add_u32 v24, v25, 5, v24
    s_xor_b32 s3, s52, 0
    s_lshl_b32 s3, s3, 11
    v_add_u32 v9, s3, v24
    s_xor_b32 s3, s52, 1
    s_lshl_b32 s3, s3, 11
    v_add_u32 v10, s3, v24
    s_xor_b32 s3, s52, 2
    s_lshl_b32 s3, s3, 11
    v_add_u32 v11, s3, v24
    s_xor_b32 s3, s52, 3
    s_lshl_b32 s3, s3, 11
    v_add_u32 v12, s3, v24
    v_and_b32 v24, 15, v17
    v_bfe_u32 v25, v17, 4, 1
    v_cmp_eq_u32 vcc, v24, v25
    v_mov_b32 v26, 0x3f803f80
    s_nop 0
    v_cndmask_b32 v76, 0, v26, vcc
    v_cndmask_b32 v77, 0, v26, vcc
    v_cndmask_b32 v78, 0, v26, vcc
    v_cndmask_b32 v79, 0, v26, vcc
    v_mov_b32 v64, 0
    v_mov_b32 v65, 0
    v_mov_b32 v66, 0
    v_mov_b32 v67, 0
    v_mov_b32 v68, 0
    v_mov_b32 v69, 0
    v_mov_b32 v70, 0
    v_mov_b32 v71, 0
    v_mov_b32 v72, 0
    v_mov_b32 v73, 0
    v_mov_b32 v74, 0
    v_mov_b32 v75, 0
    s_mul_i32 s4, s55, 114688
    s_add_u32 s4, s4, 8388608
    s_lshr_b32 s56, s54, 1
    s_lshl_b32 s56, s56, 18
    s_lshl_b32 s57, s55, 10
    s_add_u32 s56, s56, s57
    s_bitcmp1_b32 s54, 0
    s_cselect_b32 s5, 2097152, 0
    s_cselect_b32 s10, 131072, 0
    s_cselect_b32 s11, 1.0, 0x3eb8aa3b
    s_add_u32 s5, s5, s56
    s_add_u32 s10, s10, s56
    s_add_u32 s10, s10, 4194304
    s_lshl_b32 s6, s54, 4
    s_add_u32 s6, s6, s53
    s_lshl_b32 s6, s6, 8
    s_add_u32 s6, s6, 15728640
    s_lshl_b32 s7, s67, 16
    s_lshl_b32 s56, s65, 15
    s_add_u32 s7, s7, s56
    s_lshl_b32 s56, s66, 21
    s_add_u32 s7, s7, s56
    s_add_u32 s7, s7, 2105344
    s_lshl_b32 s56, s52, 2
    s_add_u32 s56, s56, 161520
    v_mov_b32 v13, s56
    s_mov_b32 s3, 0x3f803f80
    s_waitcnt vmcnt(0) lgkmcnt(0)
    s_barrier
    ds_read_b128 v[128:131], v1 offset:0
    ds_read_b128 v[132:135], v2 offset:0
    ds_read_b128 v[136:139], v3 offset:0
    ds_read_b128 v[140:143], v4 offset:0
    ds_read_b128 v[144:147], v5 offset:0
    ds_read_b128 v[148:151], v6 offset:0
    ds_read_b128 v[152:155], v7 offset:0
    ds_read_b128 v[156:159], v8 offset:0
    s_waitcnt lgkmcnt(0)
    v_dot2c_f32_bf16 v64, s3, v128
    v_dot2c_f32_bf16 v70, v128, v128
    v_dot2c_f32_bf16 v65, s3, v129
    v_dot2c_f32_bf16 v71, v129, v129
    v_dot2c_f32_bf16 v66, s3, v130
    v_dot2c_f32_bf16 v72, v130, v130
    v_dot2c_f32_bf16 v67, s3, v131
    v_dot2c_f32_bf16 v73, v131, v131
    v_dot2c_f32_bf16 v68, s3, v132
    v_dot2c_f32_bf16 v74, v132, v132
    v_dot2c_f32_bf16 v69, s3, v133
    v_dot2c_f32_bf16 v75, v133, v133
    v_dot2c_f32_bf16 v64, s3, v134
    v_dot2c_f32_bf16 v70, v134, v134
    v_dot2c_f32_bf16 v65, s3, v135
    v_dot2c_f32_bf16 v71, v135, v135
    v_dot2c_f32_bf16 v66, s3, v136
    v_dot2c_f32_bf16 v72, v136, v136
    v_dot2c_f32_bf16 v67, s3, v137
    v_dot2c_f32_bf16 v73, v137, v137
    v_dot2c_f32_bf16 v68, s3, v138
    v_dot2c_f32_bf16 v74, v138, v138
    v_dot2c_f32_bf16 v69, s3, v139
    v_dot2c_f32_bf16 v75, v139, v139
    v_dot2c_f32_bf16 v64, s3, v140
    v_dot2c_f32_bf16 v70, v140, v140
    v_dot2c_f32_bf16 v65, s3, v141
    v_dot2c_f32_bf16 v71, v141, v141
    v_dot2c_f32_bf16 v66, s3, v142
    v_dot2c_f32_bf16 v72, v142, v142
    v_dot2c_f32_bf16 v67, s3, v143
    v_dot2c_f32_bf16 v73, v143, v143
    v_dot2c_f32_bf16 v68, s3, v144
    v_dot2c_f32_bf16 v74, v144, v144
    v_dot2c_f32_bf16 v69, s3, v145
    v_dot2c_f32_bf16 v75, v145, v145
    v_dot2c_f32_bf16 v64, s3, v146
    v_dot2c_f32_bf16 v70, v146, v146
    v_dot2c_f32_bf16 v65, s3, v147
    v_dot2c_f32_bf16 v71, v147, v147
    v_dot2c_f32_bf16 v66, s3, v148
    v_dot2c_f32_bf16 v72, v148, v148
    v_dot2c_f32_bf16 v67, s3, v149
    v_dot2c_f32_bf16 v73, v149, v149
    v_dot2c_f32_bf16 v68, s3, v150
    v_dot2c_f32_bf16 v74, v150, v150
    v_dot2c_f32_bf16 v69, s3, v151
    v_dot2c_f32_bf16 v75, v151, v151
    v_dot2c_f32_bf16 v64, s3, v152
    v_dot2c_f32_bf16 v70, v152, v152
    v_dot2c_f32_bf16 v65, s3, v153
    v_dot2c_f32_bf16 v71, v153, v153
    v_dot2c_f32_bf16 v66, s3, v154
    v_dot2c_f32_bf16 v72, v154, v154
    v_dot2c_f32_bf16 v67, s3, v155
    v_dot2c_f32_bf16 v73, v155, v155
    v_dot2c_f32_bf16 v68, s3, v156
    v_dot2c_f32_bf16 v74, v156, v156
    v_dot2c_f32_bf16 v69, s3, v157
    v_dot2c_f32_bf16 v75, v157, v157
    v_dot2c_f32_bf16 v64, s3, v158
    v_dot2c_f32_bf16 v70, v158, v158
    v_dot2c_f32_bf16 v65, s3, v159
    v_dot2c_f32_bf16 v71, v159, v159
    s_barrier
    v_add_u32 v9, 0x00018000, v9
    v_add_u32 v10, 0x00018000, v10
    v_add_u32 v11, 0x00018000, v11
    v_add_u32 v12, 0x00018000, v12
    ds_read_b64_tr_b16 v[80:81], v9 offset:0
    ds_read_b64_tr_b16 v[82:83], v9 offset:256
    ds_read_b64_tr_b16 v[84:85], v9 offset:512
    ds_read_b64_tr_b16 v[86:87], v9 offset:768
    ds_read_b64_tr_b16 v[88:89], v9 offset:16384
    ds_read_b64_tr_b16 v[90:91], v9 offset:16640
    ds_read_b64_tr_b16 v[92:93], v10 offset:0
    ds_read_b64_tr_b16 v[94:95], v10 offset:256
    ds_read_b64_tr_b16 v[96:97], v10 offset:512
    ds_read_b64_tr_b16 v[98:99], v10 offset:768
    ds_read_b64_tr_b16 v[100:101], v10 offset:16384
    ds_read_b64_tr_b16 v[102:103], v10 offset:16640
    s_waitcnt lgkmcnt(6)
    v_mfma_f32_32x32x16_bf16 v[16:31], v[80:83], v[128:131], 0
    v_mfma_f32_16x16x32_bf16 v[116:119], v[76:79], v[80:83], 0
    ds_read_b64_tr_b16 v[104:105], v11 offset:0
    ds_read_b64_tr_b16 v[106:107], v11 offset:256
    v_mfma_f32_32x32x16_bf16 v[32:47], v[84:87], v[128:131], 0
    v_mfma_f32_16x16x32_bf16 v[120:123], v[76:79], v[84:87], 0
    ds_read_b64_tr_b16 v[108:109], v11 offset:512
    ds_read_b64_tr_b16 v[110:111], v11 offset:768
    v_mfma_f32_32x32x16_bf16 v[48:63], v[128:131], v[88:91], 0
    v_mfma_f32_16x16x32_bf16 v[124:127], v[76:79], v[88:91], 0
    ds_read_b64_tr_b16 v[112:113], v11 offset:16384
    ds_read_b64_tr_b16 v[114:115], v11 offset:16640
    s_waitcnt lgkmcnt(6)
    v_mfma_f32_32x32x16_bf16 v[16:31], v[92:95], v[132:135], v[16:31]
    ds_read_b64_tr_b16 v[80:81], v12 offset:0
    ds_read_b64_tr_b16 v[82:83], v12 offset:256
    v_mfma_f32_32x32x16_bf16 v[32:47], v[96:99], v[132:135], v[32:47]
    ds_read_b64_tr_b16 v[84:85], v12 offset:512
    ds_read_b64_tr_b16 v[86:87], v12 offset:768
    v_mfma_f32_32x32x16_bf16 v[48:63], v[132:135], v[100:103], v[48:63]
    ds_read_b64_tr_b16 v[88:89], v12 offset:16384
    ds_read_b64_tr_b16 v[90:91], v12 offset:16640
    s_waitcnt lgkmcnt(6)
    v_mfma_f32_32x32x16_bf16 v[16:31], v[104:107], v[136:139], v[16:31]
    ds_read_b64_tr_b16 v[92:93], v9 offset:8192
    ds_read_b64_tr_b16 v[94:95], v9 offset:8448
    v_mfma_f32_32x32x16_bf16 v[32:47], v[108:111], v[136:139], v[32:47]
    ds_read_b64_tr_b16 v[96:97], v9 offset:8704
    ds_read_b64_tr_b16 v[98:99], v9 offset:8960
    v_mfma_f32_32x32x16_bf16 v[48:63], v[136:139], v[112:115], v[48:63]
    ds_read_b64_tr_b16 v[100:101], v9 offset:16896
    ds_read_b64_tr_b16 v[102:103], v9 offset:17152
    s_waitcnt lgkmcnt(6)
    v_mfma_f32_32x32x16_bf16 v[16:31], v[80:83], v[140:143], v[16:31]
    ds_read_b64_tr_b16 v[104:105], v10 offset:8192
    ds_read_b64_tr_b16 v[106:107], v10 offset:8448
    v_mfma_f32_32x32x16_bf16 v[32:47], v[84:87], v[140:143], v[32:47]
    ds_read_b64_tr_b16 v[108:109], v10 offset:8704
    ds_read_b64_tr_b16 v[110:111], v10 offset:8960
    v_mfma_f32_32x32x16_bf16 v[48:63], v[140:143], v[88:91], v[48:63]
    ds_read_b64_tr_b16 v[112:113], v10 offset:16896
    ds_read_b64_tr_b16 v[114:115], v10 offset:17152
    s_waitcnt lgkmcnt(6)
    v_mfma_f32_32x32x16_bf16 v[16:31], v[92:95], v[144:147], v[16:31]
    v_mfma_f32_16x16x32_bf16 v[116:119], v[76:79], v[92:95], v[116:119]
    ds_read_b64_tr_b16 v[80:81], v11 offset:8192
    ds_read_b64_tr_b16 v[82:83], v11 offset:8448
    v_mfma_f32_32x32x16_bf16 v[32:47], v[96:99], v[144:147], v[32:47]
    v_mfma_f32_16x16x32_bf16 v[120:123], v[76:79], v[96:99], v[120:123]
    ds_read_b64_tr_b16 v[84:85], v11 offset:8704
    ds_read_b64_tr_b16 v[86:87], v11 offset:8960
    v_mfma_f32_32x32x16_bf16 v[48:63], v[144:147], v[100:103], v[48:63]
    v_mfma_f32_16x16x32_bf16 v[124:127], v[76:79], v[100:103], v[124:127]
    ds_read_b64_tr_b16 v[88:89], v11 offset:16896
    ds_read_b64_tr_b16 v[90:91], v11 offset:17152
    s_waitcnt lgkmcnt(6)
    v_mfma_f32_32x32x16_bf16 v[16:31], v[104:107], v[148:151], v[16:31]
    ds_read_b64_tr_b16 v[92:93], v12 offset:8192
    ds_read_b64_tr_b16 v[94:95], v12 offset:8448
    v_mfma_f32_32x32x16_bf16 v[32:47], v[108:111], v[148:151], v[32:47]
    ds_read_b64_tr_b16 v[96:97], v12 offset:8704
    ds_read_b64_tr_b16 v[98:99], v12 offset:8960
    v_mfma_f32_32x32x16_bf16 v[48:63], v[148:151], v[112:115], v[48:63]
    ds_read_b64_tr_b16 v[100:101], v12 offset:16896
    ds_read_b64_tr_b16 v[102:103], v12 offset:17152
    s_barrier
    s_waitcnt lgkmcnt(6)
    v_mfma_f32_32x32x16_bf16 v[16:31], v[80:83], v[152:155], v[16:31]
    ds_read_b128 v[160:163], v1 offset:32768
    ds_read_b128 v[164:167], v2 offset:32768
    ds_read_b128 v[168:171], v3 offset:32768
    ds_read_b128 v[172:175], v4 offset:32768
    ds_read_b128 v[176:179], v5 offset:32768
    ds_read_b128 v[180:183], v6 offset:32768
    ds_read_b128 v[184:187], v7 offset:32768
    ds_read_b128 v[188:191], v8 offset:32768
    ds_read_b64_tr_b16 v[104:105], v9 offset:24576
    ds_read_b64_tr_b16 v[106:107], v9 offset:24832
    v_mfma_f32_32x32x16_bf16 v[32:47], v[84:87], v[152:155], v[32:47]
    ds_read_b64_tr_b16 v[108:109], v9 offset:25088
    ds_read_b64_tr_b16 v[110:111], v9 offset:25344
    v_mfma_f32_32x32x16_bf16 v[48:63], v[152:155], v[88:91], v[48:63]
    ds_read_b64_tr_b16 v[112:113], v9 offset:40960
    ds_read_b64_tr_b16 v[114:115], v9 offset:41216
    s_waitcnt lgkmcnt(14)
    v_mfma_f32_32x32x16_bf16 v[16:31], v[92:95], v[156:159], v[16:31]
    ds_read_b64_tr_b16 v[80:81], v10 offset:24576
    ds_read_b64_tr_b16 v[82:83], v10 offset:24832
    v_mfma_f32_32x32x16_bf16 v[32:47], v[96:99], v[156:159], v[32:47]
    ds_read_b64_tr_b16 v[84:85], v10 offset:25088
    ds_read_b64_tr_b16 v[86:87], v10 offset:25344
    v_mfma_f32_32x32x16_bf16 v[48:63], v[156:159], v[100:103], v[48:63]
    ds_read_b64_tr_b16 v[88:89], v10 offset:40960
    ds_read_b64_tr_b16 v[90:91], v10 offset:41216
    s_waitcnt lgkmcnt(12)
    v_dot2c_f32_bf16 v64, s3, v160
    v_dot2c_f32_bf16 v70, v160, v160
    v_dot2c_f32_bf16 v65, s3, v161
    v_dot2c_f32_bf16 v71, v161, v161
    v_dot2c_f32_bf16 v66, s3, v162
    v_dot2c_f32_bf16 v72, v162, v162
    v_dot2c_f32_bf16 v67, s3, v163
    v_dot2c_f32_bf16 v73, v163, v163
    v_dot2c_f32_bf16 v68, s3, v164
    v_dot2c_f32_bf16 v74, v164, v164
    v_dot2c_f32_bf16 v69, s3, v165
    v_dot2c_f32_bf16 v75, v165, v165
    v_dot2c_f32_bf16 v64, s3, v166
    v_dot2c_f32_bf16 v70, v166, v166
    v_dot2c_f32_bf16 v65, s3, v167
    v_dot2c_f32_bf16 v71, v167, v167
    v_dot2c_f32_bf16 v66, s3, v168
    v_dot2c_f32_bf16 v72, v168, v168
    v_dot2c_f32_bf16 v67, s3, v169
    v_dot2c_f32_bf16 v73, v169, v169
    v_dot2c_f32_bf16 v68, s3, v170
    v_dot2c_f32_bf16 v74, v170, v170
    v_dot2c_f32_bf16 v69, s3, v171
    v_dot2c_f32_bf16 v75, v171, v171
    v_dot2c_f32_bf16 v64, s3, v172
    v_dot2c_f32_bf16 v70, v172, v172
    v_dot2c_f32_bf16 v65, s3, v173
    v_dot2c_f32_bf16 v71, v173, v173
    v_dot2c_f32_bf16 v66, s3, v174
    v_dot2c_f32_bf16 v72, v174, v174
    v_dot2c_f32_bf16 v67, s3, v175
    v_dot2c_f32_bf16 v73, v175, v175
    v_dot2c_f32_bf16 v68, s3, v176
    v_dot2c_f32_bf16 v74, v176, v176
    v_dot2c_f32_bf16 v69, s3, v177
    v_dot2c_f32_bf16 v75, v177, v177
    v_dot2c_f32_bf16 v64, s3, v178
    v_dot2c_f32_bf16 v70, v178, v178
    v_dot2c_f32_bf16 v65, s3, v179
    v_dot2c_f32_bf16 v71, v179, v179
    v_dot2c_f32_bf16 v66, s3, v180
    v_dot2c_f32_bf16 v72, v180, v180
    v_dot2c_f32_bf16 v67, s3, v181
    v_dot2c_f32_bf16 v73, v181, v181
    v_dot2c_f32_bf16 v68, s3, v182
    v_dot2c_f32_bf16 v74, v182, v182
    v_dot2c_f32_bf16 v69, s3, v183
    v_dot2c_f32_bf16 v75, v183, v183
    v_dot2c_f32_bf16 v64, s3, v184
    v_dot2c_f32_bf16 v70, v184, v184
    v_dot2c_f32_bf16 v65, s3, v185
    v_dot2c_f32_bf16 v71, v185, v185
    v_dot2c_f32_bf16 v66, s3, v186
    v_dot2c_f32_bf16 v72, v186, v186
    v_dot2c_f32_bf16 v67, s3, v187
    v_dot2c_f32_bf16 v73, v187, v187
    v_dot2c_f32_bf16 v68, s3, v188
    v_dot2c_f32_bf16 v74, v188, v188
    v_dot2c_f32_bf16 v69, s3, v189
    v_dot2c_f32_bf16 v75, v189, v189
    v_dot2c_f32_bf16 v64, s3, v190
    v_dot2c_f32_bf16 v70, v190, v190
    v_dot2c_f32_bf16 v65, s3, v191
    v_dot2c_f32_bf16 v71, v191, v191
    s_barrier
    s_waitcnt lgkmcnt(6)
    v_mfma_f32_32x32x16_bf16 v[16:31], v[104:107], v[160:163], v[16:31]
    v_mfma_f32_16x16x32_bf16 v[116:119], v[76:79], v[104:107], v[116:119]
    ds_read_b64_tr_b16 v[92:93], v11 offset:24576
    ds_read_b64_tr_b16 v[94:95], v11 offset:24832
    v_mfma_f32_32x32x16_bf16 v[32:47], v[108:111], v[160:163], v[32:47]
    v_mfma_f32_16x16x32_bf16 v[120:123], v[76:79], v[108:111], v[120:123]
    ds_read_b64_tr_b16 v[96:97], v11 offset:25088
    ds_read_b64_tr_b16 v[98:99], v11 offset:25344
    v_mfma_f32_32x32x16_bf16 v[48:63], v[160:163], v[112:115], v[48:63]
    v_mfma_f32_16x16x32_bf16 v[124:127], v[76:79], v[112:115], v[124:127]
    ds_read_b64_tr_b16 v[100:101], v11 offset:40960
    ds_read_b64_tr_b16 v[102:103], v11 offset:41216
    s_waitcnt lgkmcnt(6)
    v_mfma_f32_32x32x16_bf16 v[16:31], v[80:83], v[164:167], v[16:31]
    ds_read_b64_tr_b16 v[104:105], v12 offset:24576
    ds_read_b64_tr_b16 v[106:107], v12 offset:24832
    v_mfma_f32_32x32x16_bf16 v[32:47], v[84:87], v[164:167], v[32:47]
    ds_read_b64_tr_b16 v[108:109], v12 offset:25088
    ds_read_b64_tr_b16 v[110:111], v12 offset:25344
    v_mfma_f32_32x32x16_bf16 v[48:63], v[164:167], v[88:91], v[48:63]
    ds_read_b64_tr_b16 v[112:113], v12 offset:40960
    ds_read_b64_tr_b16 v[114:115], v12 offset:41216
    s_waitcnt lgkmcnt(6)
    v_mfma_f32_32x32x16_bf16 v[16:31], v[92:95], v[168:171], v[16:31]
    ds_read_b64_tr_b16 v[80:81], v9 offset:32768
    ds_read_b64_tr_b16 v[82:83], v9 offset:33024
    v_mfma_f32_32x32x16_bf16 v[32:47], v[96:99], v[168:171], v[32:47]
    ds_read_b64_tr_b16 v[84:85], v9 offset:33280
    ds_read_b64_tr_b16 v[86:87], v9 offset:33536
    v_mfma_f32_32x32x16_bf16 v[48:63], v[168:171], v[100:103], v[48:63]
    ds_read_b64_tr_b16 v[88:89], v9 offset:41472
    ds_read_b64_tr_b16 v[90:91], v9 offset:41728
    s_waitcnt lgkmcnt(6)
    v_mfma_f32_32x32x16_bf16 v[16:31], v[104:107], v[172:175], v[16:31]
    ds_read_b64_tr_b16 v[92:93], v10 offset:32768
    ds_read_b64_tr_b16 v[94:95], v10 offset:33024
    v_mfma_f32_32x32x16_bf16 v[32:47], v[108:111], v[172:175], v[32:47]
    ds_read_b64_tr_b16 v[96:97], v10 offset:33280
    ds_read_b64_tr_b16 v[98:99], v10 offset:33536
    v_mfma_f32_32x32x16_bf16 v[48:63], v[172:175], v[112:115], v[48:63]
    ds_read_b64_tr_b16 v[100:101], v10 offset:41472
    ds_read_b64_tr_b16 v[102:103], v10 offset:41728
    s_waitcnt lgkmcnt(6)
    v_mfma_f32_32x32x16_bf16 v[16:31], v[80:83], v[176:179], v[16:31]
    v_mfma_f32_16x16x32_bf16 v[116:119], v[76:79], v[80:83], v[116:119]
    ds_read_b64_tr_b16 v[104:105], v11 offset:32768
    ds_read_b64_tr_b16 v[106:107], v11 offset:33024
    v_mfma_f32_32x32x16_bf16 v[32:47], v[84:87], v[176:179], v[32:47]
    v_mfma_f32_16x16x32_bf16 v[120:123], v[76:79], v[84:87], v[120:123]
    ds_read_b64_tr_b16 v[108:109], v11 offset:33280
    ds_read_b64_tr_b16 v[110:111], v11 offset:33536
    v_mfma_f32_32x32x16_bf16 v[48:63], v[176:179], v[88:91], v[48:63]
    v_mfma_f32_16x16x32_bf16 v[124:127], v[76:79], v[88:91], v[124:127]
    ds_read_b64_tr_b16 v[112:113], v11 offset:41472
    ds_read_b64_tr_b16 v[114:115], v11 offset:41728
    s_waitcnt lgkmcnt(6)
    v_mfma_f32_32x32x16_bf16 v[16:31], v[92:95], v[180:183], v[16:31]
    ds_read_b64_tr_b16 v[80:81], v12 offset:32768
    ds_read_b64_tr_b16 v[82:83], v12 offset:33024
    v_mfma_f32_32x32x16_bf16 v[32:47], v[96:99], v[180:183], v[32:47]
    ds_read_b64_tr_b16 v[84:85], v12 offset:33280
    ds_read_b64_tr_b16 v[86:87], v12 offset:33536
    v_mfma_f32_32x32x16_bf16 v[48:63], v[180:183], v[100:103], v[48:63]
    ds_read_b64_tr_b16 v[88:89], v12 offset:41472
    ds_read_b64_tr_b16 v[90:91], v12 offset:41728
    s_barrier
    s_waitcnt lgkmcnt(6)
    v_mfma_f32_32x32x16_bf16 v[16:31], v[104:107], v[184:187], v[16:31]
    v_add_u32 v1, 0x00010000, v1
    v_add_u32 v2, 0x00010000, v2
    v_add_u32 v3, 0x00010000, v3
    v_add_u32 v4, 0x00010000, v4
    v_add_u32 v5, 0x00010000, v5
    v_add_u32 v6, 0x00010000, v6
    v_add_u32 v7, 0x00010000, v7
    v_add_u32 v8, 0x00010000, v8
    ds_read_b128 v[192:195], v1 offset:0
    ds_read_b128 v[196:199], v2 offset:0
    ds_read_b128 v[200:203], v3 offset:0
    ds_read_b128 v[204:207], v4 offset:0
    ds_read_b128 v[208:211], v5 offset:0
    ds_read_b128 v[212:215], v6 offset:0
    ds_read_b128 v[216:219], v7 offset:0
    ds_read_b128 v[220:223], v8 offset:0
    v_add_u32 v9, 0xfffe8000, v9
    v_add_u32 v10, 0xfffe8000, v10
    v_add_u32 v11, 0xfffe8000, v11
    v_add_u32 v12, 0xfffe8000, v12
    ds_read_b64_tr_b16 v[92:93], v9 offset:0
    ds_read_b64_tr_b16 v[94:95], v9 offset:256
    v_mfma_f32_32x32x16_bf16 v[32:47], v[108:111], v[184:187], v[32:47]
    ds_read_b64_tr_b16 v[96:97], v9 offset:512
    ds_read_b64_tr_b16 v[98:99], v9 offset:768
    v_mfma_f32_32x32x16_bf16 v[48:63], v[184:187], v[112:115], v[48:63]
    ds_read_b64_tr_b16 v[100:101], v9 offset:16384
    ds_read_b64_tr_b16 v[102:103], v9 offset:16640
    s_waitcnt lgkmcnt(14)
    v_mfma_f32_32x32x16_bf16 v[16:31], v[80:83], v[188:191], v[16:31]
    ds_read_b64_tr_b16 v[104:105], v10 offset:0
    ds_read_b64_tr_b16 v[106:107], v10 offset:256
    v_mfma_f32_32x32x16_bf16 v[32:47], v[84:87], v[188:191], v[32:47]
    ds_read_b64_tr_b16 v[108:109], v10 offset:512
    ds_read_b64_tr_b16 v[110:111], v10 offset:768
    v_mfma_f32_32x32x16_bf16 v[48:63], v[188:191], v[88:91], v[48:63]
    ds_read_b64_tr_b16 v[112:113], v10 offset:16384
    ds_read_b64_tr_b16 v[114:115], v10 offset:16640
    s_waitcnt lgkmcnt(12)
    v_dot2c_f32_bf16 v64, s3, v192
    v_dot2c_f32_bf16 v70, v192, v192
    v_dot2c_f32_bf16 v65, s3, v193
    v_dot2c_f32_bf16 v71, v193, v193
    v_dot2c_f32_bf16 v66, s3, v194
    v_dot2c_f32_bf16 v72, v194, v194
    v_dot2c_f32_bf16 v67, s3, v195
    v_dot2c_f32_bf16 v73, v195, v195
    v_dot2c_f32_bf16 v68, s3, v196
    v_dot2c_f32_bf16 v74, v196, v196
    v_dot2c_f32_bf16 v69, s3, v197
    v_dot2c_f32_bf16 v75, v197, v197
    v_dot2c_f32_bf16 v64, s3, v198
    v_dot2c_f32_bf16 v70, v198, v198
    v_dot2c_f32_bf16 v65, s3, v199
    v_dot2c_f32_bf16 v71, v199, v199
    v_dot2c_f32_bf16 v66, s3, v200
    v_dot2c_f32_bf16 v72, v200, v200
    v_dot2c_f32_bf16 v67, s3, v201
    v_dot2c_f32_bf16 v73, v201, v201
    v_dot2c_f32_bf16 v68, s3, v202
    v_dot2c_f32_bf16 v74, v202, v202
    v_dot2c_f32_bf16 v69, s3, v203
    v_dot2c_f32_bf16 v75, v203, v203
    v_dot2c_f32_bf16 v64, s3, v204
    v_dot2c_f32_bf16 v70, v204, v204
    v_dot2c_f32_bf16 v65, s3, v205
    v_dot2c_f32_bf16 v71, v205, v205
    v_dot2c_f32_bf16 v66, s3, v206
    v_dot2c_f32_bf16 v72, v206, v206
    v_dot2c_f32_bf16 v67, s3, v207
    v_dot2c_f32_bf16 v73, v207, v207
    v_dot2c_f32_bf16 v68, s3, v208
    v_dot2c_f32_bf16 v74, v208, v208
    v_dot2c_f32_bf16 v69, s3, v209
    v_dot2c_f32_bf16 v75, v209, v209
    v_dot2c_f32_bf16 v64, s3, v210
    v_dot2c_f32_bf16 v70, v210, v210
    v_dot2c_f32_bf16 v65, s3, v211
    v_dot2c_f32_bf16 v71, v211, v211
    v_dot2c_f32_bf16 v66, s3, v212
    v_dot2c_f32_bf16 v72, v212, v212
    v_dot2c_f32_bf16 v67, s3, v213
    v_dot2c_f32_bf16 v73, v213, v213
    v_dot2c_f32_bf16 v68, s3, v214
    v_dot2c_f32_bf16 v74, v214, v214
    v_dot2c_f32_bf16 v69, s3, v215
    v_dot2c_f32_bf16 v75, v215, v215
    v_dot2c_f32_bf16 v64, s3, v216
    v_dot2c_f32_bf16 v70, v216, v216
    v_dot2c_f32_bf16 v65, s3, v217
    v_dot2c_f32_bf16 v71, v217, v217
    v_dot2c_f32_bf16 v66, s3, v218
    v_dot2c_f32_bf16 v72, v218, v218
    v_dot2c_f32_bf16 v67, s3, v219
    v_dot2c_f32_bf16 v73, v219, v219
    v_dot2c_f32_bf16 v68, s3, v220
    v_dot2c_f32_bf16 v74, v220, v220
    v_dot2c_f32_bf16 v69, s3, v221
    v_dot2c_f32_bf16 v75, v221, v221
    v_dot2c_f32_bf16 v64, s3, v222
    v_dot2c_f32_bf16 v70, v222, v222
    v_dot2c_f32_bf16 v65, s3, v223
    v_dot2c_f32_bf16 v71, v223, v223
    s_waitcnt lgkmcnt(6)
    v_mfma_f32_32x32x16_bf16 v[16:31], v[92:95], v[192:195], v[16:31]
    v_mfma_f32_16x16x32_bf16 v[116:119], v[76:79], v[92:95], v[116:119]
    ds_read_b64_tr_b16 v[80:81], v11 offset:0
    ds_read_b64_tr_b16 v[82:83], v11 offset:256
    v_mfma_f32_32x32x16_bf16 v[32:47], v[96:99], v[192:195], v[32:47]
    v_mfma_f32_16x16x32_bf16 v[120:123], v[76:79], v[96:99], v[120:123]
    ds_read_b64_tr_b16 v[84:85], v11 offset:512
    ds_read_b64_tr_b16 v[86:87], v11 offset:768
    v_mfma_f32_32x32x16_bf16 v[48:63], v[192:195], v[100:103], v[48:63]
    v_mfma_f32_16x16x32_bf16 v[124:127], v[76:79], v[100:103], v[124:127]
    ds_read_b64_tr_b16 v[88:89], v11 offset:16384
    ds_read_b64_tr_b16 v[90:91], v11 offset:16640
    s_waitcnt lgkmcnt(6)
    v_mfma_f32_32x32x16_bf16 v[16:31], v[104:107], v[196:199], v[16:31]
    ds_read_b64_tr_b16 v[92:93], v12 offset:0
    ds_read_b64_tr_b16 v[94:95], v12 offset:256
    v_mfma_f32_32x32x16_bf16 v[32:47], v[108:111], v[196:199], v[32:47]
    ds_read_b64_tr_b16 v[96:97], v12 offset:512
    ds_read_b64_tr_b16 v[98:99], v12 offset:768
    v_mfma_f32_32x32x16_bf16 v[48:63], v[196:199], v[112:115], v[48:63]
    ds_read_b64_tr_b16 v[100:101], v12 offset:16384
    ds_read_b64_tr_b16 v[102:103], v12 offset:16640
    s_waitcnt lgkmcnt(6)
    v_mfma_f32_32x32x16_bf16 v[16:31], v[80:83], v[200:203], v[16:31]
    ds_read_b64_tr_b16 v[104:105], v9 offset:8192
    ds_read_b64_tr_b16 v[106:107], v9 offset:8448
    v_mfma_f32_32x32x16_bf16 v[32:47], v[84:87], v[200:203], v[32:47]
    ds_read_b64_tr_b16 v[108:109], v9 offset:8704
    ds_read_b64_tr_b16 v[110:111], v9 offset:8960
    v_mfma_f32_32x32x16_bf16 v[48:63], v[200:203], v[88:91], v[48:63]
    ds_read_b64_tr_b16 v[112:113], v9 offset:16896
    ds_read_b64_tr_b16 v[114:115], v9 offset:17152
    s_waitcnt lgkmcnt(6)
    v_mfma_f32_32x32x16_bf16 v[16:31], v[92:95], v[204:207], v[16:31]
    ds_read_b64_tr_b16 v[80:81], v10 offset:8192
    ds_read_b64_tr_b16 v[82:83], v10 offset:8448
    v_mfma_f32_32x32x16_bf16 v[32:47], v[96:99], v[204:207], v[32:47]
    ds_read_b64_tr_b16 v[84:85], v10 offset:8704
    ds_read_b64_tr_b16 v[86:87], v10 offset:8960
    v_mfma_f32_32x32x16_bf16 v[48:63], v[204:207], v[100:103], v[48:63]
    ds_read_b64_tr_b16 v[88:89], v10 offset:16896
    ds_read_b64_tr_b16 v[90:91], v10 offset:17152
    s_waitcnt lgkmcnt(6)
    v_mfma_f32_32x32x16_bf16 v[16:31], v[104:107], v[208:211], v[16:31]
    v_mfma_f32_16x16x32_bf16 v[116:119], v[76:79], v[104:107], v[116:119]
    ds_read_b64_tr_b16 v[92:93], v11 offset:8192
    ds_read_b64_tr_b16 v[94:95], v11 offset:8448
    v_mfma_f32_32x32x16_bf16 v[32:47], v[108:111], v[208:211], v[32:47]
    v_mfma_f32_16x16x32_bf16 v[120:123], v[76:79], v[108:111], v[120:123]
    ds_read_b64_tr_b16 v[96:97], v11 offset:8704
    ds_read_b64_tr_b16 v[98:99], v11 offset:8960
    v_mfma_f32_32x32x16_bf16 v[48:63], v[208:211], v[112:115], v[48:63]
    v_mfma_f32_16x16x32_bf16 v[124:127], v[76:79], v[112:115], v[124:127]
    ds_read_b64_tr_b16 v[100:101], v11 offset:16896
    ds_read_b64_tr_b16 v[102:103], v11 offset:17152
    s_waitcnt lgkmcnt(6)
    v_mfma_f32_32x32x16_bf16 v[16:31], v[80:83], v[212:215], v[16:31]
    ds_read_b64_tr_b16 v[104:105], v12 offset:8192
    ds_read_b64_tr_b16 v[106:107], v12 offset:8448
    v_mfma_f32_32x32x16_bf16 v[32:47], v[84:87], v[212:215], v[32:47]
    ds_read_b64_tr_b16 v[108:109], v12 offset:8704
    ds_read_b64_tr_b16 v[110:111], v12 offset:8960
    v_mfma_f32_32x32x16_bf16 v[48:63], v[212:215], v[88:91], v[48:63]
    ds_read_b64_tr_b16 v[112:113], v12 offset:16896
    ds_read_b64_tr_b16 v[114:115], v12 offset:17152
    s_barrier
    s_waitcnt lgkmcnt(6)
    v_mfma_f32_32x32x16_bf16 v[16:31], v[92:95], v[216:219], v[16:31]
    v_add_u32 v1, 0xffff8000, v1
    v_add_u32 v2, 0xffff8000, v2
    v_add_u32 v3, 0xffff8000, v3
    v_add_u32 v4, 0xffff8000, v4
    v_add_u32 v5, 0xffff8000, v5
    v_add_u32 v6, 0xffff8000, v6
    v_add_u32 v7, 0xffff8000, v7
    v_add_u32 v8, 0xffff8000, v8
    ds_read_b128 v[224:227], v1 offset:0
    ds_read_b128 v[228:231], v2 offset:0
    ds_read_b128 v[232:235], v3 offset:0
    ds_read_b128 v[236:239], v4 offset:0
    ds_read_b128 v[240:243], v5 offset:0
    ds_read_b128 v[244:247], v6 offset:0
    ds_read_b128 v[248:251], v7 offset:0
    ds_read_b128 v[252:255], v8 offset:0
    v_add_u32 v9, 0x00018000, v9
    v_add_u32 v10, 0x00018000, v10
    v_add_u32 v11, 0x00018000, v11
    v_add_u32 v12, 0x00018000, v12
    ds_read_b64_tr_b16 v[80:81], v9 offset:0
    ds_read_b64_tr_b16 v[82:83], v9 offset:256
    v_mfma_f32_32x32x16_bf16 v[32:47], v[96:99], v[216:219], v[32:47]
    ds_read_b64_tr_b16 v[84:85], v9 offset:512
    ds_read_b64_tr_b16 v[86:87], v9 offset:768
    v_mfma_f32_32x32x16_bf16 v[48:63], v[216:219], v[100:103], v[48:63]
    ds_read_b64_tr_b16 v[88:89], v9 offset:16384
    ds_read_b64_tr_b16 v[90:91], v9 offset:16640
    s_waitcnt lgkmcnt(14)
    v_mfma_f32_32x32x16_bf16 v[16:31], v[104:107], v[220:223], v[16:31]
    ds_read_b64_tr_b16 v[92:93], v9 offset:8192
    ds_read_b64_tr_b16 v[94:95], v9 offset:8448
    v_mfma_f32_32x32x16_bf16 v[32:47], v[108:111], v[220:223], v[32:47]
    ds_read_b64_tr_b16 v[96:97], v9 offset:8704
    ds_read_b64_tr_b16 v[98:99], v9 offset:8960
    v_mfma_f32_32x32x16_bf16 v[48:63], v[220:223], v[112:115], v[48:63]
    ds_read_b64_tr_b16 v[100:101], v9 offset:16896
    ds_read_b64_tr_b16 v[102:103], v9 offset:17152
    s_waitcnt lgkmcnt(12)
    v_dot2c_f32_bf16 v64, s3, v224
    v_dot2c_f32_bf16 v70, v224, v224
    v_dot2c_f32_bf16 v65, s3, v225
    v_dot2c_f32_bf16 v71, v225, v225
    v_dot2c_f32_bf16 v66, s3, v226
    v_dot2c_f32_bf16 v72, v226, v226
    v_dot2c_f32_bf16 v67, s3, v227
    v_dot2c_f32_bf16 v73, v227, v227
    v_dot2c_f32_bf16 v68, s3, v228
    v_dot2c_f32_bf16 v74, v228, v228
    v_dot2c_f32_bf16 v69, s3, v229
    v_dot2c_f32_bf16 v75, v229, v229
    v_dot2c_f32_bf16 v64, s3, v230
    v_dot2c_f32_bf16 v70, v230, v230
    v_dot2c_f32_bf16 v65, s3, v231
    v_dot2c_f32_bf16 v71, v231, v231
    v_dot2c_f32_bf16 v66, s3, v232
    v_dot2c_f32_bf16 v72, v232, v232
    v_dot2c_f32_bf16 v67, s3, v233
    v_dot2c_f32_bf16 v73, v233, v233
    v_dot2c_f32_bf16 v68, s3, v234
    v_dot2c_f32_bf16 v74, v234, v234
    v_dot2c_f32_bf16 v69, s3, v235
    v_dot2c_f32_bf16 v75, v235, v235
    v_dot2c_f32_bf16 v64, s3, v236
    v_dot2c_f32_bf16 v70, v236, v236
    v_dot2c_f32_bf16 v65, s3, v237
    v_dot2c_f32_bf16 v71, v237, v237
    v_dot2c_f32_bf16 v66, s3, v238
    v_dot2c_f32_bf16 v72, v238, v238
    v_dot2c_f32_bf16 v67, s3, v239
    v_dot2c_f32_bf16 v73, v239, v239
    v_dot2c_f32_bf16 v68, s3, v240
    v_dot2c_f32_bf16 v74, v240, v240
    v_dot2c_f32_bf16 v69, s3, v241
    v_dot2c_f32_bf16 v75, v241, v241
    v_dot2c_f32_bf16 v64, s3, v242
    v_dot2c_f32_bf16 v70, v242, v242
    v_dot2c_f32_bf16 v65, s3, v243
    v_dot2c_f32_bf16 v71, v243, v243
    v_dot2c_f32_bf16 v66, s3, v244
    v_dot2c_f32_bf16 v72, v244, v244
    v_dot2c_f32_bf16 v67, s3, v245
    v_dot2c_f32_bf16 v73, v245, v245
    v_dot2c_f32_bf16 v68, s3, v246
    v_dot2c_f32_bf16 v74, v246, v246
    v_dot2c_f32_bf16 v69, s3, v247
    v_dot2c_f32_bf16 v75, v247, v247
    v_dot2c_f32_bf16 v64, s3, v248
    v_dot2c_f32_bf16 v70, v248, v248
    v_dot2c_f32_bf16 v65, s3, v249
    v_dot2c_f32_bf16 v71, v249, v249
    v_dot2c_f32_bf16 v66, s3, v250
    v_dot2c_f32_bf16 v72, v250, v250
    v_dot2c_f32_bf16 v67, s3, v251
    v_dot2c_f32_bf16 v73, v251, v251
    v_dot2c_f32_bf16 v68, s3, v252
    v_dot2c_f32_bf16 v74, v252, v252
    v_dot2c_f32_bf16 v69, s3, v253
    v_dot2c_f32_bf16 v75, v253, v253
    v_dot2c_f32_bf16 v64, s3, v254
    v_dot2c_f32_bf16 v70, v254, v254
    v_dot2c_f32_bf16 v65, s3, v255
    v_dot2c_f32_bf16 v71, v255, v255
    s_waitcnt lgkmcnt(6)
    v_mfma_f32_32x32x16_bf16 v[16:31], v[80:83], v[224:227], v[16:31]
    v_mfma_f32_16x16x32_bf16 v[116:119], v[76:79], v[80:83], v[116:119]
    ds_read_b64_tr_b16 v[104:105], v10 offset:0
    ds_read_b64_tr_b16 v[106:107], v10 offset:256
    v_add_f32 v64, v64, v67
    v_add_f32 v65, v65, v68
    v_mfma_f32_32x32x16_bf16 v[32:47], v[84:87], v[224:227], v[32:47]
    v_mfma_f32_16x16x32_bf16 v[120:123], v[76:79], v[84:87], v[120:123]
    ds_read_b64_tr_b16 v[108:109], v10 offset:512
    ds_read_b64_tr_b16 v[110:111], v10 offset:768
    v_add_f32 v66, v66, v69
    v_add_f32 v70, v70, v73
    v_add_f32 v71, v71, v74
    v_mfma_f32_32x32x16_bf16 v[48:63], v[224:227], v[88:91], v[48:63]
    v_mfma_f32_16x16x32_bf16 v[124:127], v[76:79], v[88:91], v[124:127]
    ds_read_b64_tr_b16 v[112:113], v10 offset:16384
    ds_read_b64_tr_b16 v[114:115], v10 offset:16640
    v_add_f32 v72, v72, v75
    v_add_f32 v64, v64, v65
    s_waitcnt lgkmcnt(6)
    v_mfma_f32_32x32x16_bf16 v[16:31], v[92:95], v[240:243], v[16:31]
    v_mfma_f32_16x16x32_bf16 v[116:119], v[76:79], v[92:95], v[116:119]
    ds_read_b64_tr_b16 v[80:81], v11 offset:0
    ds_read_b64_tr_b16 v[82:83], v11 offset:256
    v_add_f32 v70, v70, v71
    v_add_f32 v64, v64, v66
    v_mfma_f32_32x32x16_bf16 v[32:47], v[96:99], v[240:243], v[32:47]
    v_mfma_f32_16x16x32_bf16 v[120:123], v[76:79], v[96:99], v[120:123]
    ds_read_b64_tr_b16 v[84:85], v11 offset:512
    ds_read_b64_tr_b16 v[86:87], v11 offset:768
    v_add_f32 v70, v70, v72
    v_mov_b32 v65, v64
    v_mov_b32 v71, v70
    v_mfma_f32_32x32x16_bf16 v[48:63], v[240:243], v[100:103], v[48:63]
    v_mfma_f32_16x16x32_bf16 v[124:127], v[76:79], v[100:103], v[124:127]
    ds_read_b64_tr_b16 v[88:89], v11 offset:16384
    ds_read_b64_tr_b16 v[90:91], v11 offset:16640
    s_nop 0
    v_permlane32_swap_b32 v64, v65
    s_waitcnt lgkmcnt(6)
    v_mfma_f32_32x32x16_bf16 v[16:31], v[104:107], v[228:231], v[16:31]
    ds_read_b64_tr_b16 v[92:93], v12 offset:0
    ds_read_b64_tr_b16 v[94:95], v12 offset:256
    v_permlane32_swap_b32 v70, v71
    v_add_f32 v64, v64, v65
    v_mfma_f32_32x32x16_bf16 v[32:47], v[108:111], v[228:231], v[32:47]
    v_and_b32 v73, 15, v0
    v_lshlrev_b32 v73, 3, v73
    s_lshl_b32 s58, s52, 7
    s_add_u32 s58, s58, 131072
    v_add_u32 v73, s58, v73
    s_mov_b64 exec, 0xffff
    ds_write_b64 v73, v[116:117] offset:30080
    ds_write_b64 v73, v[120:121] offset:30592
    ds_write_b64 v73, v[124:125] offset:31104
    s_mov_b64 exec, -1
    s_lshl_b32 s58, s52, 2
    s_add_u32 s58, s58, 161104
    v_mov_b32 v74, s58
    ds_write_b32 v74, v74
    v_mov_b32 v74, 161104
    ds_read_b64_tr_b16 v[96:97], v12 offset:512
    ds_read_b64_tr_b16 v[98:99], v12 offset:768
    v_add_f32 v70, v70, v71
    v_mul_f32 v64, 0x3b000000, v64
    v_mul_f32 v70, 0x3b000000, v70
    v_mfma_f32_32x32x16_bf16 v[48:63], v[228:231], v[112:115], v[48:63]
    ds_read_b64_tr_b16 v[100:101], v12 offset:16384
    ds_read_b64_tr_b16 v[102:103], v12 offset:16640
    v_cvt_pk_bf16_f32 v13, v64, v64
    v_fma_f32 v70, -v64, v64, v70
    s_waitcnt lgkmcnt(10)
    v_mfma_f32_32x32x16_bf16 v[16:31], v[80:83], v[232:235], v[16:31]
    ds_read_b64_tr_b16 v[104:105], v10 offset:8192
    ds_read_b64_tr_b16 v[106:107], v10 offset:8448
    v_xor_b32 v13, 0x80008000, v13
    v_bfe_u32 v67, v0, 5, 1
    v_mfma_f32_32x32x16_bf16 v[32:47], v[84:87], v[232:235], v[32:47]
    ds_read_b64_tr_b16 v[108:109], v10 offset:8704
    ds_read_b64_tr_b16 v[110:111], v10 offset:8960
    v_max_f32 v70, 0, v70
    v_cmp_eq_u32 vcc, 0, v67
    v_cvt_pk_bf16_f32 v70, v70, v70
    v_mfma_f32_32x32x16_bf16 v[48:63], v[232:235], v[88:91], v[48:63]
    ds_read_b64_tr_b16 v[112:113], v10 offset:16896
    ds_read_b64_tr_b16 v[114:115], v10 offset:17152
    v_and_b32 v70, s60, v70
    v_add_f32 v70, 0x3727c5ac, v70
    s_waitcnt lgkmcnt(6)
    v_mfma_f32_32x32x16_bf16 v[16:31], v[92:95], v[236:239], v[16:31]
    ds_read_b128 v[2:5], v74
    ds_read_b64_tr_b16 v[80:81], v11 offset:8192
    ds_read_b64_tr_b16 v[82:83], v11 offset:8448
    v_cvt_pk_bf16_f32 v70, v70, v70
    v_and_b32 v70, s60, v70
    v_sqrt_f32 v70, v70
    v_mfma_f32_32x32x16_bf16 v[32:47], v[96:99], v[236:239], v[32:47]
    ds_read_b64_tr_b16 v[84:85], v11 offset:8704
    ds_read_b64_tr_b16 v[86:87], v11 offset:8960
    v_cndmask_b32 v13, 0, v13, vcc
    v_cvt_pk_bf16_f32 v70, v70, v70
    v_and_b32 v70, s60, v70
    v_mfma_f32_32x32x16_bf16 v[48:63], v[236:239], v[100:103], v[48:63]
    ds_read_b64_tr_b16 v[88:89], v11 offset:16896
    ds_read_b64_tr_b16 v[90:91], v11 offset:17152
    v_rcp_f32 v14, v70
    v_and_b32 v1, 63, v0
    v_lshlrev_b32 v1, 4, v1
    s_waitcnt lgkmcnt(7)
    v_mfma_f32_32x32x16_bf16 v[16:31], v[104:107], v[244:247], v[16:31]
    s_waitcnt lgkmcnt(6)
    v_min3_u32 v2, v2, v3, v4
    v_min_u32 v2, v2, v5
    s_nop 0
    v_readfirstlane_b32 s58, v2
    s_nop 1
    s_cmp_ge_u32 s58, 1
    s_cbranch_scc0 parallel_sum__mha_block__glu_gated_geglu__prompt_kernel_gsq
parallel_sum__mha_block__glu_gated_geglu__prompt_kernel_grq:
    v_and_b32 v73, 15, v0
    v_lshlrev_b32 v73, 3, v73
    v_bfe_u32 v116, v0, 4, 1
    v_lshl_add_u32 v73, v116, 2, v73
    v_add_u32 v73, 161152, v73
    ds_read2_b32 v[116:117], v73 offset0:0 offset1:32
    ds_read2_b32 v[118:119], v73 offset0:64 offset1:96
    ds_read2_b32 v[120:121], v73 offset0:128 offset1:160
    ds_read2_b32 v[122:123], v73 offset0:192 offset1:224
    v_add_u32 v73, 1024, v73
    ds_read2_b32 v[124:125], v73 offset0:0 offset1:32
    ds_read2_b32 v[126:127], v73 offset0:64 offset1:96
    ds_read_b64_tr_b16 v[92:93], v12 offset:8192
    ds_read_b64_tr_b16 v[94:95], v12 offset:8448
    v_mul_f32 v15, v70, v70
    v_and_b32 v72, 31, v0
    v_mfma_f32_32x32x16_bf16 v[32:47], v[108:111], v[244:247], v[32:47]
    ds_read_b64_tr_b16 v[96:97], v12 offset:8704
    ds_read_b64_tr_b16 v[98:99], v12 offset:8960
    v_lshlrev_b32 v72, 2, v72
    s_lshl_b32 s57, s52, 7
    s_add_u32 s57, s57, 160512
    v_mfma_f32_32x32x16_bf16 v[48:63], v[244:247], v[112:115], v[48:63]
    ds_read_b64_tr_b16 v[100:101], v12 offset:16896
    ds_read_b64_tr_b16 v[102:103], v12 offset:17152
    v_add_u32 v72, s57, v72
    ds_write_b32 v72, v14
    s_waitcnt lgkmcnt(13)
    v_mfma_f32_32x32x16_bf16 v[16:31], v[80:83], v[248:251], v[16:31]
    s_waitcnt lgkmcnt(7)
    v_add_f32 v116, v116, v117
    v_add_f32 v118, v118, v119
    v_add_f32 v118, v118, v116
    v_cvt_pk_bf16_f32 v116, v118, v118
    v_and_b32 v116, s60, v116
    v_sub_f32 v118, v118, v116
    v_cvt_pk_bf16_f32 v117, v118, v118
    v_mfma_f32_32x32x16_bf16 v[32:47], v[84:87], v[248:251], v[32:47]
    v_and_b32 v119, s60, v117
    v_sub_f32 v118, v118, v119
    v_and_b32 v117, 0xffff, v117
    v_or_b32 v116, v116, v117
    v_cvt_pk_bf16_f32 v117, v118, v118
    v_mov_b32 v118, 0
    v_mov_b32 v119, 0
    v_mfma_f32_32x32x16_bf16 v[48:63], v[248:251], v[88:91], v[48:63]
    v_add_f32 v120, v120, v121
    v_add_f32 v122, v122, v123
    v_add_f32 v122, v122, v120
    v_cvt_pk_bf16_f32 v120, v122, v122
    v_and_b32 v120, s60, v120
    v_sub_f32 v122, v122, v120
    v_cvt_pk_bf16_f32 v121, v122, v122
    s_waitcnt lgkmcnt(1)
    v_mfma_f32_32x32x16_bf16 v[16:31], v[92:95], v[252:255], v[16:31]
    v_and_b32 v123, s60, v121
    v_sub_f32 v122, v122, v123
    v_and_b32 v121, 0xffff, v121
    v_or_b32 v120, v120, v121
    v_cvt_pk_bf16_f32 v121, v122, v122
    v_mov_b32 v122, 0
    v_mov_b32 v123, 0
    v_add_f32 v124, v124, v125
    v_mfma_f32_32x32x16_bf16 v[32:47], v[96:99], v[252:255], v[32:47]
    v_add_f32 v126, v126, v127
    v_add_f32 v126, v126, v124
    v_cvt_pk_bf16_f32 v124, v126, v126
    v_and_b32 v124, s60, v124
    v_sub_f32 v126, v126, v124
    v_cvt_pk_bf16_f32 v125, v126, v126
    v_and_b32 v127, s60, v125
    v_sub_f32 v126, v126, v127
    v_and_b32 v125, 0xffff, v125
    v_mfma_f32_32x32x16_bf16 v[48:63], v[252:255], v[100:103], v[48:63]
    v_or_b32 v124, v124, v125
    v_cvt_pk_bf16_f32 v125, v126, v126
    v_mov_b32 v126, 0
    v_mov_b32 v127, 0
    v_mov_b32 v68, v13
    v_and_b32 v69, 0xffff, v13
    v_mov_b32 v70, 0
    v_mov_b32 v71, 0
    s_nop 1
    v_mfma_f32_32x32x16_bf16 v[32:47], v[120:123], v[68:71], v[32:47]
    v_mfma_f32_32x32x16_bf16 v[16:31], v[116:119], v[68:71], v[16:31]
    v_mfma_f32_32x32x16_bf16 v[48:63], v[68:71], v[124:127], v[48:63]
    v_bfe_u32 v64, v0, 5, 1
    v_lshlrev_b32 v65, 4, v64
    s_lshl_b32 s57, s52, 7
    s_add_u32 s57, s57, 160512
    v_add_u32 v65, s57, v65
    ds_read_b128 v[80:83], v65 offset:0
    ds_read_b128 v[84:87], v65 offset:32
    ds_read_b128 v[88:91], v65 offset:64
    ds_read_b128 v[92:95], v65 offset:96
    v_mul_f32 v8, s11, v14
    v_bfe_u32 v66, v0, 4, 1
    v_lshlrev_b32 v66, 16, v66
    v_lshl_add_u32 v66, v64, 8, v66
    v_and_b32 v67, 15, v0
    v_lshl_add_u32 v66, v67, 4, v66
    v_mul_f32 v32, v8, v32
    v_mul_f32 v33, v8, v33
    v_mul_f32 v34, v8, v34
    v_mul_f32 v35, v8, v35
    v_mul_f32 v36, v8, v36
    v_mul_f32 v37, v8, v37
    v_mul_f32 v38, v8, v38
    v_mul_f32 v39, v8, v39
    v_cvt_pk_bf16_f32 v32, v32, v33
    v_cvt_pk_bf16_f32 v33, v34, v35
    v_cvt_pk_bf16_f32 v34, v36, v37
    v_cvt_pk_bf16_f32 v35, v38, v39
    s_add_u32 s57, s5, 131072
    buffer_store_dwordx4 v[32:35], v1, s[36:39], s57 offen sc1
    v_mul_f32 v40, v8, v40
    v_mul_f32 v41, v8, v41
    v_mul_f32 v42, v8, v42
    v_mul_f32 v43, v8, v43
    v_mul_f32 v44, v8, v44
    v_mul_f32 v45, v8, v45
    v_mul_f32 v46, v8, v46
    v_mul_f32 v47, v8, v47
    v_cvt_pk_bf16_f32 v40, v40, v41
    v_cvt_pk_bf16_f32 v41, v42, v43
    v_cvt_pk_bf16_f32 v42, v44, v45
    v_cvt_pk_bf16_f32 v43, v46, v47
    s_add_u32 s57, s5, 196608
    buffer_store_dwordx4 v[40:43], v1, s[36:39], s57 offen sc1
    v_mul_f32 v16, v8, v16
    v_mul_f32 v17, v8, v17
    v_mul_f32 v18, v8, v18
    v_mul_f32 v19, v8, v19
    v_mul_f32 v20, v8, v20
    v_mul_f32 v21, v8, v21
    v_mul_f32 v22, v8, v22
    v_mul_f32 v23, v8, v23
    v_cvt_pk_bf16_f32 v16, v16, v17
    v_cvt_pk_bf16_f32 v17, v18, v19
    v_cvt_pk_bf16_f32 v18, v20, v21
    v_cvt_pk_bf16_f32 v19, v22, v23
    s_add_u32 s57, s5, 0
    buffer_store_dwordx4 v[16:19], v1, s[36:39], s57 offen sc1
    v_mul_f32 v24, v8, v24
    v_mul_f32 v25, v8, v25
    v_mul_f32 v26, v8, v26
    v_mul_f32 v27, v8, v27
    v_mul_f32 v28, v8, v28
    v_mul_f32 v29, v8, v29
    v_mul_f32 v30, v8, v30
    v_mul_f32 v31, v8, v31
    v_cvt_pk_bf16_f32 v24, v24, v25
    v_cvt_pk_bf16_f32 v25, v26, v27
    v_cvt_pk_bf16_f32 v26, v28, v29
    v_cvt_pk_bf16_f32 v27, v30, v31
    s_add_u32 s57, s5, 65536
    buffer_store_dwordx4 v[24:27], v1, s[36:39], s57 offen sc1
    s_waitcnt lgkmcnt(0)
    v_mul_f32 v48, v80, v48
    v_mul_f32 v49, v81, v49
    v_mul_f32 v50, v82, v50
    v_mul_f32 v51, v83, v51
    v_mul_f32 v52, v84, v52
    v_mul_f32 v53, v85, v53
    v_mul_f32 v54, v86, v54
    v_mul_f32 v55, v87, v55
    v_cvt_pk_bf16_f32 v48, v48, v49
    v_cvt_pk_bf16_f32 v49, v50, v51
    v_cvt_pk_bf16_f32 v50, v52, v53
    v_cvt_pk_bf16_f32 v51, v54, v55
    buffer_store_dwordx4 v[48:51], v66, s[36:39], s10 offen offset:0 sc1
    v_mul_f32 v56, v88, v56
    v_mul_f32 v57, v89, v57
    v_mul_f32 v58, v90, v58
    v_mul_f32 v59, v91, v59
    v_mul_f32 v60, v92, v60
    v_mul_f32 v61, v93, v61
    v_mul_f32 v62, v94, v62
    v_mul_f32 v63, v95, v63
    v_cvt_pk_bf16_f32 v56, v56, v57
    v_cvt_pk_bf16_f32 v57, v58, v59
    v_cvt_pk_bf16_f32 v58, v60, v61
    v_cvt_pk_bf16_f32 v59, v62, v63
    buffer_store_dwordx4 v[56:59], v66, s[36:39], s10 offen offset:512 sc1
    v_bfe_u32 v64, v0, 2, 2
    v_bfe_u32 v65, v0, 5, 1
    v_lshl_add_u32 v64, v65, 4, v64
    v_lshlrev_b32 v64, 6, v64
    v_and_b32 v65, 3, v0
    v_lshl_add_u32 v64, v65, 3, v64
    v_bfe_u32 v65, v0, 4, 1
    v_mul_u32_u24 v65, 8224, v65
    v_add_u32 v64, v64, v65
    s_xor_b32 s3, s52, 0
    s_lshl_b32 s3, s3, 11
    v_add_u32 v2, s3, v64
    s_xor_b32 s3, s52, 1
    s_lshl_b32 s3, s3, 11
    v_add_u32 v3, s3, v64
    s_xor_b32 s3, s52, 2
    s_lshl_b32 s3, s3, 11
    v_add_u32 v4, s3, v64
    s_xor_b32 s3, s52, 3
    s_lshl_b32 s3, s3, 11
    v_add_u32 v5, s3, v64
    v_bfe_u32 v64, v0, 2, 3
    v_bfe_u32 v65, v0, 5, 1
    v_mul_u32_u24 v6, 3584, v64
    v_lshl_add_u32 v6, v65, 6, v6
    v_and_b32 v64, 3, v0
    v_lshl_add_u32 v6, v64, 4, v6
    v_bfe_u32 v64, v0, 2, 3
    v_bfe_u32 v65, v0, 5, 1
    v_lshl_add_u32 v64, v65, 6, v64
    v_mul_u32_u24 v7, 3584, v64
    v_and_b32 v64, 3, v0
    v_lshl_add_u32 v7, v64, 4, v7
    v_mov_b32 v64, 161088
    s_mov_b32 s59, 200000
parallel_sum__mha_block__glu_gated_geglu__prompt_kernel_nw:
    ds_read_b32 v65, v64
    s_sub_u32 s59, s59, 1
    s_cmp_eq_u32 s59, 0
    s_waitcnt lgkmcnt(0)
    s_cbranch_scc1 parallel_sum__mha_block__glu_gated_geglu__prompt_kernel_nw_x
    v_readfirstlane_b32 s58, v65
    s_nop 1
    s_cmp_ge_u32 s58, 1
    s_cbranch_scc1 parallel_sum__mha_block__glu_gated_geglu__prompt_kernel_nw_x
    s_sleep 1
    s_branch parallel_sum__mha_block__glu_gated_geglu__prompt_kernel_nw
parallel_sum__mha_block__glu_gated_geglu__prompt_kernel_nw_x:
    s_mov_b32 s61, s58
    v_mov_b32 v64, 161080
    ds_read_b32 v65, v64
    s_waitcnt lgkmcnt(0)
    v_readfirstlane_b32 s58, v65
    s_nop 1
    s_cmp_ge_u32 s58, 4
    s_cbranch_scc1 parallel_sum__mha_block__glu_gated_geglu__prompt_kernel_g0ok
    s_waitcnt vmcnt(0)
    s_lshl_b32 s58, s52, 2
    s_add_u32 s58, s58, 161120
    v_mov_b32 v64, s58
    ds_write_b32 v64, v64
    v_mov_b32 v64, 161080
    s_mov_b32 s59, 200000
parallel_sum__mha_block__glu_gated_geglu__prompt_kernel_g0w:
    ds_read_b32 v65, v64
    s_sub_u32 s59, s59, 1
    s_cmp_eq_u32 s59, 0
    s_waitcnt lgkmcnt(0)
    s_cbranch_scc1 parallel_sum__mha_block__glu_gated_geglu__prompt_kernel_g0w_x
    v_readfirstlane_b32 s58, v65
    s_nop 1
    s_cmp_ge_u32 s58, 4
    s_cbranch_scc1 parallel_sum__mha_block__glu_gated_geglu__prompt_kernel_g0w_x
    s_sleep 1
    s_branch parallel_sum__mha_block__glu_gated_geglu__prompt_kernel_g0w
parallel_sum__mha_block__glu_gated_geglu__prompt_kernel_g0w_x:
parallel_sum__mha_block__glu_gated_geglu__prompt_kernel_g0ok:
    v_add_u32 v2, 0x00010000, v2
    v_add_u32 v3, 0x00010000, v3
    v_add_u32 v4, 0x00010000, v4
    v_add_u32 v5, 0x00010000, v5
    ds_read_b64_tr_b16 v[80:81], v2 offset:0
    ds_read_b64_tr_b16 v[82:83], v2 offset:256
    ds_read_b64_tr_b16 v[84:85], v2 offset:32
    ds_read_b64_tr_b16 v[86:87], v2 offset:288
    ds_read_b64_tr_b16 v[88:89], v2 offset:512
    ds_read_b64_tr_b16 v[90:91], v2 offset:768
    ds_read_b64_tr_b16 v[92:93], v2 offset:544
    ds_read_b64_tr_b16 v[94:95], v2 offset:800
    ds_read_b64_tr_b16 v[96:97], v3 offset:0
    ds_read_b64_tr_b16 v[98:99], v3 offset:256
    v_mov_b32 v120, v76
    v_mov_b32 v121, v77
    v_mov_b32 v122, v78
    v_mov_b32 v123, v79
    v_mul_f32 v8, 0xc0135761, v14
    v_mul_f32 v64, v14, v14
    v_mul_f32 v64, v64, v14
    v_mul_f32 v14, 0xbdd2d3e8, v64
    s_lshl_b32 s56, s52, 2
    s_add_u32 s56, s56, 161024
    v_mov_b32 v9, s56
    v_mov_b32 v10, 161024
    s_setprio 0
    s_waitcnt lgkmcnt(8)
    v_mfma_f32_32x32x16_bf16 v[16:31], v[80:83], v[128:131], 0
    v_mfma_f32_16x16x32_bf16 v[104:107], v[120:123], v[80:83], 0
    s_setprio 3
    v_mov_b32 v11, 1
    ds_write_b32 v9, v11
    ds_read_b64_tr_b16 v[100:101], v3 offset:32
    ds_read_b64_tr_b16 v[102:103], v3 offset:288
    s_setprio 0
    s_waitcnt lgkmcnt(9)
    v_mfma_f32_32x32x16_bf16 v[32:47], v[84:87], v[128:131], 0
    v_mfma_f32_16x16x32_bf16 v[108:111], v[120:123], v[84:87], 0
    s_waitcnt vmcnt(0)
    ds_write_b32 v9, v9 offset:96
    ds_read_b64_tr_b16 v[80:81], v3 offset:512
    ds_read_b64_tr_b16 v[82:83], v3 offset:768
    s_waitcnt lgkmcnt(10)
    v_mfma_f32_32x32x16_bf16 v[48:63], v[88:91], v[128:131], 0
    v_mfma_f32_16x16x32_bf16 v[112:115], v[120:123], v[88:91], 0
    ds_read_b64_tr_b16 v[84:85], v3 offset:544
    ds_read_b64_tr_b16 v[86:87], v3 offset:800
    s_waitcnt lgkmcnt(10)
    v_mfma_f32_32x32x16_bf16 v[64:79], v[92:95], v[128:131], 0
    v_mfma_f32_16x16x32_bf16 v[116:119], v[120:123], v[92:95], 0
    ds_read_b64_tr_b16 v[88:89], v4 offset:0
    ds_read_b64_tr_b16 v[90:91], v4 offset:256
    s_waitcnt lgkmcnt(10)
    v_mfma_f32_32x32x16_bf16 v[16:31], v[96:99], v[132:135], v[16:31]
    ds_read_b64_tr_b16 v[92:93], v4 offset:32
    ds_read_b64_tr_b16 v[94:95], v4 offset:288
    s_waitcnt lgkmcnt(9)
    v_mfma_f32_32x32x16_bf16 v[32:47], v[100:103], v[132:135], v[32:47]
    ds_read_b64_tr_b16 v[96:97], v4 offset:512
    ds_read_b64_tr_b16 v[98:99], v4 offset:768
    s_waitcnt lgkmcnt(8)
    v_mfma_f32_32x32x16_bf16 v[48:63], v[80:83], v[132:135], v[48:63]
    ds_read_b128 v[124:127], v10
    ds_read_b64_tr_b16 v[100:101], v4 offset:544
    ds_read_b64_tr_b16 v[102:103], v4 offset:800
    s_waitcnt lgkmcnt(9)
    v_mfma_f32_32x32x16_bf16 v[64:79], v[84:87], v[132:135], v[64:79]
    ds_read_b64_tr_b16 v[80:81], v5 offset:0
    ds_read_b64_tr_b16 v[82:83], v5 offset:256
    s_waitcnt lgkmcnt(9)
    v_mfma_f32_32x32x16_bf16 v[16:31], v[88:91], v[136:139], v[16:31]
    s_waitcnt lgkmcnt(4)
    s_setprio 3
    v_min3_u32 v11, v124, v125, v126
    v_min_u32 v11, v11, v127
    ds_read_b64_tr_b16 v[84:85], v5 offset:32
    ds_read_b64_tr_b16 v[86:87], v5 offset:288
    s_setprio 0
    s_waitcnt lgkmcnt(9)
    v_mfma_f32_32x32x16_bf16 v[32:47], v[92:95], v[136:139], v[32:47]
    s_setprio 3
    v_readfirstlane_b32 s58, v11
    ds_read_b64_tr_b16 v[88:89], v5 offset:512
    ds_read_b64_tr_b16 v[90:91], v5 offset:768
    s_setprio 0
    s_waitcnt lgkmcnt(9)
    v_mfma_f32_32x32x16_bf16 v[48:63], v[96:99], v[136:139], v[48:63]
    s_cmp_ge_u32 s58, 1
    s_cbranch_scc0 parallel_sum__mha_block__glu_gated_geglu__prompt_kernel_gs1
parallel_sum__mha_block__glu_gated_geglu__prompt_kernel_gr1:
    ds_read_b64_tr_b16 v[92:93], v5 offset:544
    ds_read_b64_tr_b16 v[94:95], v5 offset:800
    s_waitcnt lgkmcnt(8)
    v_mfma_f32_32x32x16_bf16 v[64:79], v[100:103], v[136:139], v[64:79]
    ds_read_b64_tr_b16 v[96:97], v2 offset:57344
    ds_read_b64_tr_b16 v[98:99], v2 offset:57600
    s_waitcnt lgkmcnt(8)
    v_mfma_f32_32x32x16_bf16 v[16:31], v[80:83], v[140:143], v[16:31]
    ds_read_b64_tr_b16 v[100:101], v2 offset:57376
    ds_read_b64_tr_b16 v[102:103], v2 offset:57632
    s_waitcnt lgkmcnt(8)
    v_mfma_f32_32x32x16_bf16 v[32:47], v[84:87], v[140:143], v[32:47]
    ds_read_b64_tr_b16 v[80:81], v2 offset:57856
    ds_read_b64_tr_b16 v[82:83], v2 offset:58112
    s_waitcnt lgkmcnt(8)
    v_mfma_f32_32x32x16_bf16 v[48:63], v[88:91], v[140:143], v[48:63]
    ds_read_b64_tr_b16 v[84:85], v2 offset:57888
    ds_read_b64_tr_b16 v[86:87], v2 offset:58144
    s_waitcnt lgkmcnt(8)
    v_mfma_f32_32x32x16_bf16 v[64:79], v[92:95], v[140:143], v[64:79]
    ds_read_b64_tr_b16 v[88:89], v3 offset:57344
    ds_read_b64_tr_b16 v[90:91], v3 offset:57600
    s_waitcnt lgkmcnt(8)
    v_mfma_f32_32x32x16_bf16 v[16:31], v[96:99], v[144:147], v[16:31]
    v_mfma_f32_16x16x32_bf16 v[104:107], v[120:123], v[96:99], v[104:107]
    s_setprio 3
    v_mov_b32 v11, 2
    ds_write_b32 v9, v11
    ds_read_b64_tr_b16 v[92:93], v3 offset:57376
    ds_read_b64_tr_b16 v[94:95], v3 offset:57632
    s_setprio 0
    s_waitcnt lgkmcnt(9)
    v_mfma_f32_32x32x16_bf16 v[32:47], v[100:103], v[144:147], v[32:47]
    v_mfma_f32_16x16x32_bf16 v[108:111], v[120:123], v[100:103], v[108:111]
    ds_read_b64_tr_b16 v[96:97], v3 offset:57856
    ds_read_b64_tr_b16 v[98:99], v3 offset:58112
    s_waitcnt lgkmcnt(9)
    v_mfma_f32_32x32x16_bf16 v[48:63], v[80:83], v[144:147], v[48:63]
    v_mfma_f32_16x16x32_bf16 v[112:115], v[120:123], v[80:83], v[112:115]
    ds_read_b64_tr_b16 v[100:101], v3 offset:57888
    ds_read_b64_tr_b16 v[102:103], v3 offset:58144
    s_waitcnt lgkmcnt(9)
    v_mfma_f32_32x32x16_bf16 v[64:79], v[84:87], v[144:147], v[64:79]
    v_mfma_f32_16x16x32_bf16 v[116:119], v[120:123], v[84:87], v[116:119]
    ds_read_b64_tr_b16 v[80:81], v4 offset:57344
    ds_read_b64_tr_b16 v[82:83], v4 offset:57600
    s_waitcnt lgkmcnt(9)
    v_mfma_f32_32x32x16_bf16 v[16:31], v[88:91], v[148:151], v[16:31]
    ds_read_b64_tr_b16 v[84:85], v4 offset:57376
    ds_read_b64_tr_b16 v[86:87], v4 offset:57632
    s_waitcnt lgkmcnt(8)
    v_mfma_f32_32x32x16_bf16 v[32:47], v[92:95], v[148:151], v[32:47]
    ds_read_b64_tr_b16 v[88:89], v4 offset:57856
    ds_read_b64_tr_b16 v[90:91], v4 offset:58112
    s_waitcnt lgkmcnt(8)
    v_mfma_f32_32x32x16_bf16 v[48:63], v[96:99], v[148:151], v[48:63]
    ds_read_b128 v[124:127], v10
    ds_read_b64_tr_b16 v[92:93], v4 offset:57888
    ds_read_b64_tr_b16 v[94:95], v4 offset:58144
    s_waitcnt lgkmcnt(9)
    v_mfma_f32_32x32x16_bf16 v[64:79], v[100:103], v[148:151], v[64:79]
    ds_read_b64_tr_b16 v[96:97], v5 offset:57344
    ds_read_b64_tr_b16 v[98:99], v5 offset:57600
    s_waitcnt lgkmcnt(9)
    v_mfma_f32_32x32x16_bf16 v[16:31], v[80:83], v[152:155], v[16:31]
    s_waitcnt lgkmcnt(4)
    s_setprio 3
    v_min3_u32 v11, v124, v125, v126
    v_min_u32 v11, v11, v127
    ds_read_b64_tr_b16 v[100:101], v5 offset:57376
    ds_read_b64_tr_b16 v[102:103], v5 offset:57632
    s_setprio 0
    s_waitcnt lgkmcnt(9)
    v_mfma_f32_32x32x16_bf16 v[32:47], v[84:87], v[152:155], v[32:47]
    s_setprio 3
    v_readfirstlane_b32 s58, v11
    ds_read_b64_tr_b16 v[80:81], v5 offset:57856
    ds_read_b64_tr_b16 v[82:83], v5 offset:58112
    s_setprio 0
    s_waitcnt lgkmcnt(9)
    v_mfma_f32_32x32x16_bf16 v[48:63], v[88:91], v[152:155], v[48:63]
    s_cmp_ge_u32 s58, 2
    s_cbranch_scc0 parallel_sum__mha_block__glu_gated_geglu__prompt_kernel_gs2
parallel_sum__mha_block__glu_gated_geglu__prompt_kernel_gr2:
    ds_read_b64_tr_b16 v[84:85], v5 offset:57888
    ds_read_b64_tr_b16 v[86:87], v5 offset:58144
    s_waitcnt lgkmcnt(8)
    v_mfma_f32_32x32x16_bf16 v[64:79], v[92:95], v[152:155], v[64:79]
    s_setprio 3
    v_add_u32 v2, 0x00012100, v2
    v_add_u32 v3, 0x00012100, v3
    v_add_u32 v4, 0x00012100, v4
    v_add_u32 v5, 0x00012100, v5
    ds_read_b64_tr_b16 v[88:89], v2 offset:0
    ds_read_b64_tr_b16 v[90:91], v2 offset:256
    s_setprio 0
    s_waitcnt lgkmcnt(8)
    v_mfma_f32_32x32x16_bf16 v[16:31], v[96:99], v[156:159], v[16:31]
    ds_read_b64_tr_b16 v[92:93], v2 offset:32
    ds_read_b64_tr_b16 v[94:95], v2 offset:288
    s_waitcnt lgkmcnt(8)
    v_mfma_f32_32x32x16_bf16 v[32:47], v[100:103], v[156:159], v[32:47]
    ds_read_b64_tr_b16 v[96:97], v2 offset:512
    ds_read_b64_tr_b16 v[98:99], v2 offset:768
    s_waitcnt lgkmcnt(8)
    v_mfma_f32_32x32x16_bf16 v[48:63], v[80:83], v[156:159], v[48:63]
    ds_read_b64_tr_b16 v[100:101], v2 offset:544
    ds_read_b64_tr_b16 v[102:103], v2 offset:800
    s_waitcnt lgkmcnt(8)
    v_mfma_f32_32x32x16_bf16 v[64:79], v[84:87], v[156:159], v[64:79]
    ds_read_b64_tr_b16 v[80:81], v3 offset:0
    ds_read_b64_tr_b16 v[82:83], v3 offset:256
    s_waitcnt lgkmcnt(8)
    v_mfma_f32_32x32x16_bf16 v[16:31], v[88:91], v[160:163], v[16:31]
    v_mfma_f32_16x16x32_bf16 v[104:107], v[120:123], v[88:91], v[104:107]
    s_setprio 3
    v_mov_b32 v11, 3
    ds_write_b32 v9, v11
    ds_read_b64_tr_b16 v[84:85], v3 offset:32
    ds_read_b64_tr_b16 v[86:87], v3 offset:288
    s_setprio 0
    s_waitcnt lgkmcnt(9)
    v_mfma_f32_32x32x16_bf16 v[32:47], v[92:95], v[160:163], v[32:47]
    v_mfma_f32_16x16x32_bf16 v[108:111], v[120:123], v[92:95], v[108:111]
    ds_read_b64_tr_b16 v[88:89], v3 offset:512
    ds_read_b64_tr_b16 v[90:91], v3 offset:768
    s_waitcnt lgkmcnt(9)
    v_mfma_f32_32x32x16_bf16 v[48:63], v[96:99], v[160:163], v[48:63]
    v_mfma_f32_16x16x32_bf16 v[112:115], v[120:123], v[96:99], v[112:115]
    ds_read_b64_tr_b16 v[92:93], v3 offset:544
    ds_read_b64_tr_b16 v[94:95], v3 offset:800
    s_waitcnt lgkmcnt(9)
    v_mfma_f32_32x32x16_bf16 v[64:79], v[100:103], v[160:163], v[64:79]
    v_mfma_f32_16x16x32_bf16 v[116:119], v[120:123], v[100:103], v[116:119]
    ds_read_b64_tr_b16 v[96:97], v4 offset:0
    ds_read_b64_tr_b16 v[98:99], v4 offset:256
    s_waitcnt lgkmcnt(9)
    v_mfma_f32_32x32x16_bf16 v[16:31], v[80:83], v[164:167], v[16:31]
    ds_read_b64_tr_b16 v[100:101], v4 offset:32
    ds_read_b64_tr_b16 v[102:103], v4 offset:288
    s_waitcnt lgkmcnt(8)
    v_mfma_f32_32x32x16_bf16 v[32:47], v[84:87], v[164:167], v[32:47]
    ds_read_b64_tr_b16 v[80:81], v4 offset:512
    ds_read_b64_tr_b16 v[82:83], v4 offset:768
    s_waitcnt lgkmcnt(8)
    v_mfma_f32_32x32x16_bf16 v[48:63], v[88:91], v[164:167], v[48:63]
    ds_read_b128 v[124:127], v10
    ds_read_b64_tr_b16 v[84:85], v4 offset:544
    ds_read_b64_tr_b16 v[86:87], v4 offset:800
    s_waitcnt lgkmcnt(9)
    v_mfma_f32_32x32x16_bf16 v[64:79], v[92:95], v[164:167], v[64:79]
    ds_read_b64_tr_b16 v[88:89], v5 offset:0
    ds_read_b64_tr_b16 v[90:91], v5 offset:256
    s_waitcnt lgkmcnt(9)
    v_mfma_f32_32x32x16_bf16 v[16:31], v[96:99], v[168:171], v[16:31]
    s_waitcnt lgkmcnt(4)
    s_setprio 3
    v_min3_u32 v11, v124, v125, v126
    v_min_u32 v11, v11, v127
    ds_read_b64_tr_b16 v[92:93], v5 offset:32
    ds_read_b64_tr_b16 v[94:95], v5 offset:288
    s_setprio 0
    s_waitcnt lgkmcnt(9)
    v_mfma_f32_32x32x16_bf16 v[32:47], v[100:103], v[168:171], v[32:47]
    s_setprio 3
    v_readfirstlane_b32 s58, v11
    ds_read_b64_tr_b16 v[96:97], v5 offset:512
    ds_read_b64_tr_b16 v[98:99], v5 offset:768
    s_setprio 0
    s_waitcnt lgkmcnt(9)
    v_mfma_f32_32x32x16_bf16 v[48:63], v[80:83], v[168:171], v[48:63]
    s_cmp_ge_u32 s58, 3
    s_cbranch_scc0 parallel_sum__mha_block__glu_gated_geglu__prompt_kernel_gs3
parallel_sum__mha_block__glu_gated_geglu__prompt_kernel_gr3:
    s_setprio 3
    v_mov_b32 v11, 161084
    s_mov_b32 s59, 200000
    s_setprio 0
parallel_sum__mha_block__glu_gated_geglu__prompt_kernel_g3w:
    ds_read_b32 v124, v11
    s_sub_u32 s59, s59, 1
    s_cmp_eq_u32 s59, 0
    s_waitcnt lgkmcnt(0)
    s_cbranch_scc1 parallel_sum__mha_block__glu_gated_geglu__prompt_kernel_g3w_x
    s_setprio 3
    v_readfirstlane_b32 s58, v124
    s_nop 1
    s_cmp_ge_u32 s58, 4
    s_setprio 0
    s_cbranch_scc1 parallel_sum__mha_block__glu_gated_geglu__prompt_kernel_g3w_x
    s_sleep 1
    s_branch parallel_sum__mha_block__glu_gated_geglu__prompt_kernel_g3w
parallel_sum__mha_block__glu_gated_geglu__prompt_kernel_g3w_x:
    ds_read_b64_tr_b16 v[100:101], v5 offset:544
    ds_read_b64_tr_b16 v[102:103], v5 offset:800
    s_waitcnt lgkmcnt(8)
    v_mfma_f32_32x32x16_bf16 v[64:79], v[84:87], v[168:171], v[64:79]
    s_setprio 3
    v_add_u32 v2, 0xfffddf00, v2
    v_add_u32 v3, 0xfffddf00, v3
    v_add_u32 v4, 0xfffddf00, v4
    v_add_u32 v5, 0xfffddf00, v5
    ds_read_b64_tr_b16 v[80:81], v2 offset:0
    ds_read_b64_tr_b16 v[82:83], v2 offset:256
    s_add_u32 m0, s14, 115456
    s_add_u32 s69, s99, s64
    s_add_u32 s56, s69, 0
    buffer_load_dwordx4 v6, s[28:31], s56 offen offset:0 lds
    s_setprio 0
    s_waitcnt lgkmcnt(8)
    v_mfma_f32_32x32x16_bf16 v[16:31], v[88:91], v[172:175], v[16:31]
    ds_read_b64_tr_b16 v[84:85], v2 offset:32
    ds_read_b64_tr_b16 v[86:87], v2 offset:288
    s_waitcnt lgkmcnt(8)
    v_mfma_f32_32x32x16_bf16 v[32:47], v[92:95], v[172:175], v[32:47]
    ds_read_b64_tr_b16 v[88:89], v2 offset:512
    ds_read_b64_tr_b16 v[90:91], v2 offset:768
    s_add_u32 s56, s69, 27648
    buffer_load_dwordx4 v6, s[28:31], s56 offen offset:1024 lds
    s_waitcnt lgkmcnt(8)
    v_mfma_f32_32x32x16_bf16 v[48:63], v[96:99], v[172:175], v[48:63]
    ds_read_b64_tr_b16 v[92:93], v2 offset:544
    ds_read_b64_tr_b16 v[94:95], v2 offset:800
    s_waitcnt lgkmcnt(8)
    v_mfma_f32_32x32x16_bf16 v[64:79], v[100:103], v[172:175], v[64:79]
    ds_read_b64_tr_b16 v[96:97], v3 offset:0
    ds_read_b64_tr_b16 v[98:99], v3 offset:256
    s_add_u32 s56, s69, 55296
    buffer_load_dwordx4 v6, s[28:31], s56 offen offset:2048 lds
    s_waitcnt lgkmcnt(8)
    v_mfma_f32_32x32x16_bf16 v[16:31], v[80:83], v[176:179], v[16:31]
    v_mfma_f32_16x16x32_bf16 v[104:107], v[120:123], v[80:83], v[104:107]
    s_setprio 3
    v_mov_b32 v11, 4
    ds_write_b32 v9, v11
    ds_read_b64_tr_b16 v[100:101], v3 offset:32
    ds_read_b64_tr_b16 v[102:103], v3 offset:288
    s_setprio 0
    s_waitcnt lgkmcnt(9)
    v_mfma_f32_32x32x16_bf16 v[32:47], v[84:87], v[176:179], v[32:47]
    v_mfma_f32_16x16x32_bf16 v[108:111], v[120:123], v[84:87], v[108:111]
    ds_read_b64_tr_b16 v[80:81], v3 offset:512
    ds_read_b64_tr_b16 v[82:83], v3 offset:768
    s_add_u32 s56, s69, 82944
    buffer_load_dwordx4 v6, s[28:31], s56 offen offset:3072 lds
    s_waitcnt lgkmcnt(9)
    v_mfma_f32_32x32x16_bf16 v[48:63], v[88:91], v[176:179], v[48:63]
    v_mfma_f32_16x16x32_bf16 v[112:115], v[120:123], v[88:91], v[112:115]
    ds_read_b64_tr_b16 v[84:85], v3 offset:544
    ds_read_b64_tr_b16 v[86:87], v3 offset:800
    s_waitcnt lgkmcnt(9)
    v_mfma_f32_32x32x16_bf16 v[64:79], v[92:95], v[176:179], v[64:79]
    v_mfma_f32_16x16x32_bf16 v[116:119], v[120:123], v[92:95], v[116:119]
    ds_read_b64_tr_b16 v[88:89], v4 offset:0
    ds_read_b64_tr_b16 v[90:91], v4 offset:256
    s_waitcnt lgkmcnt(9)
    v_mfma_f32_32x32x16_bf16 v[16:31], v[96:99], v[180:183], v[16:31]
    ds_read_b64_tr_b16 v[92:93], v4 offset:32
    ds_read_b64_tr_b16 v[94:95], v4 offset:288
    s_waitcnt lgkmcnt(8)
    v_mfma_f32_32x32x16_bf16 v[32:47], v[100:103], v[180:183], v[32:47]
    ds_read_b64_tr_b16 v[96:97], v4 offset:512
    ds_read_b64_tr_b16 v[98:99], v4 offset:768
    s_waitcnt lgkmcnt(8)
    v_mfma_f32_32x32x16_bf16 v[48:63], v[80:83], v[180:183], v[48:63]
    ds_read_b128 v[124:127], v10
    ds_read_b64_tr_b16 v[100:101], v4 offset:544
    ds_read_b64_tr_b16 v[102:103], v4 offset:800
    s_waitcnt lgkmcnt(9)
    v_mfma_f32_32x32x16_bf16 v[64:79], v[84:87], v[180:183], v[64:79]
    ds_read_b64_tr_b16 v[80:81], v5 offset:0
    ds_read_b64_tr_b16 v[82:83], v5 offset:256
    s_waitcnt lgkmcnt(9)
    v_mfma_f32_32x32x16_bf16 v[16:31], v[88:91], v[184:187], v[16:31]
    s_waitcnt lgkmcnt(4)
    s_setprio 3
    v_min3_u32 v11, v124, v125, v126
    v_min_u32 v11, v11, v127
    ds_read_b64_tr_b16 v[84:85], v5 offset:32
    ds_read_b64_tr_b16 v[86:87], v5 offset:288
    s_setprio 0
    s_waitcnt lgkmcnt(9)
    v_mfma_f32_32x32x16_bf16 v[32:47], v[92:95], v[184:187], v[32:47]
    s_setprio 3
    v_readfirstlane_b32 s58, v11
    ds_read_b64_tr_b16 v[88:89], v5 offset:512
    ds_read_b64_tr_b16 v[90:91], v5 offset:768
    s_setprio 0
    s_waitcnt lgkmcnt(9)
    v_mfma_f32_32x32x16_bf16 v[48:63], v[96:99], v[184:187], v[48:63]
    s_cmp_ge_u32 s58, 4
    s_cbranch_scc0 parallel_sum__mha_block__glu_gated_geglu__prompt_kernel_gs4
parallel_sum__mha_block__glu_gated_geglu__prompt_kernel_gr4:
    ds_read_b64_tr_b16 v[92:93], v5 offset:544
    ds_read_b64_tr_b16 v[94:95], v5 offset:800
    s_waitcnt lgkmcnt(8)
    v_mfma_f32_32x32x16_bf16 v[64:79], v[100:103], v[184:187], v[64:79]
    ds_read_b64_tr_b16 v[96:97], v2 offset:16640
    ds_read_b64_tr_b16 v[98:99], v2 offset:16896
    s_add_u32 m0, s14, 132096
    s_add_u32 s69, s99, s64
    s_add_u32 s56, s69, 229376
    buffer_load_dwordx4 v6, s[28:31], s56 offen offset:0 lds
    s_waitcnt lgkmcnt(8)
    v_mfma_f32_32x32x16_bf16 v[16:31], v[80:83], v[188:191], v[16:31]
    ds_read_b64_tr_b16 v[100:101], v2 offset:16672
    ds_read_b64_tr_b16 v[102:103], v2 offset:16928
    s_waitcnt lgkmcnt(8)
    v_mfma_f32_32x32x16_bf16 v[32:47], v[84:87], v[188:191], v[32:47]
    ds_read_b64_tr_b16 v[80:81], v2 offset:17152
    ds_read_b64_tr_b16 v[82:83], v2 offset:17408
    s_add_u32 s56, s69, 257024
    buffer_load_dwordx4 v6, s[28:31], s56 offen offset:1024 lds
    s_waitcnt lgkmcnt(8)
    v_mfma_f32_32x32x16_bf16 v[48:63], v[88:91], v[188:191], v[48:63]
    ds_read_b64_tr_b16 v[84:85], v2 offset:17184
    ds_read_b64_tr_b16 v[86:87], v2 offset:17440
    s_waitcnt lgkmcnt(8)
    v_mfma_f32_32x32x16_bf16 v[64:79], v[92:95], v[188:191], v[64:79]
    ds_read_b64_tr_b16 v[88:89], v3 offset:16640
    ds_read_b64_tr_b16 v[90:91], v3 offset:16896
    s_add_u32 s56, s69, 284672
    buffer_load_dwordx4 v6, s[28:31], s56 offen offset:2048 lds
    s_waitcnt lgkmcnt(8)
    v_mfma_f32_32x32x16_bf16 v[16:31], v[96:99], v[192:195], v[16:31]
    v_mfma_f32_16x16x32_bf16 v[104:107], v[120:123], v[96:99], v[104:107]
    s_setprio 3
    v_mov_b32 v11, 5
    ds_write_b32 v9, v11
    ds_read_b64_tr_b16 v[92:93], v3 offset:16672
    ds_read_b64_tr_b16 v[94:95], v3 offset:16928
    s_setprio 0
    s_waitcnt lgkmcnt(9)
    v_mfma_f32_32x32x16_bf16 v[32:47], v[100:103], v[192:195], v[32:47]
    v_mfma_f32_16x16x32_bf16 v[108:111], v[120:123], v[100:103], v[108:111]
    ds_read_b64_tr_b16 v[96:97], v3 offset:17152
    ds_read_b64_tr_b16 v[98:99], v3 offset:17408
    s_add_u32 s56, s69, 312320
    buffer_load_dwordx4 v6, s[28:31], s56 offen offset:3072 lds
    s_setprio 3
    v_bfe_u32 v124, v0, 2, 3
    v_bfe_u32 v125, v0, 5, 1
    s_setprio 0
    s_waitcnt lgkmcnt(9)
    v_mfma_f32_32x32x16_bf16 v[48:63], v[80:83], v[192:195], v[48:63]
    v_mfma_f32_16x16x32_bf16 v[112:115], v[120:123], v[80:83], v[112:115]
    ds_read_b64_tr_b16 v[100:101], v3 offset:17184
    ds_read_b64_tr_b16 v[102:103], v3 offset:17440
    s_and_b32 s3, s48, 1
    s_setprio 3
    v_xor_b32 v125, s3, v125
    v_lshl_add_u32 v124, v125, 7, v124
    s_setprio 0
    s_waitcnt lgkmcnt(9)
    v_mfma_f32_32x32x16_bf16 v[64:79], v[84:87], v[192:195], v[64:79]
    v_mfma_f32_16x16x32_bf16 v[116:119], v[120:123], v[84:87], v[116:119]
    ds_read_b64_tr_b16 v[80:81], v4 offset:16640
    ds_read_b64_tr_b16 v[82:83], v4 offset:16896
    s_setprio 3
    v_bfe_u32 v125, v0, 1, 1
    v_lshl_add_u32 v124, v125, 6, v124
    s_setprio 0
    s_waitcnt lgkmcnt(9)
    v_mfma_f32_32x32x16_bf16 v[16:31], v[88:91], v[196:199], v[16:31]
    ds_read_b64_tr_b16 v[84:85], v4 offset:16672
    ds_read_b64_tr_b16 v[86:87], v4 offset:16928
    s_setprio 3
    v_mul_u32_u24 v6, 3584, v124
    v_and_b32 v124, 1, v0
    v_lshl_add_u32 v6, v124, 4, v6
    s_setprio 0
    s_waitcnt lgkmcnt(8)
    v_mfma_f32_32x32x16_bf16 v[32:47], v[92:95], v[196:199], v[32:47]
    ds_read_b64_tr_b16 v[88:89], v4 offset:17152
    ds_read_b64_tr_b16 v[90:91], v4 offset:17408
    s_waitcnt lgkmcnt(8)
    v_mfma_f32_32x32x16_bf16 v[48:63], v[96:99], v[196:199], v[48:63]
    ds_read_b128 v[124:127], v10
    ds_read_b64_tr_b16 v[92:93], v4 offset:17184
    ds_read_b64_tr_b16 v[94:95], v4 offset:17440
    s_waitcnt lgkmcnt(9)
    v_mfma_f32_32x32x16_bf16 v[64:79], v[100:103], v[196:199], v[64:79]
    ds_read_b64_tr_b16 v[96:97], v5 offset:16640
    ds_read_b64_tr_b16 v[98:99], v5 offset:16896
    s_waitcnt lgkmcnt(9)
    v_mfma_f32_32x32x16_bf16 v[16:31], v[80:83], v[200:203], v[16:31]
    s_waitcnt lgkmcnt(4)
    s_setprio 3
    v_min3_u32 v11, v124, v125, v126
    v_min_u32 v11, v11, v127
    ds_read_b64_tr_b16 v[100:101], v5 offset:16672
    ds_read_b64_tr_b16 v[102:103], v5 offset:16928
    s_setprio 0
    s_waitcnt lgkmcnt(9)
    v_mfma_f32_32x32x16_bf16 v[32:47], v[84:87], v[200:203], v[32:47]
    s_setprio 3
    v_readfirstlane_b32 s58, v11
    ds_read_b64_tr_b16 v[80:81], v5 offset:17152
    ds_read_b64_tr_b16 v[82:83], v5 offset:17408
    s_setprio 0
    s_waitcnt lgkmcnt(9)
    v_mfma_f32_32x32x16_bf16 v[48:63], v[88:91], v[200:203], v[48:63]
    s_cmp_ge_u32 s58, 5
    s_cbranch_scc0 parallel_sum__mha_block__glu_gated_geglu__prompt_kernel_gs5
parallel_sum__mha_block__glu_gated_geglu__prompt_kernel_gr5:
    ds_read_b64_tr_b16 v[84:85], v5 offset:17184
    ds_read_b64_tr_b16 v[86:87], v5 offset:17440
    s_waitcnt lgkmcnt(8)
    v_mfma_f32_32x32x16_bf16 v[64:79], v[92:95], v[200:203], v[64:79]
    s_setprio 3
    v_add_u32 v2, 0x00018200, v2
    v_add_u32 v3, 0x00018200, v3
    v_add_u32 v4, 0x00018200, v4
    v_add_u32 v5, 0x00018200, v5
    ds_read_b64_tr_b16 v[88:89], v2 offset:0
    ds_read_b64_tr_b16 v[90:91], v2 offset:256
    s_setprio 0
    s_waitcnt lgkmcnt(8)
    v_mfma_f32_32x32x16_bf16 v[16:31], v[96:99], v[204:207], v[16:31]
    ds_read_b64_tr_b16 v[92:93], v2 offset:32
    ds_read_b64_tr_b16 v[94:95], v2 offset:288
    s_waitcnt lgkmcnt(8)
    v_mfma_f32_32x32x16_bf16 v[32:47], v[100:103], v[204:207], v[32:47]
    ds_read_b64_tr_b16 v[96:97], v2 offset:512
    ds_read_b64_tr_b16 v[98:99], v2 offset:768
    s_waitcnt lgkmcnt(8)
    v_mfma_f32_32x32x16_bf16 v[48:63], v[80:83], v[204:207], v[48:63]
    ds_read_b64_tr_b16 v[100:101], v2 offset:544
    ds_read_b64_tr_b16 v[102:103], v2 offset:800
    s_waitcnt lgkmcnt(8)
    v_mfma_f32_32x32x16_bf16 v[64:79], v[84:87], v[204:207], v[64:79]
    ds_read_b64_tr_b16 v[80:81], v3 offset:0
    ds_read_b64_tr_b16 v[82:83], v3 offset:256
    s_waitcnt lgkmcnt(8)
    v_mfma_f32_32x32x16_bf16 v[16:31], v[88:91], v[208:211], v[16:31]
    v_mfma_f32_16x16x32_bf16 v[104:107], v[120:123], v[88:91], v[104:107]
    s_waitcnt vmcnt(4)
    s_setprio 3
    v_mov_b32 v11, 6
    ds_write_b32 v9, v11
    ds_read_b64_tr_b16 v[84:85], v3 offset:32
    ds_read_b64_tr_b16 v[86:87], v3 offset:288
    s_setprio 0
    s_waitcnt lgkmcnt(9)
    v_mfma_f32_32x32x16_bf16 v[32:47], v[92:95], v[208:211], v[32:47]
    v_mfma_f32_16x16x32_bf16 v[108:111], v[120:123], v[92:95], v[108:111]
    ds_read_b64_tr_b16 v[88:89], v3 offset:512
    ds_read_b64_tr_b16 v[90:91], v3 offset:768
    s_waitcnt lgkmcnt(9)
    v_mfma_f32_32x32x16_bf16 v[48:63], v[96:99], v[208:211], v[48:63]
    v_mfma_f32_16x16x32_bf16 v[112:115], v[120:123], v[96:99], v[112:115]
    ds_read_b64_tr_b16 v[92:93], v3 offset:544
    ds_read_b64_tr_b16 v[94:95], v3 offset:800
    s_waitcnt lgkmcnt(9)
    v_mfma_f32_32x32x16_bf16 v[64:79], v[100:103], v[208:211], v[64:79]
    v_mfma_f32_16x16x32_bf16 v[116:119], v[120:123], v[100:103], v[116:119]
    ds_read_b64_tr_b16 v[96:97], v4 offset:0
    ds_read_b64_tr_b16 v[98:99], v4 offset:256
    s_waitcnt lgkmcnt(9)
    v_mfma_f32_32x32x16_bf16 v[16:31], v[80:83], v[212:215], v[16:31]
    ds_read_b64_tr_b16 v[100:101], v4 offset:32
    ds_read_b64_tr_b16 v[102:103], v4 offset:288
    s_waitcnt lgkmcnt(8)
    v_mfma_f32_32x32x16_bf16 v[32:47], v[84:87], v[212:215], v[32:47]
    ds_read_b64_tr_b16 v[80:81], v4 offset:512
    ds_read_b64_tr_b16 v[82:83], v4 offset:768
    s_waitcnt lgkmcnt(8)
    v_mfma_f32_32x32x16_bf16 v[48:63], v[88:91], v[212:215], v[48:63]
    ds_read_b128 v[124:127], v10
    ds_read_b64_tr_b16 v[84:85], v4 offset:544
    ds_read_b64_tr_b16 v[86:87], v4 offset:800
    s_waitcnt lgkmcnt(9)
    v_mfma_f32_32x32x16_bf16 v[64:79], v[92:95], v[212:215], v[64:79]
    ds_read_b64_tr_b16 v[88:89], v5 offset:0
    ds_read_b64_tr_b16 v[90:91], v5 offset:256
    s_waitcnt lgkmcnt(9)
    v_mfma_f32_32x32x16_bf16 v[16:31], v[96:99], v[216:219], v[16:31]
    s_waitcnt lgkmcnt(4)
    s_setprio 3
    v_min3_u32 v11, v124, v125, v126
    v_min_u32 v11, v11, v127
    ds_read_b64_tr_b16 v[92:93], v5 offset:32
    ds_read_b64_tr_b16 v[94:95], v5 offset:288
    s_setprio 0
    s_waitcnt lgkmcnt(9)
    v_mfma_f32_32x32x16_bf16 v[32:47], v[100:103], v[216:219], v[32:47]
    s_setprio 3
    v_readfirstlane_b32 s58, v11
    ds_read_b64_tr_b16 v[96:97], v5 offset:512
    ds_read_b64_tr_b16 v[98:99], v5 offset:768
    s_setprio 0
    s_waitcnt lgkmcnt(9)
    v_mfma_f32_32x32x16_bf16 v[48:63], v[80:83], v[216:219], v[48:63]
    s_cmp_ge_u32 s58, 6
    s_cbranch_scc0 parallel_sum__mha_block__glu_gated_geglu__prompt_kernel_gs6
parallel_sum__mha_block__glu_gated_geglu__prompt_kernel_gr6:
    s_setprio 3
    v_mov_b32 v11, 161064
    s_mov_b32 s59, 200000
    s_setprio 0
parallel_sum__mha_block__glu_gated_geglu__prompt_kernel_kvw:
    ds_read_b32 v124, v11
    s_sub_u32 s59, s59, 1
    s_cmp_eq_u32 s59, 0
    s_waitcnt lgkmcnt(0)
    s_cbranch_scc1 parallel_sum__mha_block__glu_gated_geglu__prompt_kernel_kvw_x
    s_setprio 3
    v_readfirstlane_b32 s58, v124
    s_nop 1
    s_cmp_ge_u32 s58, 1
    s_setprio 0
    s_cbranch_scc1 parallel_sum__mha_block__glu_gated_geglu__prompt_kernel_kvw_x
    s_sleep 1
    s_branch parallel_sum__mha_block__glu_gated_geglu__prompt_kernel_kvw
parallel_sum__mha_block__glu_gated_geglu__prompt_kernel_kvw_x:
    ds_read_b64_tr_b16 v[100:101], v5 offset:544
    ds_read_b64_tr_b16 v[102:103], v5 offset:800
    s_waitcnt lgkmcnt(8)
    v_mfma_f32_32x32x16_bf16 v[64:79], v[84:87], v[216:219], v[64:79]
    ds_read_b64_tr_b16 v[80:81], v2 offset:16640
    ds_read_b64_tr_b16 v[82:83], v2 offset:16896
    s_mul_i32 s56, s52, 24576
    s_add_u32 m0, s56, 0
    s_add_u32 s68, s7, 0
    buffer_load_dwordx4 v1, s[36:39], s68 offen offset:0 sc1 lds
    buffer_load_dwordx4 v1, s[36:39], s68 offen offset:1024 sc1 lds
    buffer_load_dwordx4 v1, s[36:39], s68 offen offset:2048 sc1 lds
    buffer_load_dwordx4 v1, s[36:39], s68 offen offset:3072 sc1 lds
    s_waitcnt lgkmcnt(8)
    v_mfma_f32_32x32x16_bf16 v[16:31], v[88:91], v[220:223], v[16:31]
    ds_read_b64_tr_b16 v[84:85], v2 offset:16672
    ds_read_b64_tr_b16 v[86:87], v2 offset:16928
    s_waitcnt lgkmcnt(8)
    v_mfma_f32_32x32x16_bf16 v[32:47], v[92:95], v[220:223], v[32:47]
    ds_read_b64_tr_b16 v[88:89], v2 offset:17152
    ds_read_b64_tr_b16 v[90:91], v2 offset:17408
    s_mul_i32 s56, s52, 24576
    s_add_u32 m0, s56, 4096
    s_add_u32 s68, s7, 4096
    buffer_load_dwordx4 v1, s[36:39], s68 offen offset:0 sc1 lds
    buffer_load_dwordx4 v1, s[36:39], s68 offen offset:1024 sc1 lds
    buffer_load_dwordx4 v1, s[36:39], s68 offen offset:2048 sc1 lds
    buffer_load_dwordx4 v1, s[36:39], s68 offen offset:3072 sc1 lds
    s_waitcnt lgkmcnt(8)
    v_mfma_f32_32x32x16_bf16 v[48:63], v[96:99], v[220:223], v[48:63]
    ds_read_b64_tr_b16 v[92:93], v2 offset:17184
    ds_read_b64_tr_b16 v[94:95], v2 offset:17440
    s_waitcnt lgkmcnt(8)
    v_mfma_f32_32x32x16_bf16 v[64:79], v[100:103], v[220:223], v[64:79]
    ds_read_b64_tr_b16 v[96:97], v3 offset:16640
    ds_read_b64_tr_b16 v[98:99], v3 offset:16896
    s_mul_i32 s56, s52, 24576
    s_add_u32 m0, s56, 8192
    s_add_u32 s68, s7, 8192
    buffer_load_dwordx4 v1, s[36:39], s68 offen offset:0 sc1 lds
    buffer_load_dwordx4 v1, s[36:39], s68 offen offset:1024 sc1 lds
    buffer_load_dwordx4 v1, s[36:39], s68 offen offset:2048 sc1 lds
    buffer_load_dwordx4 v1, s[36:39], s68 offen offset:3072 sc1 lds
    s_waitcnt lgkmcnt(8)
    v_mfma_f32_32x32x16_bf16 v[16:31], v[80:83], v[224:227], v[16:31]
    v_mfma_f32_16x16x32_bf16 v[104:107], v[120:123], v[80:83], v[104:107]
    s_waitcnt vmcnt(12)
    s_setprio 3
    v_mov_b32 v11, 7
    ds_write_b32 v9, v11
    ds_read_b64_tr_b16 v[100:101], v3 offset:16672
    ds_read_b64_tr_b16 v[102:103], v3 offset:16928
    s_setprio 0
    s_waitcnt lgkmcnt(9)
    v_mfma_f32_32x32x16_bf16 v[32:47], v[84:87], v[224:227], v[32:47]
    v_mfma_f32_16x16x32_bf16 v[108:111], v[120:123], v[84:87], v[108:111]
    ds_read_b64_tr_b16 v[80:81], v3 offset:17152
    ds_read_b64_tr_b16 v[82:83], v3 offset:17408
    s_mul_i32 s56, s52, 24576
    s_add_u32 m0, s56, 12288
    s_add_u32 s68, s7, 12288
    buffer_load_dwordx4 v1, s[36:39], s68 offen offset:0 sc1 lds
    buffer_load_dwordx4 v1, s[36:39], s68 offen offset:1024 sc1 lds
    buffer_load_dwordx4 v1, s[36:39], s68 offen offset:2048 sc1 lds
    buffer_load_dwordx4 v1, s[36:39], s68 offen offset:3072 sc1 lds
    s_waitcnt lgkmcnt(9)
    v_mfma_f32_32x32x16_bf16 v[48:63], v[88:91], v[224:227], v[48:63]
    v_mfma_f32_16x16x32_bf16 v[112:115], v[120:123], v[88:91], v[112:115]
    ds_read_b64_tr_b16 v[84:85], v3 offset:17184
    ds_read_b64_tr_b16 v[86:87], v3 offset:17440
    s_waitcnt lgkmcnt(9)
    v_mfma_f32_32x32x16_bf16 v[64:79], v[92:95], v[224:227], v[64:79]
    v_mfma_f32_16x16x32_bf16 v[116:119], v[120:123], v[92:95], v[116:119]
    ds_read_b64_tr_b16 v[88:89], v4 offset:16640
    ds_read_b64_tr_b16 v[90:91], v4 offset:16896
    s_mul_i32 s56, s52, 24576
    s_add_u32 m0, s56, 16384
    s_add_u32 s68, s7, 16384
    buffer_load_dwordx4 v1, s[36:39], s68 offen offset:0 sc1 lds
    buffer_load_dwordx4 v1, s[36:39], s68 offen offset:1024 sc1 lds
    buffer_load_dwordx4 v1, s[36:39], s68 offen offset:2048 sc1 lds
    buffer_load_dwordx4 v1, s[36:39], s68 offen offset:3072 sc1 lds
    s_waitcnt lgkmcnt(9)
    v_mfma_f32_32x32x16_bf16 v[16:31], v[96:99], v[228:231], v[16:31]
    ds_read_b64_tr_b16 v[92:93], v4 offset:16672
    ds_read_b64_tr_b16 v[94:95], v4 offset:16928
    s_waitcnt lgkmcnt(8)
    v_mfma_f32_32x32x16_bf16 v[32:47], v[100:103], v[228:231], v[32:47]
    ds_read_b64_tr_b16 v[96:97], v4 offset:17152
    ds_read_b64_tr_b16 v[98:99], v4 offset:17408
    s_mul_i32 s56, s52, 24576
    s_add_u32 m0, s56, 20480
    s_add_u32 s68, s7, 20480
    buffer_load_dwordx4 v1, s[36:39], s68 offen offset:0 sc1 lds
    buffer_load_dwordx4 v1, s[36:39], s68 offen offset:1024 sc1 lds
    buffer_load_dwordx4 v1, s[36:39], s68 offen offset:2048 sc1 lds
    buffer_load_dwordx4 v1, s[36:39], s68 offen offset:3072 sc1 lds
    s_waitcnt lgkmcnt(8)
    v_mfma_f32_32x32x16_bf16 v[48:63], v[80:83], v[228:231], v[48:63]
    ds_read_b128 v[124:127], v10
    ds_read_b64_tr_b16 v[100:101], v4 offset:17184
    ds_read_b64_tr_b16 v[102:103], v4 offset:17440
    s_waitcnt lgkmcnt(9)
    v_mfma_f32_32x32x16_bf16 v[64:79], v[84:87], v[228:231], v[64:79]
    ds_read_b64_tr_b16 v[80:81], v5 offset:16640
    ds_read_b64_tr_b16 v[82:83], v5 offset:16896
    s_waitcnt lgkmcnt(9)
    v_mfma_f32_32x32x16_bf16 v[16:31], v[88:91], v[232:235], v[16:31]
    s_waitcnt lgkmcnt(4)
    s_setprio 3
    v_min3_u32 v11, v124, v125, v126
    v_min_u32 v11, v11, v127
    ds_read_b64_tr_b16 v[84:85], v5 offset:16672
    ds_read_b64_tr_b16 v[86:87], v5 offset:16928
    s_setprio 0
    s_waitcnt lgkmcnt(9)
    v_mfma_f32_32x32x16_bf16 v[32:47], v[92:95], v[232:235], v[32:47]
    s_setprio 3
    v_readfirstlane_b32 s58, v11
    ds_read_b64_tr_b16 v[88:89], v5 offset:17152
    ds_read_b64_tr_b16 v[90:91], v5 offset:17408
    s_setprio 0
    s_waitcnt lgkmcnt(9)
    v_mfma_f32_32x32x16_bf16 v[48:63], v[96:99], v[232:235], v[48:63]
    s_cmp_ge_u32 s58, 7
    s_cbranch_scc0 parallel_sum__mha_block__glu_gated_geglu__prompt_kernel_gs7
parallel_sum__mha_block__glu_gated_geglu__prompt_kernel_gr7:
    ds_read_b64_tr_b16 v[92:93], v5 offset:17184
    ds_read_b64_tr_b16 v[94:95], v5 offset:17440
    s_waitcnt lgkmcnt(8)
    v_mfma_f32_32x32x16_bf16 v[64:79], v[100:103], v[232:235], v[64:79]
    ds_read_b64_tr_b16 v[96:97], v2 offset:33280
    ds_read_b64_tr_b16 v[98:99], v2 offset:33536
    s_add_u32 m0, s14, 98816
    s_add_u32 s69, s96, s50
    s_add_u32 s56, s69, 0
    buffer_load_dwordx4 v7, s[28:31], s56 offen offset:0 lds
    s_waitcnt lgkmcnt(8)
    v_mfma_f32_32x32x16_bf16 v[16:31], v[80:83], v[236:239], v[16:31]
    ds_read_b64_tr_b16 v[100:101], v2 offset:33312
    ds_read_b64_tr_b16 v[102:103], v2 offset:33568
    s_waitcnt lgkmcnt(8)
    v_mfma_f32_32x32x16_bf16 v[32:47], v[84:87], v[236:239], v[32:47]
    ds_read_b64_tr_b16 v[80:81], v2 offset:33792
    ds_read_b64_tr_b16 v[82:83], v2 offset:34048
    s_add_u32 s56, s69, 27648
    buffer_load_dwordx4 v7, s[28:31], s56 offen offset:1024 lds
    s_waitcnt lgkmcnt(8)
    v_mfma_f32_32x32x16_bf16 v[48:63], v[88:91], v[236:239], v[48:63]
    ds_read_b64_tr_b16 v[84:85], v2 offset:33824
    ds_read_b64_tr_b16 v[86:87], v2 offset:34080
    s_waitcnt lgkmcnt(8)
    v_mfma_f32_32x32x16_bf16 v[64:79], v[92:95], v[236:239], v[64:79]
    ds_read_b64_tr_b16 v[88:89], v3 offset:33280
    ds_read_b64_tr_b16 v[90:91], v3 offset:33536
    s_add_u32 s56, s69, 55296
    buffer_load_dwordx4 v7, s[28:31], s56 offen offset:2048 lds
    s_waitcnt lgkmcnt(8)
    v_mfma_f32_32x32x16_bf16 v[16:31], v[96:99], v[240:243], v[16:31]
    v_mfma_f32_16x16x32_bf16 v[104:107], v[120:123], v[96:99], v[104:107]
    ds_read_b64_tr_b16 v[92:93], v3 offset:33312
    ds_read_b64_tr_b16 v[94:95], v3 offset:33568
    s_waitcnt lgkmcnt(8)
    v_mfma_f32_32x32x16_bf16 v[32:47], v[100:103], v[240:243], v[32:47]
    v_mfma_f32_16x16x32_bf16 v[108:111], v[120:123], v[100:103], v[108:111]
    ds_read_b64_tr_b16 v[96:97], v3 offset:33792
    ds_read_b64_tr_b16 v[98:99], v3 offset:34048
    s_add_u32 s56, s69, 82944
    buffer_load_dwordx4 v7, s[28:31], s56 offen offset:3072 lds
    s_waitcnt lgkmcnt(8)
    v_mfma_f32_32x32x16_bf16 v[48:63], v[80:83], v[240:243], v[48:63]
    v_mfma_f32_16x16x32_bf16 v[112:115], v[120:123], v[80:83], v[112:115]
    ds_read_b64_tr_b16 v[100:101], v3 offset:33824
    ds_read_b64_tr_b16 v[102:103], v3 offset:34080
    s_waitcnt lgkmcnt(8)
    v_mfma_f32_32x32x16_bf16 v[64:79], v[84:87], v[240:243], v[64:79]
    v_mfma_f32_16x16x32_bf16 v[116:119], v[120:123], v[84:87], v[116:119]
    ds_read_b64_tr_b16 v[80:81], v4 offset:33280
    ds_read_b64_tr_b16 v[82:83], v4 offset:33536
    s_waitcnt lgkmcnt(8)
    v_mfma_f32_32x32x16_bf16 v[16:31], v[88:91], v[244:247], v[16:31]
    ds_read_b64_tr_b16 v[84:85], v4 offset:33312
    ds_read_b64_tr_b16 v[86:87], v4 offset:33568
    s_waitcnt lgkmcnt(8)
    v_mfma_f32_32x32x16_bf16 v[32:47], v[92:95], v[244:247], v[32:47]
    s_setprio 3
    v_and_b32 v12, 15, v0
    v_lshlrev_b32 v12, 3, v12
    s_lshl_b32 s58, s52, 7
    s_add_u32 s58, s58, 131072
    v_add_u32 v12, s58, v12
    s_mov_b64 exec, 0xffff
    ds_write_b64 v12, v[104:105] offset:30080
    ds_write_b64 v12, v[108:109] offset:30592
    ds_write_b64 v12, v[112:113] offset:31104
    ds_write_b64 v12, v[116:117] offset:31616
    s_mov_b64 exec, -1
    ds_read_b64_tr_b16 v[88:89], v4 offset:33792
    ds_read_b64_tr_b16 v[90:91], v4 offset:34048
    s_setprio 0
    s_waitcnt lgkmcnt(12)
    v_mfma_f32_32x32x16_bf16 v[48:63], v[96:99], v[244:247], v[48:63]
    s_waitcnt vmcnt(0)
    s_setprio 3
    v_mov_b32 v11, 8
    ds_write_b32 v9, v11
    ds_read_b64_tr_b16 v[92:93], v4 offset:33824
    ds_read_b64_tr_b16 v[94:95], v4 offset:34080
    s_setprio 0
    s_waitcnt lgkmcnt(13)
    v_mfma_f32_32x32x16_bf16 v[64:79], v[100:103], v[244:247], v[64:79]
    ds_read_b64_tr_b16 v[96:97], v5 offset:33280
    ds_read_b64_tr_b16 v[98:99], v5 offset:33536
    s_waitcnt lgkmcnt(13)
    v_mfma_f32_32x32x16_bf16 v[16:31], v[80:83], v[248:251], v[16:31]
    ds_read_b64_tr_b16 v[100:101], v5 offset:33312
    ds_read_b64_tr_b16 v[102:103], v5 offset:33568
    s_waitcnt vmcnt(4)
    ds_write_b32 v9, v9 offset:112
    s_waitcnt lgkmcnt(14)
    v_mfma_f32_32x32x16_bf16 v[32:47], v[84:87], v[248:251], v[32:47]
    ds_read_b128 v[124:127], v10
    ds_read_b64_tr_b16 v[80:81], v5 offset:33792
    ds_read_b64_tr_b16 v[82:83], v5 offset:34048
    s_waitcnt lgkmcnt(11)
    v_mfma_f32_32x32x16_bf16 v[48:63], v[88:91], v[248:251], v[48:63]
    ds_read_b64_tr_b16 v[84:85], v5 offset:33824
    ds_read_b64_tr_b16 v[86:87], v5 offset:34080
    s_waitcnt lgkmcnt(10)
    v_mfma_f32_32x32x16_bf16 v[64:79], v[92:95], v[248:251], v[64:79]
    s_waitcnt lgkmcnt(4)
    s_setprio 3
    v_min3_u32 v11, v124, v125, v126
    v_min_u32 v11, v11, v127
    s_nop 0
    v_readfirstlane_b32 s58, v11
    s_nop 1
    s_cmp_ge_u32 s58, 8
    s_setprio 0
    s_cbranch_scc0 parallel_sum__mha_block__glu_gated_geglu__prompt_kernel_gs8
parallel_sum__mha_block__glu_gated_geglu__prompt_kernel_gr8:
    ds_read_b64_tr_b16 v[88:89], v2 offset:0
    ds_read_b64_tr_b16 v[90:91], v2 offset:256
    s_add_u32 m0, s14, 115456
    s_add_u32 s69, s97, s50
    s_add_u32 s56, s69, 0
    buffer_load_dwordx4 v7, s[28:31], s56 offen offset:0 lds
    s_waitcnt lgkmcnt(10)
    v_mfma_f32_32x32x16_bf16 v[16:31], v[96:99], v[252:255], v[16:31]
    ds_read_b64_tr_b16 v[92:93], v2 offset:32
    ds_read_b64_tr_b16 v[94:95], v2 offset:288
    s_waitcnt lgkmcnt(10)
    v_mfma_f32_32x32x16_bf16 v[32:47], v[100:103], v[252:255], v[32:47]
    s_setprio 3
    v_and_b32 v12, 15, v0
    v_lshlrev_b32 v12, 3, v12
    v_bfe_u32 v104, v0, 4, 1
    v_lshl_add_u32 v12, v104, 2, v12
    v_add_u32 v12, 161152, v12
    ds_read2_b32 v[104:105], v12 offset0:0 offset1:32
    ds_read2_b32 v[106:107], v12 offset0:64 offset1:96
    ds_read2_b32 v[108:109], v12 offset0:128 offset1:160
    ds_read2_b32 v[110:111], v12 offset0:192 offset1:224
    v_add_u32 v12, 1024, v12
    ds_read2_b32 v[112:113], v12 offset0:0 offset1:32
    ds_read2_b32 v[114:115], v12 offset0:64 offset1:96
    ds_read2_b32 v[116:117], v12 offset0:128 offset1:160
    ds_read2_b32 v[118:119], v12 offset0:192 offset1:224
    ds_read_b64_tr_b16 v[96:97], v3 offset:0
    ds_read_b64_tr_b16 v[98:99], v3 offset:256
    s_add_u32 s56, s69, 27648
    buffer_load_dwordx4 v7, s[28:31], s56 offen offset:1024 lds
    s_setprio 0
    s_waitcnt lgkmcnt(15)
    v_mfma_f32_32x32x16_bf16 v[48:63], v[80:83], v[252:255], v[48:63]
    ds_read_b64_tr_b16 v[100:101], v3 offset:32
    ds_read_b64_tr_b16 v[102:103], v3 offset:288
    s_waitcnt lgkmcnt(15)
    v_mfma_f32_32x32x16_bf16 v[64:79], v[84:87], v[252:255], v[64:79]
    ds_read_b64_tr_b16 v[80:81], v4 offset:0
    ds_read_b64_tr_b16 v[82:83], v4 offset:256
    s_add_u32 s56, s69, 55296
    buffer_load_dwordx4 v7, s[28:31], s56 offen offset:2048 lds
    s_setprio 3
    s_waitcnt lgkmcnt(6)
    v_mov_b32 v84, v13
    v_and_b32 v85, 0xffff, v13
    v_mov_b32 v86, 0
    v_mov_b32 v87, 0
    v_add_f32 v104, v104, v105
    v_add_f32 v106, v106, v107
    v_add_f32 v106, v106, v104
    v_cvt_pk_bf16_f32 v104, v106, v106
    v_and_b32 v104, s60, v104
    v_sub_f32 v106, v106, v104
    v_cvt_pk_bf16_f32 v105, v106, v106
    v_and_b32 v107, s60, v105
    v_sub_f32 v106, v106, v107
    v_and_b32 v105, 0xffff, v105
    v_or_b32 v104, v104, v105
    v_cvt_pk_bf16_f32 v105, v106, v106
    v_mov_b32 v106, 0
    v_mov_b32 v107, 0
    v_add_f32 v108, v108, v109
    v_add_f32 v110, v110, v111
    v_add_f32 v110, v110, v108
    v_cvt_pk_bf16_f32 v108, v110, v110
    v_and_b32 v108, s60, v108
    v_sub_f32 v110, v110, v108
    v_cvt_pk_bf16_f32 v109, v110, v110
    v_and_b32 v111, s60, v109
    v_sub_f32 v110, v110, v111
    v_and_b32 v109, 0xffff, v109
    v_or_b32 v108, v108, v109
    v_cvt_pk_bf16_f32 v109, v110, v110
    v_mov_b32 v110, 0
    v_mov_b32 v111, 0
    v_add_f32 v112, v112, v113
    v_add_f32 v114, v114, v115
    v_add_f32 v114, v114, v112
    v_cvt_pk_bf16_f32 v112, v114, v114
    v_and_b32 v112, s60, v112
    v_sub_f32 v114, v114, v112
    v_cvt_pk_bf16_f32 v113, v114, v114
    v_and_b32 v115, s60, v113
    v_sub_f32 v114, v114, v115
    v_and_b32 v113, 0xffff, v113
    v_or_b32 v112, v112, v113
    v_cvt_pk_bf16_f32 v113, v114, v114
    v_mov_b32 v114, 0
    v_mov_b32 v115, 0
    v_add_f32 v116, v116, v117
    v_add_f32 v118, v118, v119
    v_add_f32 v118, v118, v116
    v_cvt_pk_bf16_f32 v116, v118, v118
    v_and_b32 v116, s60, v116
    v_sub_f32 v118, v118, v116
    v_cvt_pk_bf16_f32 v117, v118, v118
    v_and_b32 v119, s60, v117
    v_sub_f32 v118, v118, v119
    v_and_b32 v117, 0xffff, v117
    v_or_b32 v116, v116, v117
    v_cvt_pk_bf16_f32 v117, v118, v118
    v_mov_b32 v118, 0
    v_mov_b32 v119, 0
    v_mfma_f32_32x32x16_bf16 v[16:31], v[104:107], v[84:87], v[16:31]
    v_mfma_f32_32x32x16_bf16 v[32:47], v[108:111], v[84:87], v[32:47]
    v_mfma_f32_32x32x16_bf16 v[48:63], v[112:115], v[84:87], v[48:63]
    v_mfma_f32_32x32x16_bf16 v[64:79], v[116:119], v[84:87], v[64:79]
    s_nop 8
    v_mul_f32 v116, v16, v16
    v_mul_f32 v117, v17, v17
    v_fma_f32 v116, v116, v14, v8
    v_fma_f32 v117, v117, v14, v8
    v_mul_f32 v116, v16, v116
    v_mul_f32 v117, v17, v117
    v_exp_f32 v116, v116
    v_exp_f32 v117, v117
    v_mul_f32 v24, v16, v24
    v_mul_f32 v25, v17, v25
    v_fma_f32 v116, v116, v15, v15
    v_fma_f32 v117, v117, v15, v15
    v_rcp_f32 v116, v116
    v_rcp_f32 v117, v117
    v_mul_f32 v24, v24, v116
    v_mul_f32 v25, v25, v117
    v_cvt_pk_bf16_f32 v16, v24, v25
    v_mul_f32 v118, v18, v18
    v_mul_f32 v119, v19, v19
    v_fma_f32 v118, v118, v14, v8
    v_fma_f32 v119, v119, v14, v8
    v_mul_f32 v118, v18, v118
    v_mul_f32 v119, v19, v119
    v_exp_f32 v118, v118
    v_exp_f32 v119, v119
    v_mul_f32 v26, v18, v26
    v_mul_f32 v27, v19, v27
    v_fma_f32 v118, v118, v15, v15
    v_fma_f32 v119, v119, v15, v15
    v_rcp_f32 v118, v118
    v_rcp_f32 v119, v119
    v_mul_f32 v26, v26, v118
    v_mul_f32 v27, v27, v119
    v_cvt_pk_bf16_f32 v17, v26, v27
    v_mul_f32 v116, v20, v20
    v_mul_f32 v117, v21, v21
    v_fma_f32 v116, v116, v14, v8
    v_fma_f32 v117, v117, v14, v8
    v_mul_f32 v116, v20, v116
    v_mul_f32 v117, v21, v117
    v_exp_f32 v116, v116
    v_exp_f32 v117, v117
    v_mul_f32 v28, v20, v28
    v_mul_f32 v29, v21, v29
    v_fma_f32 v116, v116, v15, v15
    v_fma_f32 v117, v117, v15, v15
    v_rcp_f32 v116, v116
    v_rcp_f32 v117, v117
    v_mul_f32 v28, v28, v116
    v_mul_f32 v29, v29, v117
    v_cvt_pk_bf16_f32 v18, v28, v29
    v_mul_f32 v118, v22, v22
    v_mul_f32 v119, v23, v23
    v_fma_f32 v118, v118, v14, v8
    v_fma_f32 v119, v119, v14, v8
    v_mul_f32 v118, v22, v118
    v_mul_f32 v119, v23, v119
    v_exp_f32 v118, v118
    v_exp_f32 v119, v119
    v_mul_f32 v30, v22, v30
    v_mul_f32 v31, v23, v31
    v_fma_f32 v118, v118, v15, v15
    v_fma_f32 v119, v119, v15, v15
    v_rcp_f32 v118, v118
    v_rcp_f32 v119, v119
    v_mul_f32 v30, v30, v118
    v_mul_f32 v31, v31, v119
    v_cvt_pk_bf16_f32 v19, v30, v31
    s_lshl_b32 s3, s64, 5
    s_add_u32 s3, s3, s4
    s_add_u32 s3, s3, 0
    buffer_store_dwordx4 v[16:19], v1, s[36:39], s3 offen sc1
    v_mul_f32 v116, v32, v32
    v_mul_f32 v117, v33, v33
    v_fma_f32 v116, v116, v14, v8
    v_fma_f32 v117, v117, v14, v8
    v_mul_f32 v116, v32, v116
    v_mul_f32 v117, v33, v117
    v_exp_f32 v116, v116
    v_exp_f32 v117, v117
    v_mul_f32 v40, v32, v40
    v_mul_f32 v41, v33, v41
    v_fma_f32 v116, v116, v15, v15
    v_fma_f32 v117, v117, v15, v15
    v_rcp_f32 v116, v116
    v_rcp_f32 v117, v117
    v_mul_f32 v40, v40, v116
    v_mul_f32 v41, v41, v117
    v_cvt_pk_bf16_f32 v32, v40, v41
    v_mul_f32 v118, v34, v34
    v_mul_f32 v119, v35, v35
    v_fma_f32 v118, v118, v14, v8
    v_fma_f32 v119, v119, v14, v8
    v_mul_f32 v118, v34, v118
    v_mul_f32 v119, v35, v119
    v_exp_f32 v118, v118
    v_exp_f32 v119, v119
    v_mul_f32 v42, v34, v42
    v_mul_f32 v43, v35, v43
    v_fma_f32 v118, v118, v15, v15
    v_fma_f32 v119, v119, v15, v15
    v_rcp_f32 v118, v118
    v_rcp_f32 v119, v119
    v_mul_f32 v42, v42, v118
    v_mul_f32 v43, v43, v119
    v_cvt_pk_bf16_f32 v33, v42, v43
    v_mul_f32 v116, v36, v36
    v_mul_f32 v117, v37, v37
    v_fma_f32 v116, v116, v14, v8
    v_fma_f32 v117, v117, v14, v8
    v_mul_f32 v116, v36, v116
    v_mul_f32 v117, v37, v117
    v_exp_f32 v116, v116
    v_exp_f32 v117, v117
    v_mul_f32 v44, v36, v44
    v_mul_f32 v45, v37, v45
    v_fma_f32 v116, v116, v15, v15
    v_fma_f32 v117, v117, v15, v15
    v_rcp_f32 v116, v116
    v_rcp_f32 v117, v117
    v_mul_f32 v44, v44, v116
    v_mul_f32 v45, v45, v117
    v_cvt_pk_bf16_f32 v34, v44, v45
    v_mul_f32 v118, v38, v38
    v_mul_f32 v119, v39, v39
    v_fma_f32 v118, v118, v14, v8
    v_fma_f32 v119, v119, v14, v8
    v_mul_f32 v118, v38, v118
    v_mul_f32 v119, v39, v119
    v_exp_f32 v118, v118
    v_exp_f32 v119, v119
    v_mul_f32 v46, v38, v46
    v_mul_f32 v47, v39, v47
    v_fma_f32 v118, v118, v15, v15
    v_fma_f32 v119, v119, v15, v15
    v_rcp_f32 v118, v118
    v_rcp_f32 v119, v119
    v_mul_f32 v46, v46, v118
    v_mul_f32 v47, v47, v119
    v_cvt_pk_bf16_f32 v35, v46, v47
    s_lshl_b32 s3, s64, 5
    s_add_u32 s3, s3, s4
    s_add_u32 s3, s3, 1024
    buffer_store_dwordx4 v[32:35], v1, s[36:39], s3 offen sc1
    s_waitcnt lgkmcnt(15)
    v_mfma_f32_32x32x16_bf16 v[16:31], v[88:91], v[128:131], 0
    v_mfma_f32_16x16x32_bf16 v[104:107], v[120:123], v[88:91], 0
    ds_read_b64_tr_b16 v[84:85], v4 offset:32
    ds_read_b64_tr_b16 v[86:87], v4 offset:288
    v_mul_f32 v116, v48, v48
    v_mul_f32 v117, v49, v49
    v_fma_f32 v116, v116, v14, v8
    v_fma_f32 v117, v117, v14, v8
    v_mul_f32 v116, v48, v116
    v_mul_f32 v117, v49, v117
    s_waitcnt lgkmcnt(15)
    v_mfma_f32_32x32x16_bf16 v[32:47], v[92:95], v[128:131], 0
    v_mfma_f32_16x16x32_bf16 v[108:111], v[120:123], v[92:95], 0
    ds_read_b64_tr_b16 v[88:89], v5 offset:0
    ds_read_b64_tr_b16 v[90:91], v5 offset:256
    s_add_u32 s56, s69, 82944
    buffer_load_dwordx4 v7, s[28:31], s56 offen offset:3072 lds
    v_exp_f32 v116, v116
    v_exp_f32 v117, v117
    v_mul_f32 v56, v48, v56
    v_mul_f32 v57, v49, v57
    v_fma_f32 v116, v116, v15, v15
    v_fma_f32 v117, v117, v15, v15
    s_waitcnt lgkmcnt(8)
    v_mfma_f32_32x32x16_bf16 v[16:31], v[96:99], v[132:135], v[16:31]
    ds_read_b64_tr_b16 v[92:93], v5 offset:32
    ds_read_b64_tr_b16 v[94:95], v5 offset:288
    v_rcp_f32 v116, v116
    v_rcp_f32 v117, v117
    v_mul_f32 v56, v56, v116
    v_mul_f32 v57, v57, v117
    v_cvt_pk_bf16_f32 v48, v56, v57
    v_mul_f32 v118, v50, v50
    s_waitcnt lgkmcnt(8)
    v_mfma_f32_32x32x16_bf16 v[32:47], v[100:103], v[132:135], v[32:47]
    ds_read_b64_tr_b16 v[96:97], v2 offset:512
    ds_read_b64_tr_b16 v[98:99], v2 offset:768
    v_mul_f32 v119, v51, v51
    v_fma_f32 v118, v118, v14, v8
    v_fma_f32 v119, v119, v14, v8
    v_mul_f32 v118, v50, v118
    v_mul_f32 v119, v51, v119
    v_exp_f32 v118, v118
    s_waitcnt lgkmcnt(8)
    v_mfma_f32_32x32x16_bf16 v[16:31], v[80:83], v[136:139], v[16:31]
    ds_read_b64_tr_b16 v[100:101], v2 offset:544
    ds_read_b64_tr_b16 v[102:103], v2 offset:800
    v_exp_f32 v119, v119
    v_mul_f32 v58, v50, v58
    v_mul_f32 v59, v51, v59
    v_fma_f32 v118, v118, v15, v15
    v_fma_f32 v119, v119, v15, v15
    v_rcp_f32 v118, v118
    s_waitcnt lgkmcnt(8)
    v_mfma_f32_32x32x16_bf16 v[32:47], v[84:87], v[136:139], v[32:47]
    ds_read_b64_tr_b16 v[80:81], v3 offset:512
    ds_read_b64_tr_b16 v[82:83], v3 offset:768
    v_rcp_f32 v119, v119
    v_mul_f32 v58, v58, v118
    v_mul_f32 v59, v59, v119
    v_cvt_pk_bf16_f32 v49, v58, v59
    v_mul_f32 v116, v52, v52
    v_mul_f32 v117, v53, v53
    s_waitcnt lgkmcnt(8)
    v_mfma_f32_32x32x16_bf16 v[16:31], v[88:91], v[140:143], v[16:31]
    s_waitcnt vmcnt(0)
    v_mov_b32 v11, 9
    ds_write_b32 v9, v11
    ds_read_b64_tr_b16 v[84:85], v3 offset:544
    ds_read_b64_tr_b16 v[86:87], v3 offset:800
    v_fma_f32 v116, v116, v14, v8
    v_fma_f32 v117, v117, v14, v8
    v_mul_f32 v116, v52, v116
    v_mul_f32 v117, v53, v117
    v_exp_f32 v116, v116
    v_exp_f32 v117, v117
    s_waitcnt lgkmcnt(9)
    v_mfma_f32_32x32x16_bf16 v[32:47], v[92:95], v[140:143], v[32:47]
    ds_read_b64_tr_b16 v[88:89], v4 offset:512
    ds_read_b64_tr_b16 v[90:91], v4 offset:768
    v_mul_f32 v60, v52, v60
    v_mul_f32 v61, v53, v61
    v_fma_f32 v116, v116, v15, v15
    v_fma_f32 v117, v117, v15, v15
    v_rcp_f32 v116, v116
    v_rcp_f32 v117, v117
    s_waitcnt lgkmcnt(9)
    v_mfma_f32_32x32x16_bf16 v[16:31], v[96:99], v[144:147], v[16:31]
    v_mfma_f32_16x16x32_bf16 v[104:107], v[120:123], v[96:99], v[104:107]
    ds_read_b64_tr_b16 v[92:93], v4 offset:544
    ds_read_b64_tr_b16 v[94:95], v4 offset:800
    v_mul_f32 v60, v60, v116
    v_mul_f32 v61, v61, v117
    v_cvt_pk_bf16_f32 v50, v60, v61
    v_mul_f32 v118, v54, v54
    v_mul_f32 v119, v55, v55
    v_fma_f32 v118, v118, v14, v8
    s_waitcnt lgkmcnt(9)
    v_mfma_f32_32x32x16_bf16 v[32:47], v[100:103], v[144:147], v[32:47]
    v_mfma_f32_16x16x32_bf16 v[108:111], v[120:123], v[100:103], v[108:111]
    ds_read_b128 v[124:127], v10
    ds_read_b64_tr_b16 v[96:97], v5 offset:512
    ds_read_b64_tr_b16 v[98:99], v5 offset:768
    v_fma_f32 v119, v119, v14, v8
    v_mul_f32 v118, v54, v118
    v_mul_f32 v119, v55, v119
    v_exp_f32 v118, v118
    v_exp_f32 v119, v119
    v_mul_f32 v62, v54, v62
    s_waitcnt lgkmcnt(10)
    v_mfma_f32_32x32x16_bf16 v[16:31], v[80:83], v[148:151], v[16:31]
    ds_read_b64_tr_b16 v[100:101], v5 offset:544
    ds_read_b64_tr_b16 v[102:103], v5 offset:800
    v_mul_f32 v63, v55, v63
    v_fma_f32 v118, v118, v15, v15
    v_fma_f32 v119, v119, v15, v15
    v_rcp_f32 v118, v118
    v_rcp_f32 v119, v119
    v_mul_f32 v62, v62, v118
    s_waitcnt lgkmcnt(9)
    v_mfma_f32_32x32x16_bf16 v[32:47], v[84:87], v[148:151], v[32:47]
    s_waitcnt lgkmcnt(4)
    v_min3_u32 v11, v124, v125, v126
    v_min_u32 v11, v11, v127
    s_nop 0
    v_readfirstlane_b32 s58, v11
    s_nop 1
    s_cmp_ge_u32 s58, 9
    s_cbranch_scc0 parallel_sum__mha_block__glu_gated_geglu__prompt_kernel_gs9
parallel_sum__mha_block__glu_gated_geglu__prompt_kernel_gr9:
    ds_read_b64_tr_b16 v[80:81], v2 offset:16640
    ds_read_b64_tr_b16 v[82:83], v2 offset:16896
    s_add_u32 m0, s14, 132096
    s_add_u32 s69, s98, s50
    s_add_u32 s56, s69, 0
    buffer_load_dwordx4 v7, s[28:31], s56 offen offset:0 lds
    v_mul_f32 v63, v63, v119
    v_cvt_pk_bf16_f32 v51, v62, v63
    s_lshl_b32 s3, s64, 5
    s_add_u32 s3, s3, s4
    s_add_u32 s3, s3, 2048
    buffer_store_dwordx4 v[48:51], v1, s[36:39], s3 offen sc1
    s_waitcnt lgkmcnt(9)
    v_mfma_f32_32x32x16_bf16 v[16:31], v[88:91], v[152:155], v[16:31]
    ds_read_b64_tr_b16 v[84:85], v2 offset:16672
    ds_read_b64_tr_b16 v[86:87], v2 offset:16928
    v_mul_f32 v116, v64, v64
    v_mul_f32 v117, v65, v65
    v_fma_f32 v116, v116, v14, v8
    v_fma_f32 v117, v117, v14, v8
    v_mul_f32 v116, v64, v116
    v_mul_f32 v117, v65, v117
    s_waitcnt lgkmcnt(9)
    v_mfma_f32_32x32x16_bf16 v[32:47], v[92:95], v[152:155], v[32:47]
    ds_read_b64_tr_b16 v[88:89], v3 offset:16640
    ds_read_b64_tr_b16 v[90:91], v3 offset:16896
    s_add_u32 s56, s69, 27648
    buffer_load_dwordx4 v7, s[28:31], s56 offen offset:1024 lds
    v_exp_f32 v116, v116
    v_exp_f32 v117, v117
    v_mul_f32 v72, v64, v72
    v_mul_f32 v73, v65, v73
    v_fma_f32 v116, v116, v15, v15
    v_fma_f32 v117, v117, v15, v15
    s_waitcnt lgkmcnt(8)
    v_mfma_f32_32x32x16_bf16 v[16:31], v[96:99], v[156:159], v[16:31]
    ds_read_b64_tr_b16 v[92:93], v3 offset:16672
    ds_read_b64_tr_b16 v[94:95], v3 offset:16928
    v_rcp_f32 v116, v116
    v_rcp_f32 v117, v117
    v_mul_f32 v72, v72, v116
    v_mul_f32 v73, v73, v117
    v_cvt_pk_bf16_f32 v64, v72, v73
    v_mul_f32 v118, v66, v66
    s_waitcnt lgkmcnt(8)
    v_mfma_f32_32x32x16_bf16 v[32:47], v[100:103], v[156:159], v[32:47]
    ds_read_b64_tr_b16 v[96:97], v4 offset:16640
    ds_read_b64_tr_b16 v[98:99], v4 offset:16896
    s_add_u32 s56, s69, 55296
    buffer_load_dwordx4 v7, s[28:31], s56 offen offset:2048 lds
    v_mul_f32 v119, v67, v67
    v_fma_f32 v118, v118, v14, v8
    v_fma_f32 v119, v119, v14, v8
    v_mul_f32 v118, v66, v118
    v_mul_f32 v119, v67, v119
    v_exp_f32 v118, v118
    s_waitcnt lgkmcnt(8)
    v_mfma_f32_32x32x16_bf16 v[16:31], v[80:83], v[160:163], v[16:31]
    v_mfma_f32_16x16x32_bf16 v[104:107], v[120:123], v[80:83], v[104:107]
    ds_read_b64_tr_b16 v[100:101], v4 offset:16672
    ds_read_b64_tr_b16 v[102:103], v4 offset:16928
    v_exp_f32 v119, v119
    v_mul_f32 v74, v66, v74
    v_mul_f32 v75, v67, v75
    v_fma_f32 v118, v118, v15, v15
    v_fma_f32 v119, v119, v15, v15
    v_rcp_f32 v118, v118
    s_waitcnt lgkmcnt(8)
    v_mfma_f32_32x32x16_bf16 v[32:47], v[84:87], v[160:163], v[32:47]
    v_mfma_f32_16x16x32_bf16 v[108:111], v[120:123], v[84:87], v[108:111]
    ds_read_b64_tr_b16 v[80:81], v5 offset:16640
    ds_read_b64_tr_b16 v[82:83], v5 offset:16896
    s_add_u32 s56, s69, 82944
    buffer_load_dwordx4 v7, s[28:31], s56 offen offset:3072 lds
    v_rcp_f32 v119, v119
    v_mul_f32 v74, v74, v118
    v_mul_f32 v75, v75, v119
    v_cvt_pk_bf16_f32 v65, v74, v75
    v_mul_f32 v116, v68, v68
    v_mul_f32 v117, v69, v69
    s_waitcnt lgkmcnt(8)
    v_mfma_f32_32x32x16_bf16 v[16:31], v[88:91], v[164:167], v[16:31]
    ds_read_b64_tr_b16 v[84:85], v5 offset:16672
    ds_read_b64_tr_b16 v[86:87], v5 offset:16928
    v_fma_f32 v116, v116, v14, v8
    v_fma_f32 v117, v117, v14, v8
    v_mul_f32 v116, v68, v116
    v_mul_f32 v117, v69, v117
    v_exp_f32 v116, v116
    v_exp_f32 v117, v117
    s_waitcnt lgkmcnt(8)
    v_mfma_f32_32x32x16_bf16 v[32:47], v[92:95], v[164:167], v[32:47]
    ds_read_b64_tr_b16 v[88:89], v2 offset:17152
    ds_read_b64_tr_b16 v[90:91], v2 offset:17408
    v_mul_f32 v76, v68, v76
    v_mul_f32 v77, v69, v77
    v_fma_f32 v116, v116, v15, v15
    v_fma_f32 v117, v117, v15, v15
    v_rcp_f32 v116, v116
    v_rcp_f32 v117, v117
    s_waitcnt lgkmcnt(8)
    v_mfma_f32_32x32x16_bf16 v[16:31], v[96:99], v[168:171], v[16:31]
    ds_read_b64_tr_b16 v[92:93], v2 offset:17184
    ds_read_b64_tr_b16 v[94:95], v2 offset:17440
    v_mul_f32 v76, v76, v116
    v_mul_f32 v77, v77, v117
    v_cvt_pk_bf16_f32 v66, v76, v77
    v_mul_f32 v118, v70, v70
    v_mul_f32 v119, v71, v71
    v_fma_f32 v118, v118, v14, v8
    s_waitcnt lgkmcnt(8)
    v_mfma_f32_32x32x16_bf16 v[32:47], v[100:103], v[168:171], v[32:47]
    ds_read_b64_tr_b16 v[96:97], v3 offset:17152
    ds_read_b64_tr_b16 v[98:99], v3 offset:17408
    v_fma_f32 v119, v119, v14, v8
    v_mul_f32 v118, v70, v118
    v_mul_f32 v119, v71, v119
    v_exp_f32 v118, v118
    v_exp_f32 v119, v119
    v_mul_f32 v78, v70, v78
    s_waitcnt lgkmcnt(8)
    v_mfma_f32_32x32x16_bf16 v[16:31], v[80:83], v[172:175], v[16:31]
    s_waitcnt vmcnt(0)
    v_mov_b32 v11, 10
    ds_write_b32 v9, v11
    ds_read_b64_tr_b16 v[100:101], v3 offset:17184
    ds_read_b64_tr_b16 v[102:103], v3 offset:17440
    v_mul_f32 v79, v71, v79
    v_fma_f32 v118, v118, v15, v15
    v_fma_f32 v119, v119, v15, v15
    v_rcp_f32 v118, v118
    v_rcp_f32 v119, v119
    v_mul_f32 v78, v78, v118
    s_waitcnt lgkmcnt(9)
    v_mfma_f32_32x32x16_bf16 v[32:47], v[84:87], v[172:175], v[32:47]
    ds_read_b64_tr_b16 v[80:81], v4 offset:17152
    ds_read_b64_tr_b16 v[82:83], v4 offset:17408
    v_mul_f32 v79, v79, v119
    v_cvt_pk_bf16_f32 v67, v78, v79
    s_lshl_b32 s3, s64, 5
    s_add_u32 s3, s3, s4
    s_add_u32 s3, s3, 3072
    buffer_store_dwordx4 v[64:67], v1, s[36:39], s3 offen sc1
    s_setprio 0
    s_waitcnt lgkmcnt(9)
    v_mfma_f32_32x32x16_bf16 v[16:31], v[88:91], v[176:179], v[16:31]
    v_mfma_f32_16x16x32_bf16 v[104:107], v[120:123], v[88:91], v[104:107]
    ds_read_b64_tr_b16 v[84:85], v4 offset:17184
    ds_read_b64_tr_b16 v[86:87], v4 offset:17440
    s_waitcnt lgkmcnt(9)
    v_mfma_f32_32x32x16_bf16 v[32:47], v[92:95], v[176:179], v[32:47]
    v_mfma_f32_16x16x32_bf16 v[108:111], v[120:123], v[92:95], v[108:111]
    ds_read_b128 v[124:127], v10
    ds_read_b64_tr_b16 v[88:89], v5 offset:17152
    ds_read_b64_tr_b16 v[90:91], v5 offset:17408
    s_waitcnt lgkmcnt(10)
    v_mfma_f32_32x32x16_bf16 v[16:31], v[96:99], v[180:183], v[16:31]
    ds_read_b64_tr_b16 v[92:93], v5 offset:17184
    ds_read_b64_tr_b16 v[94:95], v5 offset:17440
    s_waitcnt lgkmcnt(9)
    v_mfma_f32_32x32x16_bf16 v[32:47], v[100:103], v[180:183], v[32:47]
    s_waitcnt lgkmcnt(4)
    s_setprio 3
    v_min3_u32 v11, v124, v125, v126
    v_min_u32 v11, v11, v127
    s_nop 0
    v_readfirstlane_b32 s58, v11
    s_nop 1
    s_cmp_ge_u32 s58, 10
    s_setprio 0
    s_cbranch_scc0 parallel_sum__mha_block__glu_gated_geglu__prompt_kernel_gs10
parallel_sum__mha_block__glu_gated_geglu__prompt_kernel_gr10:
    ds_read_b64_tr_b16 v[96:97], v2 offset:33280
    ds_read_b64_tr_b16 v[98:99], v2 offset:33536
    s_add_u32 m0, s14, 98816
    s_add_u32 s69, s99, s50
    s_add_u32 s56, s69, 0
    buffer_load_dwordx4 v7, s[28:31], s56 offen offset:0 lds
    s_waitcnt lgkmcnt(9)
    v_mfma_f32_32x32x16_bf16 v[16:31], v[80:83], v[184:187], v[16:31]
    ds_read_b64_tr_b16 v[100:101], v2 offset:33312
    ds_read_b64_tr_b16 v[102:103], v2 offset:33568
    s_waitcnt lgkmcnt(9)
    v_mfma_f32_32x32x16_bf16 v[32:47], v[84:87], v[184:187], v[32:47]
    ds_read_b64_tr_b16 v[80:81], v3 offset:33280
    ds_read_b64_tr_b16 v[82:83], v3 offset:33536
    s_add_u32 s56, s69, 27648
    buffer_load_dwordx4 v7, s[28:31], s56 offen offset:1024 lds
    s_waitcnt lgkmcnt(8)
    v_mfma_f32_32x32x16_bf16 v[16:31], v[88:91], v[188:191], v[16:31]
    ds_read_b64_tr_b16 v[84:85], v3 offset:33312
    ds_read_b64_tr_b16 v[86:87], v3 offset:33568
    s_waitcnt lgkmcnt(8)
    v_mfma_f32_32x32x16_bf16 v[32:47], v[92:95], v[188:191], v[32:47]
    ds_read_b64_tr_b16 v[88:89], v4 offset:33280
    ds_read_b64_tr_b16 v[90:91], v4 offset:33536
    s_add_u32 s56, s69, 55296
    buffer_load_dwordx4 v7, s[28:31], s56 offen offset:2048 lds
    s_waitcnt lgkmcnt(8)
    v_mfma_f32_32x32x16_bf16 v[16:31], v[96:99], v[192:195], v[16:31]
    v_mfma_f32_16x16x32_bf16 v[104:107], v[120:123], v[96:99], v[104:107]
    ds_read_b64_tr_b16 v[92:93], v4 offset:33312
    ds_read_b64_tr_b16 v[94:95], v4 offset:33568
    s_waitcnt lgkmcnt(8)
    v_mfma_f32_32x32x16_bf16 v[32:47], v[100:103], v[192:195], v[32:47]
    v_mfma_f32_16x16x32_bf16 v[108:111], v[120:123], v[100:103], v[108:111]
    ds_read_b64_tr_b16 v[96:97], v5 offset:33280
    ds_read_b64_tr_b16 v[98:99], v5 offset:33536
    s_add_u32 s56, s69, 82944
    buffer_load_dwordx4 v7, s[28:31], s56 offen offset:3072 lds
    s_waitcnt lgkmcnt(8)
    v_mfma_f32_32x32x16_bf16 v[16:31], v[80:83], v[196:199], v[16:31]
    ds_read_b64_tr_b16 v[100:101], v5 offset:33312
    ds_read_b64_tr_b16 v[102:103], v5 offset:33568
    s_waitcnt lgkmcnt(8)
    v_mfma_f32_32x32x16_bf16 v[32:47], v[84:87], v[196:199], v[32:47]
    ds_read_b64_tr_b16 v[80:81], v2 offset:33792
    ds_read_b64_tr_b16 v[82:83], v2 offset:34048
    s_waitcnt lgkmcnt(8)
    v_mfma_f32_32x32x16_bf16 v[16:31], v[88:91], v[200:203], v[16:31]
    ds_read_b64_tr_b16 v[84:85], v2 offset:33824
    ds_read_b64_tr_b16 v[86:87], v2 offset:34080
    s_waitcnt lgkmcnt(8)
    v_mfma_f32_32x32x16_bf16 v[32:47], v[92:95], v[200:203], v[32:47]
    ds_read_b64_tr_b16 v[88:89], v3 offset:33792
    ds_read_b64_tr_b16 v[90:91], v3 offset:34048
    s_waitcnt lgkmcnt(8)
    v_mfma_f32_32x32x16_bf16 v[16:31], v[96:99], v[204:207], v[16:31]
    s_waitcnt vmcnt(0)
    s_setprio 3
    v_mov_b32 v11, 11
    ds_write_b32 v9, v11
    ds_read_b64_tr_b16 v[92:93], v3 offset:33824
    ds_read_b64_tr_b16 v[94:95], v3 offset:34080
    s_setprio 0
    s_waitcnt lgkmcnt(9)
    v_mfma_f32_32x32x16_bf16 v[32:47], v[100:103], v[204:207], v[32:47]
    ds_read_b64_tr_b16 v[96:97], v4 offset:33792
    ds_read_b64_tr_b16 v[98:99], v4 offset:34048
    s_waitcnt lgkmcnt(9)
    v_mfma_f32_32x32x16_bf16 v[16:31], v[80:83], v[208:211], v[16:31]
    v_mfma_f32_16x16x32_bf16 v[104:107], v[120:123], v[80:83], v[104:107]
    ds_read_b64_tr_b16 v[100:101], v4 offset:33824
    ds_read_b64_tr_b16 v[102:103], v4 offset:34080
    s_waitcnt lgkmcnt(9)
    v_mfma_f32_32x32x16_bf16 v[32:47], v[84:87], v[208:211], v[32:47]
    v_mfma_f32_16x16x32_bf16 v[108:111], v[120:123], v[84:87], v[108:111]
    ds_read_b128 v[124:127], v10
    ds_read_b64_tr_b16 v[80:81], v5 offset:33792
    ds_read_b64_tr_b16 v[82:83], v5 offset:34048
    s_waitcnt lgkmcnt(10)
    v_mfma_f32_32x32x16_bf16 v[16:31], v[88:91], v[212:215], v[16:31]
    ds_read_b64_tr_b16 v[84:85], v5 offset:33824
    ds_read_b64_tr_b16 v[86:87], v5 offset:34080
    s_waitcnt lgkmcnt(9)
    v_mfma_f32_32x32x16_bf16 v[32:47], v[92:95], v[212:215], v[32:47]
    s_waitcnt lgkmcnt(4)
    s_setprio 3
    v_min3_u32 v11, v124, v125, v126
    v_min_u32 v11, v11, v127
    s_nop 0
    v_readfirstlane_b32 s58, v11
    s_nop 1
    s_cmp_ge_u32 s58, 11
    s_setprio 0
    s_cbranch_scc0 parallel_sum__mha_block__glu_gated_geglu__prompt_kernel_gs11
parallel_sum__mha_block__glu_gated_geglu__prompt_kernel_gr11:
    ds_read_b64_tr_b16 v[88:89], v2 offset:0
    ds_read_b64_tr_b16 v[90:91], v2 offset:256
    s_add_u32 m0, s14, 115456
    s_lshr_b32 s69, s48, 1
    s_xor_b32 s69, s69, 0
    s_mul_i32 s69, s69, 917504
    s_add_u32 s69, s69, s15
    s_add_u32 s69, s69, s49
    s_add_u32 s56, s69, 0
    buffer_load_dwordx4 v6, s[28:31], s56 offen offset:0 lds
    s_waitcnt lgkmcnt(9)
    v_mfma_f32_32x32x16_bf16 v[16:31], v[96:99], v[216:219], v[16:31]
    ds_read_b64_tr_b16 v[92:93], v2 offset:32
    ds_read_b64_tr_b16 v[94:95], v2 offset:288
    s_waitcnt lgkmcnt(9)
    v_mfma_f32_32x32x16_bf16 v[32:47], v[100:103], v[216:219], v[32:47]
    ds_read_b64_tr_b16 v[96:97], v2 offset:512
    ds_read_b64_tr_b16 v[98:99], v2 offset:768
    s_add_u32 s56, s69, 27648
    buffer_load_dwordx4 v6, s[28:31], s56 offen offset:1024 lds
    s_waitcnt lgkmcnt(8)
    v_mfma_f32_32x32x16_bf16 v[16:31], v[80:83], v[220:223], v[16:31]
    ds_read_b64_tr_b16 v[100:101], v2 offset:544
    ds_read_b64_tr_b16 v[102:103], v2 offset:800
    s_waitcnt lgkmcnt(8)
    v_mfma_f32_32x32x16_bf16 v[32:47], v[84:87], v[220:223], v[32:47]
    ds_read_b64_tr_b16 v[80:81], v3 offset:0
    ds_read_b64_tr_b16 v[82:83], v3 offset:256
    s_add_u32 s56, s69, 55296
    buffer_load_dwordx4 v6, s[28:31], s56 offen offset:2048 lds
    s_waitcnt lgkmcnt(8)
    v_mfma_f32_32x32x16_bf16 v[16:31], v[88:91], v[224:227], v[16:31]
    v_mfma_f32_16x16x32_bf16 v[104:107], v[120:123], v[88:91], v[104:107]
    ds_read_b64_tr_b16 v[84:85], v3 offset:32
    ds_read_b64_tr_b16 v[86:87], v3 offset:288
    s_waitcnt lgkmcnt(8)
    v_mfma_f32_32x32x16_bf16 v[32:47], v[92:95], v[224:227], v[32:47]
    v_mfma_f32_16x16x32_bf16 v[108:111], v[120:123], v[92:95], v[108:111]
    ds_read_b64_tr_b16 v[88:89], v4 offset:0
    ds_read_b64_tr_b16 v[90:91], v4 offset:256
    s_add_u32 s56, s69, 82944
    buffer_load_dwordx4 v6, s[28:31], s56 offen offset:3072 lds
    s_waitcnt lgkmcnt(8)
    v_mfma_f32_32x32x16_bf16 v[16:31], v[96:99], v[240:243], v[16:31]
    v_mfma_f32_16x16x32_bf16 v[104:107], v[120:123], v[96:99], v[104:107]
    ds_read_b64_tr_b16 v[92:93], v4 offset:32
    ds_read_b64_tr_b16 v[94:95], v4 offset:288
    s_waitcnt lgkmcnt(8)
    v_mfma_f32_32x32x16_bf16 v[32:47], v[100:103], v[240:243], v[32:47]
    v_mfma_f32_16x16x32_bf16 v[108:111], v[120:123], v[100:103], v[108:111]
    ds_read_b64_tr_b16 v[96:97], v5 offset:0
    ds_read_b64_tr_b16 v[98:99], v5 offset:256
    s_waitcnt lgkmcnt(8)
    v_mfma_f32_32x32x16_bf16 v[16:31], v[80:83], v[228:231], v[16:31]
    ds_read_b64_tr_b16 v[100:101], v5 offset:32
    ds_read_b64_tr_b16 v[102:103], v5 offset:288
    s_waitcnt lgkmcnt(8)
    v_mfma_f32_32x32x16_bf16 v[32:47], v[84:87], v[228:231], v[32:47]
    s_setprio 3
    v_and_b32 v12, 15, v0
    v_lshlrev_b32 v12, 3, v12
    s_lshl_b32 s58, s52, 7
    s_add_u32 s58, s58, 131072
    v_add_u32 v12, s58, v12
    s_mov_b64 exec, 0xffff
    ds_write_b64 v12, v[104:105] offset:30080
    ds_write_b64 v12, v[108:109] offset:30592
    s_mov_b64 exec, -1
    ds_read_b64_tr_b16 v[80:81], v3 offset:512
    ds_read_b64_tr_b16 v[82:83], v3 offset:768
    s_setprio 0
    s_waitcnt lgkmcnt(10)
    v_mfma_f32_32x32x16_bf16 v[16:31], v[88:91], v[232:235], v[16:31]
    s_waitcnt vmcnt(0)
    s_setprio 3
    v_mov_b32 v11, 12
    ds_write_b32 v9, v11
    ds_read_b64_tr_b16 v[84:85], v3 offset:544
    ds_read_b64_tr_b16 v[86:87], v3 offset:800
    s_setprio 0
    s_waitcnt lgkmcnt(11)
    v_mfma_f32_32x32x16_bf16 v[32:47], v[92:95], v[232:235], v[32:47]
    ds_read_b64_tr_b16 v[88:89], v4 offset:512
    ds_read_b64_tr_b16 v[90:91], v4 offset:768
    s_waitcnt lgkmcnt(11)
    v_mfma_f32_32x32x16_bf16 v[16:31], v[96:99], v[236:239], v[16:31]
    ds_read_b64_tr_b16 v[92:93], v4 offset:544
    ds_read_b64_tr_b16 v[94:95], v4 offset:800
    s_waitcnt lgkmcnt(11)
    v_mfma_f32_32x32x16_bf16 v[32:47], v[100:103], v[236:239], v[32:47]
    ds_read_b128 v[124:127], v10
    ds_read_b64_tr_b16 v[96:97], v5 offset:512
    ds_read_b64_tr_b16 v[98:99], v5 offset:768
    s_waitcnt lgkmcnt(10)
    v_mfma_f32_32x32x16_bf16 v[16:31], v[80:83], v[244:247], v[16:31]
    ds_read_b64_tr_b16 v[100:101], v5 offset:544
    ds_read_b64_tr_b16 v[102:103], v5 offset:800
    s_waitcnt lgkmcnt(9)
    v_mfma_f32_32x32x16_bf16 v[32:47], v[84:87], v[244:247], v[32:47]
    s_waitcnt lgkmcnt(4)
    s_setprio 3
    v_min3_u32 v11, v124, v125, v126
    v_min_u32 v11, v11, v127
    s_nop 0
    v_readfirstlane_b32 s58, v11
    s_nop 1
    s_cmp_ge_u32 s58, 12
    s_setprio 0
    s_cbranch_scc0 parallel_sum__mha_block__glu_gated_geglu__prompt_kernel_gs12
parallel_sum__mha_block__glu_gated_geglu__prompt_kernel_gr12:
    ds_read_b64_tr_b16 v[80:81], v2 offset:16640
    ds_read_b64_tr_b16 v[82:83], v2 offset:16896
    s_add_u32 m0, s14, 132096
    s_lshr_b32 s69, s48, 1
    s_xor_b32 s69, s69, 1
    s_mul_i32 s69, s69, 917504
    s_add_u32 s69, s69, s15
    s_add_u32 s69, s69, s49
    s_add_u32 s56, s69, 0
    buffer_load_dwordx4 v6, s[28:31], s56 offen offset:0 lds
    s_waitcnt lgkmcnt(9)
    v_mfma_f32_32x32x16_bf16 v[16:31], v[88:91], v[248:251], v[16:31]
    ds_read_b64_tr_b16 v[84:85], v3 offset:16640
    ds_read_b64_tr_b16 v[86:87], v3 offset:16896
    s_waitcnt lgkmcnt(9)
    v_mfma_f32_32x32x16_bf16 v[32:47], v[92:95], v[248:251], v[32:47]
    s_setprio 3
    v_and_b32 v12, 15, v0
    v_lshlrev_b32 v12, 3, v12
    v_bfe_u32 v104, v0, 4, 1
    v_lshl_add_u32 v12, v104, 2, v12
    v_add_u32 v12, 161152, v12
    ds_read2_b32 v[104:105], v12 offset0:0 offset1:32
    ds_read2_b32 v[106:107], v12 offset0:64 offset1:96
    ds_read2_b32 v[108:109], v12 offset0:128 offset1:160
    ds_read2_b32 v[110:111], v12 offset0:192 offset1:224
    ds_read_b64_tr_b16 v[88:89], v4 offset:16640
    ds_read_b64_tr_b16 v[90:91], v4 offset:16896
    s_add_u32 s56, s69, 27648
    buffer_load_dwordx4 v6, s[28:31], s56 offen offset:1024 lds
    s_setprio 0
    s_waitcnt lgkmcnt(12)
    v_mfma_f32_32x32x16_bf16 v[16:31], v[96:99], v[252:255], v[16:31]
    ds_read_b64_tr_b16 v[92:93], v5 offset:16640
    ds_read_b64_tr_b16 v[94:95], v5 offset:16896
    s_waitcnt lgkmcnt(12)
    v_mfma_f32_32x32x16_bf16 v[32:47], v[100:103], v[252:255], v[32:47]
    ds_read_b64_tr_b16 v[96:97], v2 offset:16672
    ds_read_b64_tr_b16 v[98:99], v2 offset:16928
    s_add_u32 s56, s69, 55296
    buffer_load_dwordx4 v6, s[28:31], s56 offen offset:2048 lds
    s_setprio 3
    s_waitcnt lgkmcnt(12)
    v_mfma_f32_32x32x16_bf16 v[48:63], v[80:83], v[128:131], 0
    v_mfma_f32_16x16x32_bf16 v[112:115], v[120:123], v[80:83], 0
    ds_read_b64_tr_b16 v[100:101], v3 offset:16672
    ds_read_b64_tr_b16 v[102:103], v3 offset:16928
    s_waitcnt lgkmcnt(8)
    v_mov_b32 v116, v13
    v_and_b32 v117, 0xffff, v13
    v_mov_b32 v118, 0
    v_mov_b32 v119, 0
    v_add_f32 v104, v104, v105
    v_add_f32 v106, v106, v107
    v_add_f32 v106, v106, v104
    v_cvt_pk_bf16_f32 v104, v106, v106
    v_and_b32 v104, s60, v104
    v_sub_f32 v106, v106, v104
    v_cvt_pk_bf16_f32 v105, v106, v106
    v_and_b32 v107, s60, v105
    v_sub_f32 v106, v106, v107
    v_and_b32 v105, 0xffff, v105
    v_or_b32 v104, v104, v105
    v_cvt_pk_bf16_f32 v105, v106, v106
    v_mov_b32 v106, 0
    v_mov_b32 v107, 0
    v_add_f32 v108, v108, v109
    v_add_f32 v110, v110, v111
    v_add_f32 v110, v110, v108
    v_cvt_pk_bf16_f32 v108, v110, v110
    v_and_b32 v108, s60, v108
    v_sub_f32 v110, v110, v108
    v_cvt_pk_bf16_f32 v109, v110, v110
    v_and_b32 v111, s60, v109
    v_sub_f32 v110, v110, v111
    v_and_b32 v109, 0xffff, v109
    v_or_b32 v108, v108, v109
    v_cvt_pk_bf16_f32 v109, v110, v110
    v_mov_b32 v110, 0
    v_mov_b32 v111, 0
    v_mfma_f32_32x32x16_bf16 v[16:31], v[104:107], v[116:119], v[16:31]
    s_nop 0
    v_mfma_f32_32x32x16_bf16 v[32:47], v[108:111], v[116:119], v[32:47]
    s_waitcnt lgkmcnt(12)
    v_mfma_f32_32x32x16_bf16 v[48:63], v[84:87], v[132:135], v[48:63]
    ds_read_b64_tr_b16 v[80:81], v4 offset:16672
    ds_read_b64_tr_b16 v[82:83], v4 offset:16928
    s_add_u32 s56, s69, 82944
    buffer_load_dwordx4 v6, s[28:31], s56 offen offset:3072 lds
    s_waitcnt lgkmcnt(8)
    v_mfma_f32_32x32x16_bf16 v[48:63], v[88:91], v[136:139], v[48:63]
    ds_read_b64_tr_b16 v[84:85], v5 offset:16672
    ds_read_b64_tr_b16 v[86:87], v5 offset:16928
    v_mul_f32 v116, v16, v16
    v_mul_f32 v117, v17, v17
    v_fma_f32 v116, v116, v14, v8
    v_fma_f32 v117, v117, v14, v8
    v_mul_f32 v116, v16, v116
    v_mul_f32 v117, v17, v117
    s_waitcnt lgkmcnt(8)
    v_mfma_f32_32x32x16_bf16 v[48:63], v[92:95], v[140:143], v[48:63]
    ds_read_b64_tr_b16 v[88:89], v2 offset:17152
    ds_read_b64_tr_b16 v[90:91], v2 offset:17408
    v_exp_f32 v116, v116
    v_exp_f32 v117, v117
    v_mul_f32 v24, v16, v24
    v_mul_f32 v25, v17, v25
    v_fma_f32 v116, v116, v15, v15
    v_fma_f32 v117, v117, v15, v15
    s_waitcnt lgkmcnt(8)
    v_mfma_f32_32x32x16_bf16 v[48:63], v[96:99], v[144:147], v[48:63]
    v_mfma_f32_16x16x32_bf16 v[112:115], v[120:123], v[96:99], v[112:115]
    ds_read_b64_tr_b16 v[92:93], v3 offset:17152
    ds_read_b64_tr_b16 v[94:95], v3 offset:17408
    v_rcp_f32 v116, v116
    v_rcp_f32 v117, v117
    v_mul_f32 v24, v24, v116
    v_mul_f32 v25, v25, v117
    v_cvt_pk_bf16_f32 v16, v24, v25
    v_mul_f32 v118, v18, v18
    s_waitcnt lgkmcnt(8)
    v_mfma_f32_32x32x16_bf16 v[48:63], v[100:103], v[148:151], v[48:63]
    ds_read_b64_tr_b16 v[96:97], v4 offset:17152
    ds_read_b64_tr_b16 v[98:99], v4 offset:17408
    v_mul_f32 v119, v19, v19
    v_fma_f32 v118, v118, v14, v8
    v_fma_f32 v119, v119, v14, v8
    v_mul_f32 v118, v18, v118
    v_mul_f32 v119, v19, v119
    v_exp_f32 v118, v118
    s_waitcnt lgkmcnt(8)
    v_mfma_f32_32x32x16_bf16 v[48:63], v[80:83], v[152:155], v[48:63]
    s_waitcnt vmcnt(0)
    v_mov_b32 v11, 13
    ds_write_b32 v9, v11
    ds_read_b64_tr_b16 v[100:101], v5 offset:17152
    ds_read_b64_tr_b16 v[102:103], v5 offset:17408
    v_exp_f32 v119, v119
    v_mul_f32 v26, v18, v26
    v_mul_f32 v27, v19, v27
    v_fma_f32 v118, v118, v15, v15
    v_fma_f32 v119, v119, v15, v15
    v_rcp_f32 v118, v118
    s_waitcnt lgkmcnt(9)
    v_mfma_f32_32x32x16_bf16 v[48:63], v[84:87], v[156:159], v[48:63]
    ds_read_b64_tr_b16 v[80:81], v2 offset:17184
    ds_read_b64_tr_b16 v[82:83], v2 offset:17440
    v_rcp_f32 v119, v119
    v_mul_f32 v26, v26, v118
    v_mul_f32 v27, v27, v119
    v_cvt_pk_bf16_f32 v17, v26, v27
    v_mul_f32 v116, v20, v20
    v_mul_f32 v117, v21, v21
    s_waitcnt lgkmcnt(9)
    v_mfma_f32_32x32x16_bf16 v[48:63], v[88:91], v[160:163], v[48:63]
    v_mfma_f32_16x16x32_bf16 v[112:115], v[120:123], v[88:91], v[112:115]
    ds_read_b64_tr_b16 v[84:85], v3 offset:17184
    ds_read_b64_tr_b16 v[86:87], v3 offset:17440
    v_fma_f32 v116, v116, v14, v8
    v_fma_f32 v117, v117, v14, v8
    v_mul_f32 v116, v20, v116
    v_mul_f32 v117, v21, v117
    v_exp_f32 v116, v116
    v_exp_f32 v117, v117
    s_waitcnt lgkmcnt(9)
    v_mfma_f32_32x32x16_bf16 v[48:63], v[92:95], v[164:167], v[48:63]
    ds_read_b128 v[124:127], v10
    ds_read_b64_tr_b16 v[88:89], v4 offset:17184
    ds_read_b64_tr_b16 v[90:91], v4 offset:17440
    v_mul_f32 v28, v20, v28
    v_mul_f32 v29, v21, v29
    v_fma_f32 v116, v116, v15, v15
    v_fma_f32 v117, v117, v15, v15
    v_rcp_f32 v116, v116
    v_rcp_f32 v117, v117
    s_waitcnt lgkmcnt(10)
    v_mfma_f32_32x32x16_bf16 v[48:63], v[96:99], v[168:171], v[48:63]
    ds_read_b64_tr_b16 v[92:93], v5 offset:17184
    ds_read_b64_tr_b16 v[94:95], v5 offset:17440
    v_mul_f32 v28, v28, v116
    v_mul_f32 v29, v29, v117
    v_cvt_pk_bf16_f32 v18, v28, v29
    v_mul_f32 v118, v22, v22
    v_mul_f32 v119, v23, v23
    v_fma_f32 v118, v118, v14, v8
    s_waitcnt lgkmcnt(9)
    v_mfma_f32_32x32x16_bf16 v[48:63], v[100:103], v[172:175], v[48:63]
    s_waitcnt lgkmcnt(4)
    v_min3_u32 v11, v124, v125, v126
    v_min_u32 v11, v11, v127
    s_nop 0
    v_readfirstlane_b32 s58, v11
    s_nop 1
    s_cmp_ge_u32 s58, 13
    s_cbranch_scc0 parallel_sum__mha_block__glu_gated_geglu__prompt_kernel_gs13
parallel_sum__mha_block__glu_gated_geglu__prompt_kernel_gr13:
    ds_read_b64_tr_b16 v[96:97], v2 offset:33280
    ds_read_b64_tr_b16 v[98:99], v2 offset:33536
    v_fma_f32 v119, v119, v14, v8
    v_mul_f32 v118, v22, v118
    v_mul_f32 v119, v23, v119
    v_exp_f32 v118, v118
    v_exp_f32 v119, v119
    v_mul_f32 v30, v22, v30
    s_waitcnt lgkmcnt(9)
    v_mfma_f32_32x32x16_bf16 v[48:63], v[80:83], v[176:179], v[48:63]
    v_mfma_f32_16x16x32_bf16 v[112:115], v[120:123], v[80:83], v[112:115]
    ds_read_b64_tr_b16 v[100:101], v2 offset:33312
    ds_read_b64_tr_b16 v[102:103], v2 offset:33568
    v_mul_f32 v31, v23, v31
    v_fma_f32 v118, v118, v15, v15
    v_fma_f32 v119, v119, v15, v15
    v_rcp_f32 v118, v118
    v_rcp_f32 v119, v119
    v_mul_f32 v30, v30, v118
    s_waitcnt lgkmcnt(9)
    v_mfma_f32_32x32x16_bf16 v[48:63], v[84:87], v[180:183], v[48:63]
    ds_read_b64_tr_b16 v[80:81], v2 offset:33792
    ds_read_b64_tr_b16 v[82:83], v2 offset:34048
    v_mul_f32 v31, v31, v119
    v_cvt_pk_bf16_f32 v19, v30, v31
    s_lshl_b32 s3, s50, 5
    s_add_u32 s3, s3, s4
    s_add_u32 s3, s3, 0
    buffer_store_dwordx4 v[16:19], v1, s[36:39], s3 offen sc1
    s_waitcnt lgkmcnt(8)
    v_mfma_f32_32x32x16_bf16 v[48:63], v[88:91], v[184:187], v[48:63]
    ds_read_b64_tr_b16 v[84:85], v2 offset:33824
    ds_read_b64_tr_b16 v[86:87], v2 offset:34080
    v_mul_f32 v116, v32, v32
    v_mul_f32 v117, v33, v33
    v_fma_f32 v116, v116, v14, v8
    v_fma_f32 v117, v117, v14, v8
    v_mul_f32 v116, v32, v116
    v_mul_f32 v117, v33, v117
    s_waitcnt lgkmcnt(8)
    v_mfma_f32_32x32x16_bf16 v[48:63], v[92:95], v[188:191], v[48:63]
    ds_read_b64_tr_b16 v[88:89], v3 offset:33280
    ds_read_b64_tr_b16 v[90:91], v3 offset:33536
    v_exp_f32 v116, v116
    v_exp_f32 v117, v117
    v_mul_f32 v40, v32, v40
    v_mul_f32 v41, v33, v41
    v_fma_f32 v116, v116, v15, v15
    v_fma_f32 v117, v117, v15, v15
    s_waitcnt lgkmcnt(8)
    v_mfma_f32_32x32x16_bf16 v[48:63], v[96:99], v[192:195], v[48:63]
    v_mfma_f32_16x16x32_bf16 v[112:115], v[120:123], v[96:99], v[112:115]
    ds_read_b64_tr_b16 v[92:93], v4 offset:33280
    ds_read_b64_tr_b16 v[94:95], v4 offset:33536
    v_rcp_f32 v116, v116
    v_rcp_f32 v117, v117
    v_mul_f32 v40, v40, v116
    v_mul_f32 v41, v41, v117
    v_cvt_pk_bf16_f32 v32, v40, v41
    v_mul_f32 v118, v34, v34
    s_waitcnt lgkmcnt(8)
    v_mfma_f32_32x32x16_bf16 v[48:63], v[100:103], v[208:211], v[48:63]
    v_mfma_f32_16x16x32_bf16 v[112:115], v[120:123], v[100:103], v[112:115]
    ds_read_b64_tr_b16 v[96:97], v5 offset:33280
    ds_read_b64_tr_b16 v[98:99], v5 offset:33536
    v_mul_f32 v119, v35, v35
    v_fma_f32 v118, v118, v14, v8
    v_fma_f32 v119, v119, v14, v8
    v_mul_f32 v118, v34, v118
    v_mul_f32 v119, v35, v119
    v_exp_f32 v118, v118
    s_waitcnt lgkmcnt(8)
    v_mfma_f32_32x32x16_bf16 v[48:63], v[80:83], v[224:227], v[48:63]
    v_mfma_f32_16x16x32_bf16 v[112:115], v[120:123], v[80:83], v[112:115]
    ds_read_b64_tr_b16 v[100:101], v3 offset:33312
    ds_read_b64_tr_b16 v[102:103], v3 offset:33568
    v_exp_f32 v119, v119
    v_mul_f32 v42, v34, v42
    v_mul_f32 v43, v35, v43
    v_fma_f32 v118, v118, v15, v15
    v_fma_f32 v119, v119, v15, v15
    v_rcp_f32 v118, v118
    s_waitcnt lgkmcnt(8)
    v_mfma_f32_32x32x16_bf16 v[48:63], v[84:87], v[240:243], v[48:63]
    v_mfma_f32_16x16x32_bf16 v[112:115], v[120:123], v[84:87], v[112:115]
    ds_read_b64_tr_b16 v[80:81], v4 offset:33312
    ds_read_b64_tr_b16 v[82:83], v4 offset:33568
    v_rcp_f32 v119, v119
    v_mul_f32 v42, v42, v118
    v_mul_f32 v43, v43, v119
    v_cvt_pk_bf16_f32 v33, v42, v43
    v_mul_f32 v116, v36, v36
    v_mul_f32 v117, v37, v37
    s_waitcnt lgkmcnt(8)
    v_mfma_f32_32x32x16_bf16 v[48:63], v[88:91], v[196:199], v[48:63]
    ds_read_b64_tr_b16 v[84:85], v5 offset:33312
    ds_read_b64_tr_b16 v[86:87], v5 offset:33568
    v_fma_f32 v116, v116, v14, v8
    v_fma_f32 v117, v117, v14, v8
    v_mul_f32 v116, v36, v116
    v_mul_f32 v117, v37, v117
    v_exp_f32 v116, v116
    v_exp_f32 v117, v117
    s_waitcnt lgkmcnt(8)
    v_mfma_f32_32x32x16_bf16 v[48:63], v[92:95], v[200:203], v[48:63]
    v_and_b32 v12, 15, v0
    v_lshlrev_b32 v12, 3, v12
    s_lshl_b32 s58, s52, 7
    s_add_u32 s58, s58, 131072
    v_add_u32 v12, s58, v12
    s_mov_b64 exec, 0xffff
    ds_write_b64 v12, v[112:113] offset:31104
    s_mov_b64 exec, -1
    ds_read_b64_tr_b16 v[88:89], v3 offset:33792
    ds_read_b64_tr_b16 v[90:91], v3 offset:34048
    v_mul_f32 v44, v36, v44
    v_mul_f32 v45, v37, v45
    v_fma_f32 v116, v116, v15, v15
    v_fma_f32 v117, v117, v15, v15
    v_rcp_f32 v116, v116
    v_rcp_f32 v117, v117
    s_waitcnt lgkmcnt(9)
    v_mfma_f32_32x32x16_bf16 v[48:63], v[96:99], v[204:207], v[48:63]
    v_mov_b32 v11, 14
    ds_write_b32 v9, v11
    ds_read_b64_tr_b16 v[92:93], v4 offset:33792
    ds_read_b64_tr_b16 v[94:95], v4 offset:34048
    v_mul_f32 v44, v44, v116
    v_mul_f32 v45, v45, v117
    v_cvt_pk_bf16_f32 v34, v44, v45
    v_mul_f32 v118, v38, v38
    v_mul_f32 v119, v39, v39
    v_fma_f32 v118, v118, v14, v8
    s_waitcnt lgkmcnt(10)
    v_mfma_f32_32x32x16_bf16 v[48:63], v[100:103], v[212:215], v[48:63]
    ds_read_b64_tr_b16 v[96:97], v5 offset:33792
    ds_read_b64_tr_b16 v[98:99], v5 offset:34048
    v_fma_f32 v119, v119, v14, v8
    v_mul_f32 v118, v38, v118
    v_mul_f32 v119, v39, v119
    v_exp_f32 v118, v118
    v_exp_f32 v119, v119
    v_mul_f32 v46, v38, v46
    s_waitcnt lgkmcnt(10)
    v_mfma_f32_32x32x16_bf16 v[48:63], v[80:83], v[216:219], v[48:63]
    ds_read_b64_tr_b16 v[100:101], v3 offset:33824
    ds_read_b64_tr_b16 v[102:103], v3 offset:34080
    v_mul_f32 v47, v39, v47
    v_fma_f32 v118, v118, v15, v15
    v_fma_f32 v119, v119, v15, v15
    v_rcp_f32 v118, v118
    v_rcp_f32 v119, v119
    v_mul_f32 v46, v46, v118
    s_waitcnt lgkmcnt(10)
    v_mfma_f32_32x32x16_bf16 v[48:63], v[84:87], v[220:223], v[48:63]
    ds_read_b128 v[124:127], v10
    ds_read_b64_tr_b16 v[80:81], v4 offset:33824
    ds_read_b64_tr_b16 v[82:83], v4 offset:34080
    v_mul_f32 v47, v47, v119
    v_cvt_pk_bf16_f32 v35, v46, v47
    s_lshl_b32 s3, s50, 5
    s_add_u32 s3, s3, s4
    s_add_u32 s3, s3, 1024
    buffer_store_dwordx4 v[32:35], v1, s[36:39], s3 offen sc1
    s_setprio 0
    s_waitcnt lgkmcnt(10)
    v_mfma_f32_32x32x16_bf16 v[48:63], v[88:91], v[228:231], v[48:63]
    ds_read_b64_tr_b16 v[84:85], v5 offset:33824
    ds_read_b64_tr_b16 v[86:87], v5 offset:34080
    s_waitcnt lgkmcnt(9)
    v_mfma_f32_32x32x16_bf16 v[48:63], v[92:95], v[232:235], v[48:63]
    s_waitcnt lgkmcnt(4)
    s_setprio 3
    v_min3_u32 v11, v124, v125, v126
    v_min_u32 v11, v11, v127
    s_nop 0
    v_readfirstlane_b32 s58, v11
    s_nop 1
    s_cmp_ge_u32 s58, 14
    s_setprio 0
    s_cbranch_scc0 parallel_sum__mha_block__glu_gated_geglu__prompt_kernel_gs14
parallel_sum__mha_block__glu_gated_geglu__prompt_kernel_gr14:
    s_waitcnt lgkmcnt(7)
    v_mfma_f32_32x32x16_bf16 v[48:63], v[96:99], v[236:239], v[48:63]
    s_waitcnt lgkmcnt(5)
    v_mfma_f32_32x32x16_bf16 v[48:63], v[100:103], v[244:247], v[48:63]
    s_setprio 3
    v_and_b32 v12, 15, v0
    v_lshlrev_b32 v12, 3, v12
    v_bfe_u32 v112, v0, 4, 1
    v_lshl_add_u32 v12, v112, 2, v12
    v_add_u32 v12, 162176, v12
    ds_read2_b32 v[112:113], v12 offset0:0 offset1:32
    ds_read2_b32 v[114:115], v12 offset0:64 offset1:96
    s_setprio 0
    s_waitcnt lgkmcnt(4)
    v_mfma_f32_32x32x16_bf16 v[48:63], v[80:83], v[248:251], v[48:63]
    s_waitcnt lgkmcnt(2)
    v_mfma_f32_32x32x16_bf16 v[48:63], v[84:87], v[252:255], v[48:63]
    s_setprio 3
    v_mov_b32 v11, 15
    ds_write_b32 v9, v11
    s_waitcnt lgkmcnt(1)
    v_mov_b32 v116, v13
    v_and_b32 v117, 0xffff, v13
    v_mov_b32 v118, 0
    v_mov_b32 v119, 0
    v_add_f32 v112, v112, v113
    v_add_f32 v114, v114, v115
    v_add_f32 v114, v114, v112
    v_cvt_pk_bf16_f32 v112, v114, v114
    v_and_b32 v112, s60, v112
    v_sub_f32 v114, v114, v112
    v_cvt_pk_bf16_f32 v113, v114, v114
    v_and_b32 v115, s60, v113
    v_sub_f32 v114, v114, v115
    v_and_b32 v113, 0xffff, v113
    v_or_b32 v112, v112, v113
    v_cvt_pk_bf16_f32 v113, v114, v114
    v_mov_b32 v114, 0
    v_mov_b32 v115, 0
    s_nop 1
    v_mfma_f32_32x32x16_bf16 v[48:63], v[112:115], v[116:119], v[48:63]
    s_nop 11
    v_mul_f32 v116, v48, v48
    v_mul_f32 v117, v49, v49
    v_fma_f32 v116, v116, v14, v8
    v_fma_f32 v117, v117, v14, v8
    v_mul_f32 v116, v48, v116
    v_mul_f32 v117, v49, v117
    v_exp_f32 v116, v116
    v_exp_f32 v117, v117
    v_mul_f32 v56, v48, v56
    v_mul_f32 v57, v49, v57
    v_fma_f32 v116, v116, v15, v15
    v_fma_f32 v117, v117, v15, v15
    v_rcp_f32 v116, v116
    v_rcp_f32 v117, v117
    v_mul_f32 v56, v56, v116
    v_mul_f32 v57, v57, v117
    v_cvt_pk_bf16_f32 v48, v56, v57
    v_mul_f32 v118, v50, v50
    v_mul_f32 v119, v51, v51
    v_fma_f32 v118, v118, v14, v8
    v_fma_f32 v119, v119, v14, v8
    v_mul_f32 v118, v50, v118
    v_mul_f32 v119, v51, v119
    v_exp_f32 v118, v118
    v_exp_f32 v119, v119
    v_mul_f32 v58, v50, v58
    v_mul_f32 v59, v51, v59
    v_fma_f32 v118, v118, v15, v15
    v_fma_f32 v119, v119, v15, v15
    v_rcp_f32 v118, v118
    v_rcp_f32 v119, v119
    v_mul_f32 v58, v58, v118
    v_mul_f32 v59, v59, v119
    v_cvt_pk_bf16_f32 v49, v58, v59
    v_mul_f32 v116, v52, v52
    v_mul_f32 v117, v53, v53
    v_fma_f32 v116, v116, v14, v8
    v_fma_f32 v117, v117, v14, v8
    v_mul_f32 v116, v52, v116
    v_mul_f32 v117, v53, v117
    v_exp_f32 v116, v116
    v_exp_f32 v117, v117
    v_mul_f32 v60, v52, v60
    v_mul_f32 v61, v53, v61
    v_fma_f32 v116, v116, v15, v15
    v_fma_f32 v117, v117, v15, v15
    v_rcp_f32 v116, v116
    v_rcp_f32 v117, v117
    v_mul_f32 v60, v60, v116
    v_mul_f32 v61, v61, v117
    v_cvt_pk_bf16_f32 v50, v60, v61
    v_mul_f32 v118, v54, v54
    v_mul_f32 v119, v55, v55
    v_fma_f32 v118, v118, v14, v8
    v_fma_f32 v119, v119, v14, v8
    v_mul_f32 v118, v54, v118
    v_mul_f32 v119, v55, v119
    v_exp_f32 v118, v118
    v_exp_f32 v119, v119
    v_mul_f32 v62, v54, v62
    v_mul_f32 v63, v55, v63
    v_fma_f32 v118, v118, v15, v15
    v_fma_f32 v119, v119, v15, v15
    v_rcp_f32 v118, v118
    v_rcp_f32 v119, v119
    v_mul_f32 v62, v62, v118
    v_mul_f32 v63, v63, v119
    v_cvt_pk_bf16_f32 v51, v62, v63
    s_lshl_b32 s3, s49, 5
    s_add_u32 s3, s3, s4
    s_add_u32 s3, s3, 0
    buffer_store_dwordx4 v[48:51], v1, s[36:39], s3 offen sc1
    s_mov_b32 s28, s16
    s_and_b32 s29, s17, 0xffff
    s_mov_b32 s30, 1835008
    s_lshr_b32 s56, s62, 1
    s_lshl_b32 s14, s53, 1
    s_add_u32 s14, s14, s56
    s_and_b32 s15, s62, 1
    s_lshl_b32 s15, s15, 2
    s_lshr_b32 s57, s63, 3
    s_add_u32 s15, s15, s57
    s_mul_i32 s8, s52, 10240
    s_add_u32 s8, s8, 98304
    s_lshl_b32 s9, s14, 16
    s_lshl_b32 s57, s52, 13
    s_add_u32 s9, s9, s57
    s_add_u32 s9, s9, 6291456
    s_mul_i32 s10, s14, 229376
    s_mul_i32 s57, s52, 28672
    s_add_u32 s10, s10, s57
    s_add_u32 s10, s10, 8388608
    s_lshl_b32 s57, s15, 7
    s_lshl_b32 s11, s52, 17
    s_add_u32 s11, s11, s57
    s_mul_i32 s12, s52, 458752
    s_add_u32 s12, s12, s57
    s_lshl_b32 s13, s14, 16
    s_add_u32 s13, s13, s57
    v_and_b32 v17, 63, v0
    v_bfe_u32 v18, v17, 4, 1
    v_lshlrev_b32 v19, 2, v18
    v_and_b32 v20, 7, v17
    v_xor_b32 v19, v19, v20
    v_lshlrev_b32 v19, 4, v19
    v_lshrrev_b32 v20, 3, v17
    v_lshl_add_u32 v2, v20, 10, v19
    v_bfe_u32 v20, v17, 2, 2
    v_lshrrev_b32 v21, 5, v17
    v_lshl_add_u32 v22, v21, 2, v20
    v_lshlrev_b32 v22, 7, v22
    v_lshl_add_u32 v22, v18, 5, v22
    v_and_b32 v23, 3, v17
    v_lshl_add_u32 v22, v23, 3, v22
    v_add_u32 v22, s8, v22
    v_lshrrev_b32 v20, 1, v20
    v_lshl_add_u32 v3, v20, 6, v22
    v_xor_b32 v20, 1, v20
    v_lshl_add_u32 v4, v20, 6, v22
    v_lshrrev_b32 v20, 3, v0
    v_and_b32 v21, 7, v0
    v_lshlrev_b32 v21, 4, v21
    v_lshl_add_u32 v5, v20, 10, v21
    v_lshrrev_b32 v24, 2, v17
    v_lshlrev_b32 v24, 10, v24
    v_lshl_add_u32 v24, v23, 7, v24
    s_lshl_b32 s57, s53, 4
    s_add_u32 s57, s57, s54
    s_lshl_b32 s57, s57, 8
    s_add_u32 s57, s57, 15794176
    s_waitcnt vmcnt(0)
    v_mov_b32 v16, 161060
    v_mov_b32 v17, 1
    s_mov_b64 exec, 1
    ds_add_rtn_u32 v17, v16, v17
    s_mov_b64 exec, -1
    s_waitcnt lgkmcnt(0)
    v_readfirstlane_b32 s58, v17
    s_nop 1
    s_cmp_lg_u32 s58, 3
    s_cbranch_scc1 parallel_sum__mha_block__glu_gated_geglu__prompt_kernel_p2
    v_mov_b32 v17, s61
    v_mov_b32 v16, 0
    s_mov_b64 exec, 1
    buffer_store_dword v17, v16, s[36:39], s57 offen sc1
    s_mov_b64 exec, -1
parallel_sum__mha_block__glu_gated_geglu__prompt_kernel_p2:
    s_lshl_b32 s56, s63, 2
    s_add_u32 s56, s56, s52
    s_and_b32 s57, s62, 1
    s_lshl_b32 s57, s57, 9
    s_mul_i32 s58, s56, 14336
    s_add_u32 s58, s58, s57
    buffer_load_dword v25, v24, s[28:31], s58 offen
    s_lshl_b32 s58, s56, 12
    s_add_u32 s58, s58, s57
    s_mov_b64 exec, 0xffff
    buffer_load_dword v25, v24, s[32:35], s58 offen
    s_mov_b64 exec, -1
    s_mov_b32 s59, 200000
parallel_sum__mha_block__glu_gated_geglu__prompt_kernel_gfin:
    ds_read_b128 v[120:123], v10
    s_sub_u32 s59, s59, 1
    s_cmp_eq_u32 s59, 0
    s_waitcnt lgkmcnt(0)
    s_cbranch_scc1 parallel_sum__mha_block__glu_gated_geglu__prompt_kernel_gfin_x
    v_min3_u32 v126, v120, v121, v122
    v_min_u32 v126, v126, v123
    s_nop 0
    v_readfirstlane_b32 s58, v126
    s_nop 1
    s_cmp_ge_u32 s58, 15
    s_cbranch_scc0 parallel_sum__mha_block__glu_gated_geglu__prompt_kernel_gfin
parallel_sum__mha_block__glu_gated_geglu__prompt_kernel_gfin_x:
    s_add_u32 m0, s8, 0
    s_add_u32 s56, s11, 0
    buffer_load_dwordx4 v2, s[32:35], s56 offen lds
    s_add_u32 s56, s11, 7168
    buffer_load_dwordx4 v2, s[32:35], s56 offen offset:1024 lds
    s_add_u32 m0, s8, 2048
    s_add_u32 s56, s11, 16384
    buffer_load_dwordx4 v2, s[32:35], s56 offen lds
    s_add_u32 s56, s11, 23552
    buffer_load_dwordx4 v2, s[32:35], s56 offen offset:1024 lds
    s_add_u32 m0, s8, 4096
    s_add_u32 s56, s11, 32768
    buffer_load_dwordx4 v2, s[32:35], s56 offen lds
    s_add_u32 s56, s11, 39936
    buffer_load_dwordx4 v2, s[32:35], s56 offen offset:1024 lds
    s_add_u32 m0, s8, 6144
    s_add_u32 s56, s11, 49152
    buffer_load_dwordx4 v2, s[32:35], s56 offen lds
    s_add_u32 s56, s11, 56320
    buffer_load_dwordx4 v2, s[32:35], s56 offen offset:1024 lds
    s_add_u32 m0, s8, 8192
    s_add_u32 s56, s11, 65536
    buffer_load_dwordx4 v2, s[32:35], s56 offen lds
    s_add_u32 s56, s11, 72704
    buffer_load_dwordx4 v2, s[32:35], s56 offen offset:1024 lds
    buffer_load_dwordx4 v[112:115], v5, s[24:27], s13 offen
    s_add_u32 s57, s13, 32768
    buffer_load_dwordx4 v[116:119], v5, s[24:27], s57 offen
    s_waitcnt vmcnt(10)
    ds_read_b64_tr_b16 v[128:129], v3 offset:0
    ds_read_b64_tr_b16 v[130:131], v3 offset:1024
    ds_read_b64_tr_b16 v[132:133], v4 offset:0
    ds_read_b64_tr_b16 v[134:135], v4 offset:1024
    s_waitcnt lgkmcnt(0)
    s_add_u32 m0, s8, 0
    s_add_u32 s56, s11, 81920
    buffer_load_dwordx4 v2, s[32:35], s56 offen lds
    s_add_u32 s56, s11, 89088
    buffer_load_dwordx4 v2, s[32:35], s56 offen offset:1024 lds
    s_waitcnt vmcnt(10)
    ds_read_b64_tr_b16 v[136:137], v3 offset:2048
    ds_read_b64_tr_b16 v[138:139], v3 offset:3072
    ds_read_b64_tr_b16 v[140:141], v4 offset:2048
    ds_read_b64_tr_b16 v[142:143], v4 offset:3072
    s_waitcnt lgkmcnt(0)
    s_add_u32 m0, s8, 2048
    s_add_u32 s56, s11, 98304
    buffer_load_dwordx4 v2, s[32:35], s56 offen lds
    s_add_u32 s56, s11, 105472
    buffer_load_dwordx4 v2, s[32:35], s56 offen offset:1024 lds
    s_waitcnt vmcnt(10)
    ds_read_b64_tr_b16 v[144:145], v3 offset:4096
    ds_read_b64_tr_b16 v[146:147], v3 offset:5120
    ds_read_b64_tr_b16 v[148:149], v4 offset:4096
    ds_read_b64_tr_b16 v[150:151], v4 offset:5120
    s_waitcnt lgkmcnt(0)
    s_add_u32 m0, s8, 4096
    s_add_u32 s56, s11, 114688
    buffer_load_dwordx4 v2, s[32:35], s56 offen lds
    s_add_u32 s56, s11, 121856
    buffer_load_dwordx4 v2, s[32:35], s56 offen offset:1024 lds
    s_waitcnt vmcnt(10)
    ds_read_b64_tr_b16 v[152:153], v3 offset:6144
    ds_read_b64_tr_b16 v[154:155], v3 offset:7168
    ds_read_b64_tr_b16 v[156:157], v4 offset:6144
    ds_read_b64_tr_b16 v[158:159], v4 offset:7168
    s_waitcnt lgkmcnt(0)
    s_add_u32 m0, s8, 6144
    s_add_u32 s56, s12, 0
    buffer_load_dwordx4 v2, s[28:31], s56 offen lds
    s_add_u32 s56, s12, 7168
    buffer_load_dwordx4 v2, s[28:31], s56 offen offset:1024 lds
    s_waitcnt vmcnt(10)
    ds_read_b64_tr_b16 v[160:161], v3 offset:8192
    ds_read_b64_tr_b16 v[162:163], v3 offset:9216
    ds_read_b64_tr_b16 v[164:165], v4 offset:8192
    ds_read_b64_tr_b16 v[166:167], v4 offset:9216
    s_waitcnt lgkmcnt(0)
    s_add_u32 m0, s8, 8192
    s_add_u32 s56, s12, 16384
    buffer_load_dwordx4 v2, s[28:31], s56 offen lds
    s_add_u32 s56, s12, 23552
    buffer_load_dwordx4 v2, s[28:31], s56 offen offset:1024 lds
    s_waitcnt vmcnt(8)
    ds_read_b64_tr_b16 v[168:169], v3 offset:0
    ds_read_b64_tr_b16 v[170:171], v3 offset:1024
    ds_read_b64_tr_b16 v[172:173], v4 offset:0
    ds_read_b64_tr_b16 v[174:175], v4 offset:1024
    s_waitcnt lgkmcnt(0)
    s_add_u32 m0, s8, 0
    s_add_u32 s56, s12, 32768
    buffer_load_dwordx4 v2, s[28:31], s56 offen lds
    s_add_u32 s56, s12, 39936
    buffer_load_dwordx4 v2, s[28:31], s56 offen offset:1024 lds
    s_waitcnt vmcnt(8)
    ds_read_b64_tr_b16 v[176:177], v3 offset:2048
    ds_read_b64_tr_b16 v[178:179], v3 offset:3072
    ds_read_b64_tr_b16 v[180:181], v4 offset:2048
    ds_read_b64_tr_b16 v[182:183], v4 offset:3072
    s_waitcnt lgkmcnt(0)
    s_add_u32 m0, s8, 2048
    s_add_u32 s56, s12, 49152
    buffer_load_dwordx4 v2, s[28:31], s56 offen lds
    s_add_u32 s56, s12, 56320
    buffer_load_dwordx4 v2, s[28:31], s56 offen offset:1024 lds
    s_waitcnt vmcnt(8)
    ds_read_b64_tr_b16 v[184:185], v3 offset:4096
    ds_read_b64_tr_b16 v[186:187], v3 offset:5120
    ds_read_b64_tr_b16 v[188:189], v4 offset:4096
    ds_read_b64_tr_b16 v[190:191], v4 offset:5120
    s_waitcnt lgkmcnt(0)
    s_add_u32 m0, s8, 4096
    s_add_u32 s56, s12, 65536
    buffer_load_dwordx4 v2, s[28:31], s56 offen lds
    s_add_u32 s56, s12, 72704
    buffer_load_dwordx4 v2, s[28:31], s56 offen offset:1024 lds
    v_and_b32 v17, 3, v0
    v_lshlrev_b32 v6, 8, v17
    s_lshl_b32 s57, s53, 12
    s_lshl_b32 s58, s52, 10
    s_add_u32 s57, s57, s58
    s_add_u32 s57, s57, 15794176
    s_mov_b32 s59, 200000
parallel_sum__mha_block__glu_gated_geglu__prompt_kernel_e2:
    buffer_load_dword v16, v6, s[36:39], s57 offen sc1
    s_sub_u32 s59, s59, 1
    s_cmp_eq_u32 s59, 0
    s_cbranch_scc1 parallel_sum__mha_block__glu_gated_geglu__prompt_kernel_e2_x
    s_waitcnt vmcnt(0)
    v_cmp_ne_u32 vcc, s61, v16
    s_nop 1
    s_cbranch_vccz parallel_sum__mha_block__glu_gated_geglu__prompt_kernel_e2_x
    s_sleep 4
    s_branch parallel_sum__mha_block__glu_gated_geglu__prompt_kernel_e2
parallel_sum__mha_block__glu_gated_geglu__prompt_kernel_e2_x:
    s_waitcnt vmcnt(0)
    s_setprio 0
    s_add_u32 s56, s10, 0
    buffer_load_dwordx4 v[192:195], v1, s[36:39], s56 offen sc1
    s_add_u32 s56, s10, 114688
    buffer_load_dwordx4 v[196:199], v1, s[36:39], s56 offen sc1
    s_add_u32 s56, s10, 1024
    buffer_load_dwordx4 v[200:203], v1, s[36:39], s56 offen sc1
    s_add_u32 s56, s10, 115712
    buffer_load_dwordx4 v[204:207], v1, s[36:39], s56 offen sc1
    s_add_u32 s56, s10, 2048
    buffer_load_dwordx4 v[208:211], v1, s[36:39], s56 offen sc1
    s_add_u32 s56, s10, 116736
    buffer_load_dwordx4 v[212:215], v1, s[36:39], s56 offen sc1
    s_add_u32 s56, s10, 3072
    buffer_load_dwordx4 v[216:219], v1, s[36:39], s56 offen sc1
    s_add_u32 s56, s10, 117760
    buffer_load_dwordx4 v[220:223], v1, s[36:39], s56 offen sc1
    s_add_u32 s56, s10, 4096
    buffer_load_dwordx4 v[224:227], v1, s[36:39], s56 offen sc1
    s_add_u32 s56, s10, 118784
    buffer_load_dwordx4 v[228:231], v1, s[36:39], s56 offen sc1
    s_add_u32 s56, s10, 5120
    buffer_load_dwordx4 v[232:235], v1, s[36:39], s56 offen sc1
    s_add_u32 s56, s10, 119808
    buffer_load_dwordx4 v[236:239], v1, s[36:39], s56 offen sc1
    s_add_u32 s56, s10, 6144
    buffer_load_dwordx4 v[240:243], v1, s[36:39], s56 offen sc1
    s_add_u32 s56, s10, 120832
    buffer_load_dwordx4 v[244:247], v1, s[36:39], s56 offen sc1
    s_add_u32 s56, s10, 7168
    buffer_load_dwordx4 v[248:251], v1, s[36:39], s56 offen sc1
    s_add_u32 s56, s10, 121856
    buffer_load_dwordx4 v[252:255], v1, s[36:39], s56 offen sc1
    ds_read_b64_tr_b16 v[80:81], v3 offset:6144
    ds_read_b64_tr_b16 v[82:83], v3 offset:7168
    ds_read_b64_tr_b16 v[84:85], v4 offset:6144
    ds_read_b64_tr_b16 v[86:87], v4 offset:7168
    ds_read_b64_tr_b16 v[88:89], v3 offset:8192
    ds_read_b64_tr_b16 v[90:91], v3 offset:9216
    ds_read_b64_tr_b16 v[92:93], v4 offset:8192
    ds_read_b64_tr_b16 v[94:95], v4 offset:9216
    s_waitcnt vmcnt(14)
    s_waitcnt lgkmcnt(4)
    v_mfma_f32_32x32x16_bf16 v[16:31], v[80:83], v[192:195], 0
    s_add_u32 m0, s8, 6144
    s_add_u32 s56, s12, 81920
    buffer_load_dwordx4 v2, s[28:31], s56 offen lds
    v_mfma_f32_32x32x16_bf16 v[32:47], v[80:83], v[196:199], 0
    s_add_u32 s56, s12, 89088
    buffer_load_dwordx4 v2, s[28:31], s56 offen offset:1024 lds
    v_mfma_f32_32x32x16_bf16 v[48:63], v[84:87], v[192:195], 0
    v_mfma_f32_32x32x16_bf16 v[64:79], v[84:87], v[196:199], 0
    s_add_u32 s56, s10, 8192
    buffer_load_dwordx4 v[192:195], v1, s[36:39], s56 offen sc1
    s_add_u32 s56, s10, 122880
    buffer_load_dwordx4 v[196:199], v1, s[36:39], s56 offen sc1
    ds_read_b64_tr_b16 v[80:81], v3 offset:0
    ds_read_b64_tr_b16 v[82:83], v3 offset:1024
    ds_read_b64_tr_b16 v[84:85], v4 offset:0
    ds_read_b64_tr_b16 v[86:87], v4 offset:1024
    s_waitcnt vmcnt(16)
    s_waitcnt lgkmcnt(4)
    v_mfma_f32_32x32x16_bf16 v[16:31], v[88:91], v[200:203], v[16:31]
    s_add_u32 m0, s8, 8192
    s_add_u32 s56, s12, 98304
    buffer_load_dwordx4 v2, s[28:31], s56 offen lds
    v_mfma_f32_32x32x16_bf16 v[32:47], v[88:91], v[204:207], v[32:47]
    s_add_u32 s56, s12, 105472
    buffer_load_dwordx4 v2, s[28:31], s56 offen offset:1024 lds
    v_mfma_f32_32x32x16_bf16 v[48:63], v[92:95], v[200:203], v[48:63]
    v_mfma_f32_32x32x16_bf16 v[64:79], v[92:95], v[204:207], v[64:79]
    s_add_u32 s56, s10, 9216
    buffer_load_dwordx4 v[200:203], v1, s[36:39], s56 offen sc1
    s_add_u32 s56, s10, 123904
    buffer_load_dwordx4 v[204:207], v1, s[36:39], s56 offen sc1
    ds_read_b64_tr_b16 v[88:89], v3 offset:2048
    ds_read_b64_tr_b16 v[90:91], v3 offset:3072
    ds_read_b64_tr_b16 v[92:93], v4 offset:2048
    ds_read_b64_tr_b16 v[94:95], v4 offset:3072
    s_waitcnt vmcnt(18)
    s_waitcnt lgkmcnt(4)
    v_mfma_f32_32x32x16_bf16 v[16:31], v[80:83], v[208:211], v[16:31]
    s_add_u32 m0, s8, 0
    s_add_u32 s56, s12, 114688
    buffer_load_dwordx4 v2, s[28:31], s56 offen lds
    v_mfma_f32_32x32x16_bf16 v[32:47], v[80:83], v[212:215], v[32:47]
    s_add_u32 s56, s12, 121856
    buffer_load_dwordx4 v2, s[28:31], s56 offen offset:1024 lds
    v_mfma_f32_32x32x16_bf16 v[48:63], v[84:87], v[208:211], v[48:63]
    v_mfma_f32_32x32x16_bf16 v[64:79], v[84:87], v[212:215], v[64:79]
    s_add_u32 s56, s10, 10240
    buffer_load_dwordx4 v[208:211], v1, s[36:39], s56 offen sc1
    s_add_u32 s56, s10, 124928
    buffer_load_dwordx4 v[212:215], v1, s[36:39], s56 offen sc1
    ds_read_b64_tr_b16 v[80:81], v3 offset:4096
    ds_read_b64_tr_b16 v[82:83], v3 offset:5120
    ds_read_b64_tr_b16 v[84:85], v4 offset:4096
    ds_read_b64_tr_b16 v[86:87], v4 offset:5120
    s_waitcnt vmcnt(20)
    s_waitcnt lgkmcnt(4)
    v_mfma_f32_32x32x16_bf16 v[16:31], v[88:91], v[216:219], v[16:31]
    s_add_u32 m0, s8, 2048
    s_add_u32 s56, s12, 131072
    buffer_load_dwordx4 v2, s[28:31], s56 offen lds
    v_mfma_f32_32x32x16_bf16 v[32:47], v[88:91], v[220:223], v[32:47]
    s_add_u32 s56, s12, 138240
    buffer_load_dwordx4 v2, s[28:31], s56 offen offset:1024 lds
    v_mfma_f32_32x32x16_bf16 v[48:63], v[92:95], v[216:219], v[48:63]
    v_mfma_f32_32x32x16_bf16 v[64:79], v[92:95], v[220:223], v[64:79]
    s_add_u32 s56, s10, 11264
    buffer_load_dwordx4 v[216:219], v1, s[36:39], s56 offen sc1
    s_add_u32 s56, s10, 125952
    buffer_load_dwordx4 v[220:223], v1, s[36:39], s56 offen sc1
    s_waitcnt vmcnt(14)
    ds_read_b64_tr_b16 v[88:89], v3 offset:6144
    ds_read_b64_tr_b16 v[90:91], v3 offset:7168
    ds_read_b64_tr_b16 v[92:93], v4 offset:6144
    ds_read_b64_tr_b16 v[94:95], v4 offset:7168
    s_waitcnt vmcnt(22)
    s_waitcnt lgkmcnt(4)
    v_mfma_f32_32x32x16_bf16 v[16:31], v[80:83], v[224:227], v[16:31]
    s_add_u32 m0, s8, 4096
    s_add_u32 s56, s12, 147456
    buffer_load_dwordx4 v2, s[28:31], s56 offen lds
    v_mfma_f32_32x32x16_bf16 v[32:47], v[80:83], v[228:231], v[32:47]
    s_add_u32 s56, s12, 154624
    buffer_load_dwordx4 v2, s[28:31], s56 offen offset:1024 lds
    v_mfma_f32_32x32x16_bf16 v[48:63], v[84:87], v[224:227], v[48:63]
    v_mfma_f32_32x32x16_bf16 v[64:79], v[84:87], v[228:231], v[64:79]
    s_add_u32 s56, s10, 12288
    buffer_load_dwordx4 v[224:227], v1, s[36:39], s56 offen sc1
    s_add_u32 s56, s10, 126976
    buffer_load_dwordx4 v[228:231], v1, s[36:39], s56 offen sc1
    s_waitcnt vmcnt(14)
    ds_read_b64_tr_b16 v[80:81], v3 offset:8192
    ds_read_b64_tr_b16 v[82:83], v3 offset:9216
    ds_read_b64_tr_b16 v[84:85], v4 offset:8192
    ds_read_b64_tr_b16 v[86:87], v4 offset:9216
    s_waitcnt vmcnt(24)
    s_waitcnt lgkmcnt(4)
    v_mfma_f32_32x32x16_bf16 v[16:31], v[88:91], v[232:235], v[16:31]
    s_add_u32 m0, s8, 6144
    s_add_u32 s56, s12, 163840
    buffer_load_dwordx4 v2, s[28:31], s56 offen lds
    v_mfma_f32_32x32x16_bf16 v[32:47], v[88:91], v[236:239], v[32:47]
    s_add_u32 s56, s12, 171008
    buffer_load_dwordx4 v2, s[28:31], s56 offen offset:1024 lds
    v_mfma_f32_32x32x16_bf16 v[48:63], v[92:95], v[232:235], v[48:63]
    v_mfma_f32_32x32x16_bf16 v[64:79], v[92:95], v[236:239], v[64:79]
    s_add_u32 s56, s10, 13312
    buffer_load_dwordx4 v[232:235], v1, s[36:39], s56 offen sc1
    s_add_u32 s56, s10, 128000
    buffer_load_dwordx4 v[236:239], v1, s[36:39], s56 offen sc1
    s_waitcnt vmcnt(14)
    ds_read_b64_tr_b16 v[88:89], v3 offset:0
    ds_read_b64_tr_b16 v[90:91], v3 offset:1024
    ds_read_b64_tr_b16 v[92:93], v4 offset:0
    ds_read_b64_tr_b16 v[94:95], v4 offset:1024
    s_waitcnt vmcnt(26)
    s_waitcnt lgkmcnt(4)
    v_mfma_f32_32x32x16_bf16 v[16:31], v[80:83], v[240:243], v[16:31]
    s_add_u32 m0, s8, 8192
    s_add_u32 s56, s12, 180224
    buffer_load_dwordx4 v2, s[28:31], s56 offen lds
    v_mfma_f32_32x32x16_bf16 v[32:47], v[80:83], v[244:247], v[32:47]
    s_add_u32 s56, s12, 187392
    buffer_load_dwordx4 v2, s[28:31], s56 offen offset:1024 lds
    v_mfma_f32_32x32x16_bf16 v[48:63], v[84:87], v[240:243], v[48:63]
    v_mfma_f32_32x32x16_bf16 v[64:79], v[84:87], v[244:247], v[64:79]
    s_add_u32 s56, s10, 14336
    buffer_load_dwordx4 v[240:243], v1, s[36:39], s56 offen sc1
    s_add_u32 s56, s10, 129024
    buffer_load_dwordx4 v[244:247], v1, s[36:39], s56 offen sc1
    s_waitcnt vmcnt(14)
    ds_read_b64_tr_b16 v[80:81], v3 offset:2048
    ds_read_b64_tr_b16 v[82:83], v3 offset:3072
    ds_read_b64_tr_b16 v[84:85], v4 offset:2048
    ds_read_b64_tr_b16 v[86:87], v4 offset:3072
    s_waitcnt vmcnt(28)
    s_waitcnt lgkmcnt(4)
    v_mfma_f32_32x32x16_bf16 v[16:31], v[88:91], v[248:251], v[16:31]
    s_add_u32 m0, s8, 0
    s_add_u32 s56, s12, 196608
    buffer_load_dwordx4 v2, s[28:31], s56 offen lds
    v_mfma_f32_32x32x16_bf16 v[32:47], v[88:91], v[252:255], v[32:47]
    s_add_u32 s56, s12, 203776
    buffer_load_dwordx4 v2, s[28:31], s56 offen offset:1024 lds
    v_mfma_f32_32x32x16_bf16 v[48:63], v[92:95], v[248:251], v[48:63]
    v_mfma_f32_32x32x16_bf16 v[64:79], v[92:95], v[252:255], v[64:79]
    s_add_u32 s56, s10, 15360
    buffer_load_dwordx4 v[248:251], v1, s[36:39], s56 offen sc1
    s_add_u32 s56, s10, 130048
    buffer_load_dwordx4 v[252:255], v1, s[36:39], s56 offen sc1
    s_waitcnt vmcnt(14)
    ds_read_b64_tr_b16 v[88:89], v3 offset:4096
    ds_read_b64_tr_b16 v[90:91], v3 offset:5120
    ds_read_b64_tr_b16 v[92:93], v4 offset:4096
    ds_read_b64_tr_b16 v[94:95], v4 offset:5120
    s_waitcnt vmcnt(28)
    s_waitcnt lgkmcnt(4)
    v_mfma_f32_32x32x16_bf16 v[16:31], v[80:83], v[192:195], v[16:31]
    s_add_u32 m0, s8, 2048
    s_add_u32 s56, s12, 212992
    buffer_load_dwordx4 v2, s[28:31], s56 offen lds
    v_mfma_f32_32x32x16_bf16 v[32:47], v[80:83], v[196:199], v[32:47]
    s_add_u32 s56, s12, 220160
    buffer_load_dwordx4 v2, s[28:31], s56 offen offset:1024 lds
    v_mfma_f32_32x32x16_bf16 v[48:63], v[84:87], v[192:195], v[48:63]
    v_mfma_f32_32x32x16_bf16 v[64:79], v[84:87], v[196:199], v[64:79]
    s_add_u32 s56, s10, 16384
    buffer_load_dwordx4 v[192:195], v1, s[36:39], s56 offen sc1
    s_add_u32 s56, s10, 131072
    buffer_load_dwordx4 v[196:199], v1, s[36:39], s56 offen sc1
    s_waitcnt vmcnt(14)
    ds_read_b64_tr_b16 v[80:81], v3 offset:6144
    ds_read_b64_tr_b16 v[82:83], v3 offset:7168
    ds_read_b64_tr_b16 v[84:85], v4 offset:6144
    ds_read_b64_tr_b16 v[86:87], v4 offset:7168
    s_waitcnt vmcnt(28)
    s_waitcnt lgkmcnt(4)
    v_mfma_f32_32x32x16_bf16 v[16:31], v[88:91], v[200:203], v[16:31]
    s_add_u32 m0, s8, 4096
    s_add_u32 s56, s12, 229376
    buffer_load_dwordx4 v2, s[28:31], s56 offen lds
    v_mfma_f32_32x32x16_bf16 v[32:47], v[88:91], v[204:207], v[32:47]
    s_add_u32 s56, s12, 236544
    buffer_load_dwordx4 v2, s[28:31], s56 offen offset:1024 lds
    v_mfma_f32_32x32x16_bf16 v[48:63], v[92:95], v[200:203], v[48:63]
    v_mfma_f32_32x32x16_bf16 v[64:79], v[92:95], v[204:207], v[64:79]
    s_add_u32 s56, s10, 17408
    buffer_load_dwordx4 v[200:203], v1, s[36:39], s56 offen sc1
    s_add_u32 s56, s10, 132096
    buffer_load_dwordx4 v[204:207], v1, s[36:39], s56 offen sc1
    s_waitcnt vmcnt(14)
    ds_read_b64_tr_b16 v[88:89], v3 offset:8192
    ds_read_b64_tr_b16 v[90:91], v3 offset:9216
    ds_read_b64_tr_b16 v[92:93], v4 offset:8192
    ds_read_b64_tr_b16 v[94:95], v4 offset:9216
    s_waitcnt vmcnt(28)
    s_waitcnt lgkmcnt(4)
    v_mfma_f32_32x32x16_bf16 v[16:31], v[80:83], v[208:211], v[16:31]
    s_add_u32 m0, s8, 6144
    s_add_u32 s56, s12, 245760
    buffer_load_dwordx4 v2, s[28:31], s56 offen lds
    v_mfma_f32_32x32x16_bf16 v[32:47], v[80:83], v[212:215], v[32:47]
    s_add_u32 s56, s12, 252928
    buffer_load_dwordx4 v2, s[28:31], s56 offen offset:1024 lds
    v_mfma_f32_32x32x16_bf16 v[48:63], v[84:87], v[208:211], v[48:63]
    v_mfma_f32_32x32x16_bf16 v[64:79], v[84:87], v[212:215], v[64:79]
    s_add_u32 s56, s10, 18432
    buffer_load_dwordx4 v[208:211], v1, s[36:39], s56 offen sc1
    s_add_u32 s56, s10, 133120
    buffer_load_dwordx4 v[212:215], v1, s[36:39], s56 offen sc1
    s_waitcnt vmcnt(14)
    ds_read_b64_tr_b16 v[80:81], v3 offset:0
    ds_read_b64_tr_b16 v[82:83], v3 offset:1024
    ds_read_b64_tr_b16 v[84:85], v4 offset:0
    ds_read_b64_tr_b16 v[86:87], v4 offset:1024
    s_waitcnt vmcnt(28)
    s_waitcnt lgkmcnt(4)
    v_mfma_f32_32x32x16_bf16 v[16:31], v[88:91], v[216:219], v[16:31]
    s_add_u32 m0, s8, 8192
    s_add_u32 s56, s12, 262144
    buffer_load_dwordx4 v2, s[28:31], s56 offen lds
    v_mfma_f32_32x32x16_bf16 v[32:47], v[88:91], v[220:223], v[32:47]
    s_add_u32 s56, s12, 269312
    buffer_load_dwordx4 v2, s[28:31], s56 offen offset:1024 lds
    v_mfma_f32_32x32x16_bf16 v[48:63], v[92:95], v[216:219], v[48:63]
    v_mfma_f32_32x32x16_bf16 v[64:79], v[92:95], v[220:223], v[64:79]
    s_add_u32 s56, s10, 19456
    buffer_load_dwordx4 v[216:219], v1, s[36:39], s56 offen sc1
    s_add_u32 s56, s10, 134144
    buffer_load_dwordx4 v[220:223], v1, s[36:39], s56 offen sc1
    s_waitcnt vmcnt(14)
    ds_read_b64_tr_b16 v[88:89], v3 offset:2048
    ds_read_b64_tr_b16 v[90:91], v3 offset:3072
    ds_read_b64_tr_b16 v[92:93], v4 offset:2048
    ds_read_b64_tr_b16 v[94:95], v4 offset:3072
    s_waitcnt vmcnt(28)
    s_waitcnt lgkmcnt(4)
    v_mfma_f32_32x32x16_bf16 v[16:31], v[80:83], v[224:227], v[16:31]
    s_add_u32 m0, s8, 0
    s_add_u32 s56, s12, 278528
    buffer_load_dwordx4 v2, s[28:31], s56 offen lds
    v_mfma_f32_32x32x16_bf16 v[32:47], v[80:83], v[228:231], v[32:47]
    s_add_u32 s56, s12, 285696
    buffer_load_dwordx4 v2, s[28:31], s56 offen offset:1024 lds
    v_mfma_f32_32x32x16_bf16 v[48:63], v[84:87], v[224:227], v[48:63]
    v_mfma_f32_32x32x16_bf16 v[64:79], v[84:87], v[228:231], v[64:79]
    s_add_u32 s56, s10, 20480
    buffer_load_dwordx4 v[224:227], v1, s[36:39], s56 offen sc1
    s_add_u32 s56, s10, 135168
    buffer_load_dwordx4 v[228:231], v1, s[36:39], s56 offen sc1
    s_waitcnt vmcnt(14)
    ds_read_b64_tr_b16 v[80:81], v3 offset:4096
    ds_read_b64_tr_b16 v[82:83], v3 offset:5120
    ds_read_b64_tr_b16 v[84:85], v4 offset:4096
    ds_read_b64_tr_b16 v[86:87], v4 offset:5120
    s_waitcnt vmcnt(28)
    s_waitcnt lgkmcnt(4)
    v_mfma_f32_32x32x16_bf16 v[16:31], v[88:91], v[232:235], v[16:31]
    s_add_u32 m0, s8, 2048
    s_add_u32 s56, s12, 294912
    buffer_load_dwordx4 v2, s[28:31], s56 offen lds
    v_mfma_f32_32x32x16_bf16 v[32:47], v[88:91], v[236:239], v[32:47]
    s_add_u32 s56, s12, 302080
    buffer_load_dwordx4 v2, s[28:31], s56 offen offset:1024 lds
    v_mfma_f32_32x32x16_bf16 v[48:63], v[92:95], v[232:235], v[48:63]
    v_mfma_f32_32x32x16_bf16 v[64:79], v[92:95], v[236:239], v[64:79]
    s_add_u32 s56, s10, 21504
    buffer_load_dwordx4 v[232:235], v1, s[36:39], s56 offen sc1
    s_add_u32 s56, s10, 136192
    buffer_load_dwordx4 v[236:239], v1, s[36:39], s56 offen sc1
    s_waitcnt vmcnt(14)
    ds_read_b64_tr_b16 v[88:89], v3 offset:6144
    ds_read_b64_tr_b16 v[90:91], v3 offset:7168
    ds_read_b64_tr_b16 v[92:93], v4 offset:6144
    ds_read_b64_tr_b16 v[94:95], v4 offset:7168
    s_waitcnt vmcnt(28)
    s_waitcnt lgkmcnt(4)
    v_mfma_f32_32x32x16_bf16 v[16:31], v[80:83], v[240:243], v[16:31]
    s_add_u32 m0, s8, 4096
    s_add_u32 s56, s12, 311296
    buffer_load_dwordx4 v2, s[28:31], s56 offen lds
    v_mfma_f32_32x32x16_bf16 v[32:47], v[80:83], v[244:247], v[32:47]
    s_add_u32 s56, s12, 318464
    buffer_load_dwordx4 v2, s[28:31], s56 offen offset:1024 lds
    v_mfma_f32_32x32x16_bf16 v[48:63], v[84:87], v[240:243], v[48:63]
    v_mfma_f32_32x32x16_bf16 v[64:79], v[84:87], v[244:247], v[64:79]
    s_add_u32 s56, s10, 22528
    buffer_load_dwordx4 v[240:243], v1, s[36:39], s56 offen sc1
    s_add_u32 s56, s10, 137216
    buffer_load_dwordx4 v[244:247], v1, s[36:39], s56 offen sc1
    s_waitcnt vmcnt(14)
    ds_read_b64_tr_b16 v[80:81], v3 offset:8192
    ds_read_b64_tr_b16 v[82:83], v3 offset:9216
    ds_read_b64_tr_b16 v[84:85], v4 offset:8192
    ds_read_b64_tr_b16 v[86:87], v4 offset:9216
    s_waitcnt vmcnt(28)
    s_waitcnt lgkmcnt(4)
    v_mfma_f32_32x32x16_bf16 v[16:31], v[88:91], v[248:251], v[16:31]
    s_add_u32 m0, s8, 6144
    s_add_u32 s56, s12, 327680
    buffer_load_dwordx4 v2, s[28:31], s56 offen lds
    v_mfma_f32_32x32x16_bf16 v[32:47], v[88:91], v[252:255], v[32:47]
    s_add_u32 s56, s12, 334848
    buffer_load_dwordx4 v2, s[28:31], s56 offen offset:1024 lds
    v_mfma_f32_32x32x16_bf16 v[48:63], v[92:95], v[248:251], v[48:63]
    v_mfma_f32_32x32x16_bf16 v[64:79], v[92:95], v[252:255], v[64:79]
    s_add_u32 s56, s10, 23552
    buffer_load_dwordx4 v[248:251], v1, s[36:39], s56 offen sc1
    s_add_u32 s56, s10, 138240
    buffer_load_dwordx4 v[252:255], v1, s[36:39], s56 offen sc1
    s_waitcnt vmcnt(14)
    ds_read_b64_tr_b16 v[88:89], v3 offset:0
    ds_read_b64_tr_b16 v[90:91], v3 offset:1024
    ds_read_b64_tr_b16 v[92:93], v4 offset:0
    ds_read_b64_tr_b16 v[94:95], v4 offset:1024
    s_waitcnt vmcnt(28)
    s_waitcnt lgkmcnt(4)
    v_mfma_f32_32x32x16_bf16 v[16:31], v[80:83], v[192:195], v[16:31]
    s_add_u32 m0, s8, 8192
    s_add_u32 s56, s12, 344064
    buffer_load_dwordx4 v2, s[28:31], s56 offen lds
    v_mfma_f32_32x32x16_bf16 v[32:47], v[80:83], v[196:199], v[32:47]
    s_add_u32 s56, s12, 351232
    buffer_load_dwordx4 v2, s[28:31], s56 offen offset:1024 lds
    v_mfma_f32_32x32x16_bf16 v[48:63], v[84:87], v[192:195], v[48:63]
    v_mfma_f32_32x32x16_bf16 v[64:79], v[84:87], v[196:199], v[64:79]
    s_add_u32 s56, s10, 24576
    buffer_load_dwordx4 v[192:195], v1, s[36:39], s56 offen sc1
    s_add_u32 s56, s10, 139264
    buffer_load_dwordx4 v[196:199], v1, s[36:39], s56 offen sc1
    s_waitcnt vmcnt(14)
    ds_read_b64_tr_b16 v[80:81], v3 offset:2048
    ds_read_b64_tr_b16 v[82:83], v3 offset:3072
    ds_read_b64_tr_b16 v[84:85], v4 offset:2048
    ds_read_b64_tr_b16 v[86:87], v4 offset:3072
    s_waitcnt vmcnt(28)
    s_waitcnt lgkmcnt(4)
    v_mfma_f32_32x32x16_bf16 v[16:31], v[88:91], v[200:203], v[16:31]
    s_add_u32 m0, s8, 0
    s_add_u32 s56, s12, 360448
    buffer_load_dwordx4 v2, s[28:31], s56 offen lds
    v_mfma_f32_32x32x16_bf16 v[32:47], v[88:91], v[204:207], v[32:47]
    s_add_u32 s56, s12, 367616
    buffer_load_dwordx4 v2, s[28:31], s56 offen offset:1024 lds
    v_mfma_f32_32x32x16_bf16 v[48:63], v[92:95], v[200:203], v[48:63]
    v_mfma_f32_32x32x16_bf16 v[64:79], v[92:95], v[204:207], v[64:79]
    s_add_u32 s56, s10, 25600
    buffer_load_dwordx4 v[200:203], v1, s[36:39], s56 offen sc1
    s_add_u32 s56, s10, 140288
    buffer_load_dwordx4 v[204:207], v1, s[36:39], s56 offen sc1
    s_waitcnt vmcnt(14)
    ds_read_b64_tr_b16 v[88:89], v3 offset:4096
    ds_read_b64_tr_b16 v[90:91], v3 offset:5120
    ds_read_b64_tr_b16 v[92:93], v4 offset:4096
    ds_read_b64_tr_b16 v[94:95], v4 offset:5120
    s_waitcnt vmcnt(28)
    s_waitcnt lgkmcnt(4)
    v_mfma_f32_32x32x16_bf16 v[16:31], v[80:83], v[208:211], v[16:31]
    s_add_u32 m0, s8, 2048
    s_add_u32 s56, s12, 376832
    buffer_load_dwordx4 v2, s[28:31], s56 offen lds
    v_mfma_f32_32x32x16_bf16 v[32:47], v[80:83], v[212:215], v[32:47]
    s_add_u32 s56, s12, 384000
    buffer_load_dwordx4 v2, s[28:31], s56 offen offset:1024 lds
    v_mfma_f32_32x32x16_bf16 v[48:63], v[84:87], v[208:211], v[48:63]
    v_mfma_f32_32x32x16_bf16 v[64:79], v[84:87], v[212:215], v[64:79]
    s_add_u32 s56, s10, 26624
    buffer_load_dwordx4 v[208:211], v1, s[36:39], s56 offen sc1
    s_add_u32 s56, s10, 141312
    buffer_load_dwordx4 v[212:215], v1, s[36:39], s56 offen sc1
    s_waitcnt vmcnt(14)
    ds_read_b64_tr_b16 v[80:81], v3 offset:6144
    ds_read_b64_tr_b16 v[82:83], v3 offset:7168
    ds_read_b64_tr_b16 v[84:85], v4 offset:6144
    ds_read_b64_tr_b16 v[86:87], v4 offset:7168
    s_waitcnt vmcnt(28)
    s_waitcnt lgkmcnt(4)
    v_mfma_f32_32x32x16_bf16 v[16:31], v[88:91], v[216:219], v[16:31]
    s_add_u32 m0, s8, 4096
    s_add_u32 s56, s12, 393216
    buffer_load_dwordx4 v2, s[28:31], s56 offen lds
    v_mfma_f32_32x32x16_bf16 v[32:47], v[88:91], v[220:223], v[32:47]
    s_add_u32 s56, s12, 400384
    buffer_load_dwordx4 v2, s[28:31], s56 offen offset:1024 lds
    v_mfma_f32_32x32x16_bf16 v[48:63], v[92:95], v[216:219], v[48:63]
    v_mfma_f32_32x32x16_bf16 v[64:79], v[92:95], v[220:223], v[64:79]
    s_add_u32 s56, s10, 27648
    buffer_load_dwordx4 v[216:219], v1, s[36:39], s56 offen sc1
    s_add_u32 s56, s10, 142336
    buffer_load_dwordx4 v[220:223], v1, s[36:39], s56 offen sc1
    s_waitcnt lgkmcnt(0)
    s_add_u32 m0, s8, 6144
    s_add_u32 s56, s12, 409600
    buffer_load_dwordx4 v2, s[28:31], s56 offen lds
    s_add_u32 s56, s12, 416768
    buffer_load_dwordx4 v2, s[28:31], s56 offen offset:1024 lds
    s_waitcnt vmcnt(16)
    ds_read_b64_tr_b16 v[88:89], v3 offset:8192
    ds_read_b64_tr_b16 v[90:91], v3 offset:9216
    ds_read_b64_tr_b16 v[92:93], v4 offset:8192
    ds_read_b64_tr_b16 v[94:95], v4 offset:9216
    s_waitcnt lgkmcnt(0)
    s_add_u32 m0, s8, 8192
    s_add_u32 s56, s12, 425984
    buffer_load_dwordx4 v2, s[28:31], s56 offen lds
    s_add_u32 s56, s12, 433152
    buffer_load_dwordx4 v2, s[28:31], s56 offen offset:1024 lds
    s_waitcnt vmcnt(14)
    ds_read_b64_tr_b16 v[96:97], v3 offset:0
    ds_read_b64_tr_b16 v[98:99], v3 offset:1024
    ds_read_b64_tr_b16 v[100:101], v4 offset:0
    ds_read_b64_tr_b16 v[102:103], v4 offset:1024
    s_waitcnt lgkmcnt(0)
    s_add_u32 m0, s8, 0
    s_add_u32 s56, s12, 442368
    buffer_load_dwordx4 v2, s[28:31], s56 offen lds
    s_add_u32 s56, s12, 449536
    buffer_load_dwordx4 v2, s[28:31], s56 offen offset:1024 lds
    v_and_b32 v120, 7, v0
    v_lshlrev_b32 v6, 8, v120
    s_lshl_b32 s10, s14, 13
    s_lshl_b32 s58, s52, 11
    s_add_u32 s10, s10, s58
    s_add_u32 s10, s10, 15859712
    v_mov_b32 v120, 161040
    s_mov_b32 s59, 200000
parallel_sum__mha_block__glu_gated_geglu__prompt_kernel_ae:
    ds_read_b128 v[124:127], v120
    s_sub_u32 s59, s59, 1
    s_cmp_eq_u32 s59, 0
    s_waitcnt lgkmcnt(0)
    s_cbranch_scc1 parallel_sum__mha_block__glu_gated_geglu__prompt_kernel_ae_x
    v_min3_u32 v124, v124, v125, v126
    v_min_u32 v124, v124, v127
    s_nop 0
    v_readfirstlane_b32 s58, v124
    s_nop 1
    s_cmp_lg_u32 s58, 0
    s_cbranch_scc1 parallel_sum__mha_block__glu_gated_geglu__prompt_kernel_ae_x
    s_sleep 8
    s_branch parallel_sum__mha_block__glu_gated_geglu__prompt_kernel_ae
parallel_sum__mha_block__glu_gated_geglu__prompt_kernel_ae_x:
    s_setprio 1
    s_waitcnt vmcnt(0)
    s_waitcnt lgkmcnt(9)
    v_mfma_f32_32x32x16_bf16 v[16:31], v[80:83], v[224:227], v[16:31]
    v_mfma_f32_32x32x16_bf16 v[32:47], v[80:83], v[228:231], v[32:47]
    v_mfma_f32_32x32x16_bf16 v[48:63], v[84:87], v[224:227], v[48:63]
    v_mfma_f32_32x32x16_bf16 v[64:79], v[84:87], v[228:231], v[64:79]
    s_waitcnt lgkmcnt(5)
    v_mfma_f32_32x32x16_bf16 v[16:31], v[88:91], v[232:235], v[16:31]
    v_mfma_f32_32x32x16_bf16 v[32:47], v[88:91], v[236:239], v[32:47]
    v_mfma_f32_32x32x16_bf16 v[48:63], v[92:95], v[232:235], v[48:63]
    v_mfma_f32_32x32x16_bf16 v[64:79], v[92:95], v[236:239], v[64:79]
    ds_read_b64_tr_b16 v[88:89], v3 offset:2048
    ds_read_b64_tr_b16 v[90:91], v3 offset:3072
    ds_read_b64_tr_b16 v[92:93], v4 offset:2048
    ds_read_b64_tr_b16 v[94:95], v4 offset:3072
    s_waitcnt lgkmcnt(5)
    v_mfma_f32_32x32x16_bf16 v[16:31], v[96:99], v[240:243], v[16:31]
    v_mfma_f32_32x32x16_bf16 v[32:47], v[96:99], v[244:247], v[32:47]
    v_mfma_f32_32x32x16_bf16 v[48:63], v[100:103], v[240:243], v[48:63]
    v_mfma_f32_32x32x16_bf16 v[64:79], v[100:103], v[244:247], v[64:79]
    ds_read_b64_tr_b16 v[80:81], v3 offset:4096
    ds_read_b64_tr_b16 v[82:83], v3 offset:5120
    ds_read_b64_tr_b16 v[84:85], v4 offset:4096
    ds_read_b64_tr_b16 v[86:87], v4 offset:5120
    s_waitcnt lgkmcnt(4)
    v_mfma_f32_32x32x16_bf16 v[16:31], v[88:91], v[248:251], v[16:31]
    v_mfma_f32_32x32x16_bf16 v[32:47], v[88:91], v[252:255], v[32:47]
    v_mfma_f32_32x32x16_bf16 v[48:63], v[92:95], v[248:251], v[48:63]
    v_mfma_f32_32x32x16_bf16 v[64:79], v[92:95], v[252:255], v[64:79]
    ds_read_b64_tr_b16 v[88:89], v3 offset:6144
    ds_read_b64_tr_b16 v[90:91], v3 offset:7168
    ds_read_b64_tr_b16 v[92:93], v4 offset:6144
    ds_read_b64_tr_b16 v[94:95], v4 offset:7168
    s_waitcnt lgkmcnt(4)
    v_mfma_f32_32x32x16_bf16 v[16:31], v[80:83], v[192:195], v[16:31]
    v_mfma_f32_32x32x16_bf16 v[32:47], v[80:83], v[196:199], v[32:47]
    v_mfma_f32_32x32x16_bf16 v[48:63], v[84:87], v[192:195], v[48:63]
    v_mfma_f32_32x32x16_bf16 v[64:79], v[84:87], v[196:199], v[64:79]
    ds_read_b64_tr_b16 v[80:81], v3 offset:8192
    ds_read_b64_tr_b16 v[82:83], v3 offset:9216
    ds_read_b64_tr_b16 v[84:85], v4 offset:8192
    ds_read_b64_tr_b16 v[86:87], v4 offset:9216
    s_waitcnt lgkmcnt(4)
    v_mfma_f32_32x32x16_bf16 v[16:31], v[88:91], v[200:203], v[16:31]
    v_mfma_f32_32x32x16_bf16 v[32:47], v[88:91], v[204:207], v[32:47]
    v_mfma_f32_32x32x16_bf16 v[48:63], v[92:95], v[200:203], v[48:63]
    v_mfma_f32_32x32x16_bf16 v[64:79], v[92:95], v[204:207], v[64:79]
    ds_read_b64_tr_b16 v[88:89], v3 offset:0
    ds_read_b64_tr_b16 v[90:91], v3 offset:1024
    ds_read_b64_tr_b16 v[92:93], v4 offset:0
    ds_read_b64_tr_b16 v[94:95], v4 offset:1024
    s_waitcnt lgkmcnt(4)
    v_mfma_f32_32x32x16_bf16 v[16:31], v[80:83], v[208:211], v[16:31]
    v_mfma_f32_32x32x16_bf16 v[32:47], v[80:83], v[212:215], v[32:47]
    v_mfma_f32_32x32x16_bf16 v[48:63], v[84:87], v[208:211], v[48:63]
    v_mfma_f32_32x32x16_bf16 v[64:79], v[84:87], v[212:215], v[64:79]
    s_waitcnt lgkmcnt(0)
    v_mfma_f32_32x32x16_bf16 v[16:31], v[88:91], v[216:219], v[16:31]
    v_mfma_f32_32x32x16_bf16 v[32:47], v[88:91], v[220:223], v[32:47]
    v_mfma_f32_32x32x16_bf16 v[48:63], v[92:95], v[216:219], v[48:63]
    v_mfma_f32_32x32x16_bf16 v[64:79], v[92:95], v[220:223], v[64:79]
    v_mov_b32 v120, 161068
    s_mov_b32 s59, 200000
parallel_sum__mha_block__glu_gated_geglu__prompt_kernel_ad:
    ds_read_b32 v121, v120
    s_sub_u32 s59, s59, 1
    s_cmp_eq_u32 s59, 0
    s_waitcnt lgkmcnt(0)
    s_cbranch_scc1 parallel_sum__mha_block__glu_gated_geglu__prompt_kernel_ad_x
    v_readfirstlane_b32 s58, v121
    s_nop 1
    s_cmp_ge_u32 s58, 4
    s_cbranch_scc1 parallel_sum__mha_block__glu_gated_geglu__prompt_kernel_ad_x
    s_sleep 1
    s_branch parallel_sum__mha_block__glu_gated_geglu__prompt_kernel_ad
parallel_sum__mha_block__glu_gated_geglu__prompt_kernel_ad_x:
    v_and_b32 v7, 31, v0
    v_mul_u32_u24 v7, 272, v7
    v_bfe_u32 v8, v0, 5, 1
    v_lshl_add_u32 v7, v8, 4, v7
    s_mul_i32 s57, s52, 17408
    v_add_u32 v7, s57, v7
    v_lshrrev_b32 v8, 3, v0
    v_mul_u32_u24 v8, 272, v8
    v_and_b32 v9, 7, v0
    v_lshl_add_u32 v8, v9, 5, v8
    v_lshlrev_b32 v80, 16, v112
    v_and_b32 v81, s60, v112
    v_lshlrev_b32 v82, 16, v113
    v_and_b32 v83, s60, v113
    v_lshlrev_b32 v84, 16, v114
    v_and_b32 v85, s60, v114
    v_lshlrev_b32 v86, 16, v115
    v_and_b32 v87, s60, v115
    v_lshlrev_b32 v88, 16, v116
    v_and_b32 v89, s60, v116
    v_lshlrev_b32 v90, 16, v117
    v_and_b32 v91, s60, v117
    v_lshlrev_b32 v92, 16, v118
    v_and_b32 v93, s60, v118
    v_lshlrev_b32 v94, 16, v119
    v_and_b32 v95, s60, v119
    s_mov_b32 s12, 0
    s_bitcmp1_b32 s12, 0
    s_cbranch_scc0 parallel_sum__mha_block__glu_gated_geglu__prompt_kernel_e3p0
parallel_sum__mha_block__glu_gated_geglu__prompt_kernel_e3r0:
    s_add_u32 s56, s9, 0
    buffer_load_dwordx4 v[192:195], v1, s[36:39], s56 offen sc1
    s_add_u32 s56, s9, 32768
    buffer_load_dwordx4 v[196:199], v1, s[36:39], s56 offen sc1
    s_bitcmp1_b32 s12, 1
    s_cbranch_scc0 parallel_sum__mha_block__glu_gated_geglu__prompt_kernel_e3p1
parallel_sum__mha_block__glu_gated_geglu__prompt_kernel_e3r1:
    s_add_u32 s56, s9, 1024
    buffer_load_dwordx4 v[200:203], v1, s[36:39], s56 offen sc1
    s_add_u32 s56, s9, 33792
    buffer_load_dwordx4 v[204:207], v1, s[36:39], s56 offen sc1
    s_bitcmp1_b32 s12, 2
    s_cbranch_scc0 parallel_sum__mha_block__glu_gated_geglu__prompt_kernel_e3p2
parallel_sum__mha_block__glu_gated_geglu__prompt_kernel_e3r2:
    s_add_u32 s56, s9, 2048
    buffer_load_dwordx4 v[208:211], v1, s[36:39], s56 offen sc1
    s_add_u32 s56, s9, 34816
    buffer_load_dwordx4 v[212:215], v1, s[36:39], s56 offen sc1
    s_bitcmp1_b32 s12, 3
    s_cbranch_scc0 parallel_sum__mha_block__glu_gated_geglu__prompt_kernel_e3p3
parallel_sum__mha_block__glu_gated_geglu__prompt_kernel_e3r3:
    s_add_u32 s56, s9, 3072
    buffer_load_dwordx4 v[216:219], v1, s[36:39], s56 offen sc1
    s_add_u32 s56, s9, 35840
    buffer_load_dwordx4 v[220:223], v1, s[36:39], s56 offen sc1
    s_bitcmp1_b32 s12, 4
    s_cbranch_scc0 parallel_sum__mha_block__glu_gated_geglu__prompt_kernel_e3p4
parallel_sum__mha_block__glu_gated_geglu__prompt_kernel_e3r4:
    s_add_u32 s56, s9, 4096
    buffer_load_dwordx4 v[224:227], v1, s[36:39], s56 offen sc1
    s_add_u32 s56, s9, 36864
    buffer_load_dwordx4 v[228:231], v1, s[36:39], s56 offen sc1
    s_waitcnt vmcnt(8)
    v_mfma_f32_32x32x16_bf16 v[16:31], v[128:131], v[192:195], v[16:31]
    v_mfma_f32_32x32x16_bf16 v[32:47], v[128:131], v[196:199], v[32:47]
    v_mfma_f32_32x32x16_bf16 v[48:63], v[132:135], v[192:195], v[48:63]
    v_mfma_f32_32x32x16_bf16 v[64:79], v[132:135], v[196:199], v[64:79]
    s_bitcmp1_b32 s12, 5
    s_cbranch_scc0 parallel_sum__mha_block__glu_gated_geglu__prompt_kernel_e3p5
parallel_sum__mha_block__glu_gated_geglu__prompt_kernel_e3r5:
    s_add_u32 s56, s9, 5120
    buffer_load_dwordx4 v[232:235], v1, s[36:39], s56 offen sc1
    s_add_u32 s56, s9, 37888
    buffer_load_dwordx4 v[236:239], v1, s[36:39], s56 offen sc1
    s_waitcnt vmcnt(8)
    v_mfma_f32_32x32x16_bf16 v[16:31], v[136:139], v[200:203], v[16:31]
    v_mfma_f32_32x32x16_bf16 v[32:47], v[136:139], v[204:207], v[32:47]
    v_mfma_f32_32x32x16_bf16 v[48:63], v[140:143], v[200:203], v[48:63]
    v_mfma_f32_32x32x16_bf16 v[64:79], v[140:143], v[204:207], v[64:79]
    s_bitcmp1_b32 s12, 6
    s_cbranch_scc0 parallel_sum__mha_block__glu_gated_geglu__prompt_kernel_e3p6
parallel_sum__mha_block__glu_gated_geglu__prompt_kernel_e3r6:
    s_add_u32 s56, s9, 6144
    buffer_load_dwordx4 v[240:243], v1, s[36:39], s56 offen sc1
    s_add_u32 s56, s9, 38912
    buffer_load_dwordx4 v[244:247], v1, s[36:39], s56 offen sc1
    s_waitcnt vmcnt(8)
    v_mfma_f32_32x32x16_bf16 v[16:31], v[144:147], v[208:211], v[16:31]
    v_mfma_f32_32x32x16_bf16 v[32:47], v[144:147], v[212:215], v[32:47]
    v_mfma_f32_32x32x16_bf16 v[48:63], v[148:151], v[208:211], v[48:63]
    v_mfma_f32_32x32x16_bf16 v[64:79], v[148:151], v[212:215], v[64:79]
    s_bitcmp1_b32 s12, 7
    s_cbranch_scc0 parallel_sum__mha_block__glu_gated_geglu__prompt_kernel_e3p7
parallel_sum__mha_block__glu_gated_geglu__prompt_kernel_e3r7:
    s_add_u32 s56, s9, 7168
    buffer_load_dwordx4 v[248:251], v1, s[36:39], s56 offen sc1
    s_add_u32 s56, s9, 39936
    buffer_load_dwordx4 v[252:255], v1, s[36:39], s56 offen sc1
    s_waitcnt vmcnt(8)
    v_mfma_f32_32x32x16_bf16 v[16:31], v[152:155], v[216:219], v[16:31]
    v_mfma_f32_32x32x16_bf16 v[32:47], v[152:155], v[220:223], v[32:47]
    v_mfma_f32_32x32x16_bf16 v[48:63], v[156:159], v[216:219], v[48:63]
    v_mfma_f32_32x32x16_bf16 v[64:79], v[156:159], v[220:223], v[64:79]
    s_waitcnt vmcnt(6)
    v_mfma_f32_32x32x16_bf16 v[16:31], v[160:163], v[224:227], v[16:31]
    v_mfma_f32_32x32x16_bf16 v[32:47], v[160:163], v[228:231], v[32:47]
    v_mfma_f32_32x32x16_bf16 v[48:63], v[164:167], v[224:227], v[48:63]
    v_mfma_f32_32x32x16_bf16 v[64:79], v[164:167], v[228:231], v[64:79]
    s_waitcnt vmcnt(4)
    v_mfma_f32_32x32x16_bf16 v[16:31], v[168:171], v[232:235], v[16:31]
    v_mfma_f32_32x32x16_bf16 v[32:47], v[168:171], v[236:239], v[32:47]
    v_mfma_f32_32x32x16_bf16 v[48:63], v[172:175], v[232:235], v[48:63]
    v_mfma_f32_32x32x16_bf16 v[64:79], v[172:175], v[236:239], v[64:79]
    s_waitcnt vmcnt(2)
    v_mfma_f32_32x32x16_bf16 v[16:31], v[176:179], v[240:243], v[16:31]
    v_mfma_f32_32x32x16_bf16 v[32:47], v[176:179], v[244:247], v[32:47]
    v_mfma_f32_32x32x16_bf16 v[48:63], v[180:183], v[240:243], v[48:63]
    v_mfma_f32_32x32x16_bf16 v[64:79], v[180:183], v[244:247], v[64:79]
    s_waitcnt vmcnt(0)
    v_mfma_f32_32x32x16_bf16 v[16:31], v[184:187], v[248:251], v[16:31]
    v_mfma_f32_32x32x16_bf16 v[32:47], v[184:187], v[252:255], v[32:47]
    v_mfma_f32_32x32x16_bf16 v[48:63], v[188:191], v[248:251], v[48:63]
    v_mfma_f32_32x32x16_bf16 v[64:79], v[188:191], v[252:255], v[64:79]
    s_nop 8
    ds_write_b128 v7, v[16:19] offset:0
    ds_write_b128 v7, v[20:23] offset:32
    ds_write_b128 v7, v[24:27] offset:64
    ds_write_b128 v7, v[28:31] offset:96
    ds_write_b128 v7, v[32:35] offset:8704
    ds_write_b128 v7, v[36:39] offset:8736
    ds_write_b128 v7, v[40:43] offset:8768
    ds_write_b128 v7, v[44:47] offset:8800
    ds_write_b128 v7, v[48:51] offset:128
    ds_write_b128 v7, v[52:55] offset:160
    ds_write_b128 v7, v[56:59] offset:192
    ds_write_b128 v7, v[60:63] offset:224
    ds_write_b128 v7, v[64:67] offset:8832
    ds_write_b128 v7, v[68:71] offset:8864
    ds_write_b128 v7, v[72:75] offset:8896
    ds_write_b128 v7, v[76:79] offset:8928
    s_waitcnt lgkmcnt(0)
    s_barrier
    ds_read_b128 v[128:131], v8 offset:0
    ds_read_b128 v[132:135], v8 offset:16
    ds_read_b128 v[136:139], v8 offset:17408
    ds_read_b128 v[140:143], v8 offset:17424
    ds_read_b128 v[144:147], v8 offset:34816
    ds_read_b128 v[148:151], v8 offset:34832
    ds_read_b128 v[152:155], v8 offset:52224
    ds_read_b128 v[156:159], v8 offset:52240
    ds_read_b128 v[160:163], v8 offset:8704
    ds_read_b128 v[164:167], v8 offset:8720
    ds_read_b128 v[168:171], v8 offset:26112
    ds_read_b128 v[172:175], v8 offset:26128
    ds_read_b128 v[176:179], v8 offset:43520
    ds_read_b128 v[180:183], v8 offset:43536
    ds_read_b128 v[184:187], v8 offset:60928
    ds_read_b128 v[188:191], v8 offset:60944
    s_add_u32 s57, s13, 32768
    s_waitcnt lgkmcnt(8)
    v_add_f32 v128, v128, v136
    v_add_f32 v129, v129, v137
    v_add_f32 v130, v130, v138
    v_add_f32 v131, v131, v139
    v_add_f32 v132, v132, v140
    v_add_f32 v133, v133, v141
    v_add_f32 v134, v134, v142
    v_add_f32 v135, v135, v143
    v_add_f32 v144, v144, v152
    v_add_f32 v145, v145, v153
    v_add_f32 v146, v146, v154
    v_add_f32 v147, v147, v155
    v_add_f32 v148, v148, v156
    v_add_f32 v149, v149, v157
    v_add_f32 v150, v150, v158
    v_add_f32 v151, v151, v159
    v_add_f32 v128, v128, v80
    v_add_f32 v129, v129, v81
    v_add_f32 v130, v130, v82
    v_add_f32 v131, v131, v83
    v_add_f32 v132, v132, v84
    v_add_f32 v133, v133, v85
    v_add_f32 v134, v134, v86
    v_add_f32 v135, v135, v87
    v_add_f32 v128, v128, v144
    v_add_f32 v129, v129, v145
    v_add_f32 v130, v130, v146
    v_add_f32 v131, v131, v147
    v_add_f32 v132, v132, v148
    v_add_f32 v133, v133, v149
    v_add_f32 v134, v134, v150
    v_add_f32 v135, v135, v151
    v_cvt_pk_bf16_f32 v128, v128, v129
    v_cvt_pk_bf16_f32 v129, v130, v131
    v_cvt_pk_bf16_f32 v130, v132, v133
    v_cvt_pk_bf16_f32 v131, v134, v135
    buffer_store_dwordx4 v[128:131], v5, s[40:43], s13 offen
    s_waitcnt lgkmcnt(0)
    v_add_f32 v160, v160, v168
    v_add_f32 v161, v161, v169
    v_add_f32 v162, v162, v170
    v_add_f32 v163, v163, v171
    v_add_f32 v164, v164, v172
    v_add_f32 v165, v165, v173
    v_add_f32 v166, v166, v174
    v_add_f32 v167, v167, v175
    v_add_f32 v176, v176, v184
    v_add_f32 v177, v177, v185
    v_add_f32 v178, v178, v186
    v_add_f32 v179, v179, v187
    v_add_f32 v180, v180, v188
    v_add_f32 v181, v181, v189
    v_add_f32 v182, v182, v190
    v_add_f32 v183, v183, v191
    v_add_f32 v160, v160, v88
    v_add_f32 v161, v161, v89
    v_add_f32 v162, v162, v90
    v_add_f32 v163, v163, v91
    v_add_f32 v164, v164, v92
    v_add_f32 v165, v165, v93
    v_add_f32 v166, v166, v94
    v_add_f32 v167, v167, v95
    v_add_f32 v160, v160, v176
    v_add_f32 v161, v161, v177
    v_add_f32 v162, v162, v178
    v_add_f32 v163, v163, v179
    v_add_f32 v164, v164, v180
    v_add_f32 v165, v165, v181
    v_add_f32 v166, v166, v182
    v_add_f32 v167, v167, v183
    v_cvt_pk_bf16_f32 v160, v160, v161
    v_cvt_pk_bf16_f32 v161, v162, v163
    v_cvt_pk_bf16_f32 v162, v164, v165
    v_cvt_pk_bf16_f32 v163, v166, v167
    buffer_store_dwordx4 v[160:163], v5, s[40:43], s57 offen
parallel_sum__mha_block__glu_gated_geglu__prompt_kernel_gend:
    s_endpgm
parallel_sum__mha_block__glu_gated_geglu__prompt_kernel_gsq:
    s_mov_b32 s59, 200000
parallel_sum__mha_block__glu_gated_geglu__prompt_kernel_glq:
    ds_read_b128 v[2:5], v74
    s_sub_u32 s59, s59, 1
    s_cmp_eq_u32 s59, 0
    s_waitcnt lgkmcnt(0)
    s_cbranch_scc1 parallel_sum__mha_block__glu_gated_geglu__prompt_kernel_gxq
    v_min3_u32 v2, v2, v3, v4
    v_min_u32 v2, v2, v5
    s_nop 0
    v_readfirstlane_b32 s58, v2
    s_nop 1
    s_cmp_ge_u32 s58, 1
    s_cbranch_scc0 parallel_sum__mha_block__glu_gated_geglu__prompt_kernel_glq
parallel_sum__mha_block__glu_gated_geglu__prompt_kernel_gxq:
    s_branch parallel_sum__mha_block__glu_gated_geglu__prompt_kernel_grq
parallel_sum__mha_block__glu_gated_geglu__prompt_kernel_gs1:
    s_setprio 3
    s_mov_b32 s59, 200000
parallel_sum__mha_block__glu_gated_geglu__prompt_kernel_gl1:
    ds_read_b128 v[124:127], v10
    s_sub_u32 s59, s59, 1
    s_cmp_eq_u32 s59, 0
    s_waitcnt lgkmcnt(0)
    s_cbranch_scc1 parallel_sum__mha_block__glu_gated_geglu__prompt_kernel_gx1
    v_min3_u32 v11, v124, v125, v126
    v_min_u32 v11, v11, v127
    s_nop 0
    v_readfirstlane_b32 s58, v11
    s_nop 1
    s_cmp_ge_u32 s58, 1
    s_cbranch_scc0 parallel_sum__mha_block__glu_gated_geglu__prompt_kernel_gl1
parallel_sum__mha_block__glu_gated_geglu__prompt_kernel_gx1:
    s_setprio 0
    s_branch parallel_sum__mha_block__glu_gated_geglu__prompt_kernel_gr1
parallel_sum__mha_block__glu_gated_geglu__prompt_kernel_gs2:
    s_setprio 3
    s_mov_b32 s59, 200000
parallel_sum__mha_block__glu_gated_geglu__prompt_kernel_gl2:
    ds_read_b128 v[124:127], v10
    s_sub_u32 s59, s59, 1
    s_cmp_eq_u32 s59, 0
    s_waitcnt lgkmcnt(0)
    s_cbranch_scc1 parallel_sum__mha_block__glu_gated_geglu__prompt_kernel_gx2
    v_min3_u32 v11, v124, v125, v126
    v_min_u32 v11, v11, v127
    s_nop 0
    v_readfirstlane_b32 s58, v11
    s_nop 1
    s_cmp_ge_u32 s58, 2
    s_cbranch_scc0 parallel_sum__mha_block__glu_gated_geglu__prompt_kernel_gl2
parallel_sum__mha_block__glu_gated_geglu__prompt_kernel_gx2:
    s_setprio 0
    s_branch parallel_sum__mha_block__glu_gated_geglu__prompt_kernel_gr2
parallel_sum__mha_block__glu_gated_geglu__prompt_kernel_gs3:
    s_setprio 3
    s_mov_b32 s59, 200000
parallel_sum__mha_block__glu_gated_geglu__prompt_kernel_gl3:
    ds_read_b128 v[124:127], v10
    s_sub_u32 s59, s59, 1
    s_cmp_eq_u32 s59, 0
    s_waitcnt lgkmcnt(0)
    s_cbranch_scc1 parallel_sum__mha_block__glu_gated_geglu__prompt_kernel_gx3
    v_min3_u32 v11, v124, v125, v126
    v_min_u32 v11, v11, v127
    s_nop 0
    v_readfirstlane_b32 s58, v11
    s_nop 1
    s_cmp_ge_u32 s58, 3
    s_cbranch_scc0 parallel_sum__mha_block__glu_gated_geglu__prompt_kernel_gl3
parallel_sum__mha_block__glu_gated_geglu__prompt_kernel_gx3:
    s_setprio 0
    s_branch parallel_sum__mha_block__glu_gated_geglu__prompt_kernel_gr3
parallel_sum__mha_block__glu_gated_geglu__prompt_kernel_gs4:
    s_setprio 3
    s_mov_b32 s59, 200000
parallel_sum__mha_block__glu_gated_geglu__prompt_kernel_gl4:
    ds_read_b128 v[124:127], v10
    s_sub_u32 s59, s59, 1
    s_cmp_eq_u32 s59, 0
    s_waitcnt lgkmcnt(0)
    s_cbranch_scc1 parallel_sum__mha_block__glu_gated_geglu__prompt_kernel_gx4
    v_min3_u32 v11, v124, v125, v126
    v_min_u32 v11, v11, v127
    s_nop 0
    v_readfirstlane_b32 s58, v11
    s_nop 1
    s_cmp_ge_u32 s58, 4
    s_cbranch_scc0 parallel_sum__mha_block__glu_gated_geglu__prompt_kernel_gl4
parallel_sum__mha_block__glu_gated_geglu__prompt_kernel_gx4:
    s_setprio 0
    s_branch parallel_sum__mha_block__glu_gated_geglu__prompt_kernel_gr4
parallel_sum__mha_block__glu_gated_geglu__prompt_kernel_gs5:
    s_setprio 3
    s_mov_b32 s59, 200000
parallel_sum__mha_block__glu_gated_geglu__prompt_kernel_gl5:
    ds_read_b128 v[124:127], v10
    s_sub_u32 s59, s59, 1
    s_cmp_eq_u32 s59, 0
    s_waitcnt lgkmcnt(0)
    s_cbranch_scc1 parallel_sum__mha_block__glu_gated_geglu__prompt_kernel_gx5
    v_min3_u32 v11, v124, v125, v126
    v_min_u32 v11, v11, v127
    s_nop 0
    v_readfirstlane_b32 s58, v11
    s_nop 1
    s_cmp_ge_u32 s58, 5
    s_cbranch_scc0 parallel_sum__mha_block__glu_gated_geglu__prompt_kernel_gl5
parallel_sum__mha_block__glu_gated_geglu__prompt_kernel_gx5:
    s_setprio 0
    s_branch parallel_sum__mha_block__glu_gated_geglu__prompt_kernel_gr5
parallel_sum__mha_block__glu_gated_geglu__prompt_kernel_gs6:
    s_setprio 3
    s_mov_b32 s59, 200000
parallel_sum__mha_block__glu_gated_geglu__prompt_kernel_gl6:
    ds_read_b128 v[124:127], v10
    s_sub_u32 s59, s59, 1
    s_cmp_eq_u32 s59, 0
    s_waitcnt lgkmcnt(0)
    s_cbranch_scc1 parallel_sum__mha_block__glu_gated_geglu__prompt_kernel_gx6
    v_min3_u32 v11, v124, v125, v126
    v_min_u32 v11, v11, v127
    s_nop 0
    v_readfirstlane_b32 s58, v11
    s_nop 1
    s_cmp_ge_u32 s58, 6
    s_cbranch_scc0 parallel_sum__mha_block__glu_gated_geglu__prompt_kernel_gl6
parallel_sum__mha_block__glu_gated_geglu__prompt_kernel_gx6:
    s_setprio 0
    s_branch parallel_sum__mha_block__glu_gated_geglu__prompt_kernel_gr6
parallel_sum__mha_block__glu_gated_geglu__prompt_kernel_gs7:
    s_setprio 3
    s_mov_b32 s59, 200000
parallel_sum__mha_block__glu_gated_geglu__prompt_kernel_gl7:
    ds_read_b128 v[124:127], v10
    s_sub_u32 s59, s59, 1
    s_cmp_eq_u32 s59, 0
    s_waitcnt lgkmcnt(0)
    s_cbranch_scc1 parallel_sum__mha_block__glu_gated_geglu__prompt_kernel_gx7
    v_min3_u32 v11, v124, v125, v126
    v_min_u32 v11, v11, v127
    s_nop 0
    v_readfirstlane_b32 s58, v11
    s_nop 1
    s_cmp_ge_u32 s58, 7
    s_cbranch_scc0 parallel_sum__mha_block__glu_gated_geglu__prompt_kernel_gl7
parallel_sum__mha_block__glu_gated_geglu__prompt_kernel_gx7:
    s_setprio 0
    s_branch parallel_sum__mha_block__glu_gated_geglu__prompt_kernel_gr7
parallel_sum__mha_block__glu_gated_geglu__prompt_kernel_gs8:
    s_setprio 3
    s_mov_b32 s59, 200000
parallel_sum__mha_block__glu_gated_geglu__prompt_kernel_gl8:
    ds_read_b128 v[124:127], v10
    s_sub_u32 s59, s59, 1
    s_cmp_eq_u32 s59, 0
    s_waitcnt lgkmcnt(0)
    s_cbranch_scc1 parallel_sum__mha_block__glu_gated_geglu__prompt_kernel_gx8
    v_min3_u32 v11, v124, v125, v126
    v_min_u32 v11, v11, v127
    s_nop 0
    v_readfirstlane_b32 s58, v11
    s_nop 1
    s_cmp_ge_u32 s58, 8
    s_cbranch_scc0 parallel_sum__mha_block__glu_gated_geglu__prompt_kernel_gl8
parallel_sum__mha_block__glu_gated_geglu__prompt_kernel_gx8:
    s_setprio 0
    s_branch parallel_sum__mha_block__glu_gated_geglu__prompt_kernel_gr8
parallel_sum__mha_block__glu_gated_geglu__prompt_kernel_gs9:
    s_setprio 3
    s_mov_b32 s59, 200000
parallel_sum__mha_block__glu_gated_geglu__prompt_kernel_gl9:
    ds_read_b128 v[124:127], v10
    s_sub_u32 s59, s59, 1
    s_cmp_eq_u32 s59, 0
    s_waitcnt lgkmcnt(0)
    s_cbranch_scc1 parallel_sum__mha_block__glu_gated_geglu__prompt_kernel_gx9
    v_min3_u32 v11, v124, v125, v126
    v_min_u32 v11, v11, v127
    s_nop 0
    v_readfirstlane_b32 s58, v11
    s_nop 1
    s_cmp_ge_u32 s58, 9
    s_cbranch_scc0 parallel_sum__mha_block__glu_gated_geglu__prompt_kernel_gl9
parallel_sum__mha_block__glu_gated_geglu__prompt_kernel_gx9:
    s_setprio 3
    s_branch parallel_sum__mha_block__glu_gated_geglu__prompt_kernel_gr9
parallel_sum__mha_block__glu_gated_geglu__prompt_kernel_gs10:
    s_setprio 3
    s_mov_b32 s59, 200000
parallel_sum__mha_block__glu_gated_geglu__prompt_kernel_gl10:
    ds_read_b128 v[124:127], v10
    s_sub_u32 s59, s59, 1
    s_cmp_eq_u32 s59, 0
    s_waitcnt lgkmcnt(0)
    s_cbranch_scc1 parallel_sum__mha_block__glu_gated_geglu__prompt_kernel_gx10
    v_min3_u32 v11, v124, v125, v126
    v_min_u32 v11, v11, v127
    s_nop 0
    v_readfirstlane_b32 s58, v11
    s_nop 1
    s_cmp_ge_u32 s58, 10
    s_cbranch_scc0 parallel_sum__mha_block__glu_gated_geglu__prompt_kernel_gl10
parallel_sum__mha_block__glu_gated_geglu__prompt_kernel_gx10:
    s_setprio 0
    s_branch parallel_sum__mha_block__glu_gated_geglu__prompt_kernel_gr10
parallel_sum__mha_block__glu_gated_geglu__prompt_kernel_gs11:
    s_setprio 3
    s_mov_b32 s59, 200000
parallel_sum__mha_block__glu_gated_geglu__prompt_kernel_gl11:
    ds_read_b128 v[124:127], v10
    s_sub_u32 s59, s59, 1
    s_cmp_eq_u32 s59, 0
    s_waitcnt lgkmcnt(0)
    s_cbranch_scc1 parallel_sum__mha_block__glu_gated_geglu__prompt_kernel_gx11
    v_min3_u32 v11, v124, v125, v126
    v_min_u32 v11, v11, v127
    s_nop 0
    v_readfirstlane_b32 s58, v11
    s_nop 1
    s_cmp_ge_u32 s58, 11
    s_cbranch_scc0 parallel_sum__mha_block__glu_gated_geglu__prompt_kernel_gl11
parallel_sum__mha_block__glu_gated_geglu__prompt_kernel_gx11:
    s_setprio 0
    s_branch parallel_sum__mha_block__glu_gated_geglu__prompt_kernel_gr11
parallel_sum__mha_block__glu_gated_geglu__prompt_kernel_gs12:
    s_setprio 3
    s_mov_b32 s59, 200000
parallel_sum__mha_block__glu_gated_geglu__prompt_kernel_gl12:
    ds_read_b128 v[124:127], v10
    s_sub_u32 s59, s59, 1
    s_cmp_eq_u32 s59, 0
    s_waitcnt lgkmcnt(0)
    s_cbranch_scc1 parallel_sum__mha_block__glu_gated_geglu__prompt_kernel_gx12
    v_min3_u32 v11, v124, v125, v126
    v_min_u32 v11, v11, v127
    s_nop 0
    v_readfirstlane_b32 s58, v11
    s_nop 1
    s_cmp_ge_u32 s58, 12
    s_cbranch_scc0 parallel_sum__mha_block__glu_gated_geglu__prompt_kernel_gl12
parallel_sum__mha_block__glu_gated_geglu__prompt_kernel_gx12:
    s_setprio 0
    s_branch parallel_sum__mha_block__glu_gated_geglu__prompt_kernel_gr12
parallel_sum__mha_block__glu_gated_geglu__prompt_kernel_gs13:
    s_setprio 3
    s_mov_b32 s59, 200000
parallel_sum__mha_block__glu_gated_geglu__prompt_kernel_gl13:
    ds_read_b128 v[124:127], v10
    s_sub_u32 s59, s59, 1
    s_cmp_eq_u32 s59, 0
    s_waitcnt lgkmcnt(0)
    s_cbranch_scc1 parallel_sum__mha_block__glu_gated_geglu__prompt_kernel_gx13
    v_min3_u32 v11, v124, v125, v126
    v_min_u32 v11, v11, v127
    s_nop 0
    v_readfirstlane_b32 s58, v11
    s_nop 1
    s_cmp_ge_u32 s58, 13
    s_cbranch_scc0 parallel_sum__mha_block__glu_gated_geglu__prompt_kernel_gl13
parallel_sum__mha_block__glu_gated_geglu__prompt_kernel_gx13:
    s_setprio 3
    s_branch parallel_sum__mha_block__glu_gated_geglu__prompt_kernel_gr13
parallel_sum__mha_block__glu_gated_geglu__prompt_kernel_gs14:
    s_setprio 3
    s_mov_b32 s59, 200000
parallel_sum__mha_block__glu_gated_geglu__prompt_kernel_gl14:
    ds_read_b128 v[124:127], v10
    s_sub_u32 s59, s59, 1
    s_cmp_eq_u32 s59, 0
    s_waitcnt lgkmcnt(0)
    s_cbranch_scc1 parallel_sum__mha_block__glu_gated_geglu__prompt_kernel_gx14
    v_min3_u32 v11, v124, v125, v126
    v_min_u32 v11, v11, v127
    s_nop 0
    v_readfirstlane_b32 s58, v11
    s_nop 1
    s_cmp_ge_u32 s58, 14
    s_cbranch_scc0 parallel_sum__mha_block__glu_gated_geglu__prompt_kernel_gl14
parallel_sum__mha_block__glu_gated_geglu__prompt_kernel_gx14:
    s_setprio 0
    s_branch parallel_sum__mha_block__glu_gated_geglu__prompt_kernel_gr14
parallel_sum__mha_block__glu_gated_geglu__prompt_kernel_e3p0:
    s_mov_b32 s59, 200000
parallel_sum__mha_block__glu_gated_geglu__prompt_kernel_e3l0:
    buffer_load_dword v120, v6, s[36:39], s10 offen sc1
    s_sub_u32 s59, s59, 1
    s_cmp_eq_u32 s59, 0
    s_waitcnt vmcnt(0)
    s_cbranch_scc1 parallel_sum__mha_block__glu_gated_geglu__prompt_kernel_e3r0
    v_cmp_eq_u32 vcc, s61, v120
    s_nop 1
    s_mov_b32 s12, vcc_lo
    s_bitcmp1_b32 s12, 0
    s_cbranch_scc0 parallel_sum__mha_block__glu_gated_geglu__prompt_kernel_e3l0
    s_branch parallel_sum__mha_block__glu_gated_geglu__prompt_kernel_e3r0
parallel_sum__mha_block__glu_gated_geglu__prompt_kernel_e3p1:
    s_mov_b32 s59, 200000
parallel_sum__mha_block__glu_gated_geglu__prompt_kernel_e3l1:
    buffer_load_dword v120, v6, s[36:39], s10 offen sc1
    s_sub_u32 s59, s59, 1
    s_cmp_eq_u32 s59, 0
    s_waitcnt vmcnt(0)
    s_cbranch_scc1 parallel_sum__mha_block__glu_gated_geglu__prompt_kernel_e3r1
    v_cmp_eq_u32 vcc, s61, v120
    s_nop 1
    s_mov_b32 s12, vcc_lo
    s_bitcmp1_b32 s12, 1
    s_cbranch_scc0 parallel_sum__mha_block__glu_gated_geglu__prompt_kernel_e3l1
    s_branch parallel_sum__mha_block__glu_gated_geglu__prompt_kernel_e3r1
parallel_sum__mha_block__glu_gated_geglu__prompt_kernel_e3p2:
    s_mov_b32 s59, 200000
parallel_sum__mha_block__glu_gated_geglu__prompt_kernel_e3l2:
    buffer_load_dword v120, v6, s[36:39], s10 offen sc1
    s_sub_u32 s59, s59, 1
    s_cmp_eq_u32 s59, 0
    s_waitcnt vmcnt(0)
    s_cbranch_scc1 parallel_sum__mha_block__glu_gated_geglu__prompt_kernel_e3r2
    v_cmp_eq_u32 vcc, s61, v120
    s_nop 1
    s_mov_b32 s12, vcc_lo
    s_bitcmp1_b32 s12, 2
    s_cbranch_scc0 parallel_sum__mha_block__glu_gated_geglu__prompt_kernel_e3l2
    s_branch parallel_sum__mha_block__glu_gated_geglu__prompt_kernel_e3r2
parallel_sum__mha_block__glu_gated_geglu__prompt_kernel_e3p3:
    s_mov_b32 s59, 200000
parallel_sum__mha_block__glu_gated_geglu__prompt_kernel_e3l3:
    buffer_load_dword v120, v6, s[36:39], s10 offen sc1
    s_sub_u32 s59, s59, 1
    s_cmp_eq_u32 s59, 0
    s_waitcnt vmcnt(0)
    s_cbranch_scc1 parallel_sum__mha_block__glu_gated_geglu__prompt_kernel_e3r3
    v_cmp_eq_u32 vcc, s61, v120
    s_nop 1
    s_mov_b32 s12, vcc_lo
    s_bitcmp1_b32 s12, 3
    s_cbranch_scc0 parallel_sum__mha_block__glu_gated_geglu__prompt_kernel_e3l3
    s_branch parallel_sum__mha_block__glu_gated_geglu__prompt_kernel_e3r3
parallel_sum__mha_block__glu_gated_geglu__prompt_kernel_e3p4:
    s_mov_b32 s59, 200000
parallel_sum__mha_block__glu_gated_geglu__prompt_kernel_e3l4:
    buffer_load_dword v120, v6, s[36:39], s10 offen sc1
    s_sub_u32 s59, s59, 1
    s_cmp_eq_u32 s59, 0
    s_waitcnt vmcnt(0)
    s_cbranch_scc1 parallel_sum__mha_block__glu_gated_geglu__prompt_kernel_e3r4
    v_cmp_eq_u32 vcc, s61, v120
    s_nop 1
    s_mov_b32 s12, vcc_lo
    s_bitcmp1_b32 s12, 4
    s_cbranch_scc0 parallel_sum__mha_block__glu_gated_geglu__prompt_kernel_e3l4
    s_branch parallel_sum__mha_block__glu_gated_geglu__prompt_kernel_e3r4
parallel_sum__mha_block__glu_gated_geglu__prompt_kernel_e3p5:
    s_mov_b32 s59, 200000
parallel_sum__mha_block__glu_gated_geglu__prompt_kernel_e3l5:
    buffer_load_dword v120, v6, s[36:39], s10 offen sc1
    s_sub_u32 s59, s59, 1
    s_cmp_eq_u32 s59, 0
    s_waitcnt vmcnt(0)
    s_cbranch_scc1 parallel_sum__mha_block__glu_gated_geglu__prompt_kernel_e3r5
    v_cmp_eq_u32 vcc, s61, v120
    s_nop 1
    s_mov_b32 s12, vcc_lo
    s_bitcmp1_b32 s12, 5
    s_cbranch_scc0 parallel_sum__mha_block__glu_gated_geglu__prompt_kernel_e3l5
    s_branch parallel_sum__mha_block__glu_gated_geglu__prompt_kernel_e3r5
parallel_sum__mha_block__glu_gated_geglu__prompt_kernel_e3p6:
    s_mov_b32 s59, 200000
parallel_sum__mha_block__glu_gated_geglu__prompt_kernel_e3l6:
    buffer_load_dword v120, v6, s[36:39], s10 offen sc1
    s_sub_u32 s59, s59, 1
    s_cmp_eq_u32 s59, 0
    s_waitcnt vmcnt(0)
    s_cbranch_scc1 parallel_sum__mha_block__glu_gated_geglu__prompt_kernel_e3r6
    v_cmp_eq_u32 vcc, s61, v120
    s_nop 1
    s_mov_b32 s12, vcc_lo
    s_bitcmp1_b32 s12, 6
    s_cbranch_scc0 parallel_sum__mha_block__glu_gated_geglu__prompt_kernel_e3l6
    s_branch parallel_sum__mha_block__glu_gated_geglu__prompt_kernel_e3r6
parallel_sum__mha_block__glu_gated_geglu__prompt_kernel_e3p7:
    s_mov_b32 s59, 200000
parallel_sum__mha_block__glu_gated_geglu__prompt_kernel_e3l7:
    buffer_load_dword v120, v6, s[36:39], s10 offen sc1
    s_sub_u32 s59, s59, 1
    s_cmp_eq_u32 s59, 0
    s_waitcnt vmcnt(0)
    s_cbranch_scc1 parallel_sum__mha_block__glu_gated_geglu__prompt_kernel_e3r7
    v_cmp_eq_u32 vcc, s61, v120
    s_nop 1
    s_mov_b32 s12, vcc_lo
    s_bitcmp1_b32 s12, 7
    s_cbranch_scc0 parallel_sum__mha_block__glu_gated_geglu__prompt_kernel_e3l7
    s_branch parallel_sum__mha_block__glu_gated_geglu__prompt_kernel_e3r7
parallel_sum__mha_block__glu_gated_geglu__prompt_kernel_end:
    s_endpgm
parallel_sum__mha_block__glu_gated_geglu__prompt_kernel_codeend:
.section .rodata,"a"
.p2align 6
.amdhsa_kernel parallel_sum__mha_block__glu_gated_geglu__prompt_kernel
  .amdhsa_next_free_vgpr 256
  .amdhsa_next_free_sgpr 102
  .amdhsa_accum_offset 256
  .amdhsa_group_segment_fixed_size 0
  .amdhsa_kernarg_size 80
  .amdhsa_user_sgpr_count 2
  .amdhsa_user_sgpr_kernarg_segment_ptr 1
  .amdhsa_system_sgpr_workgroup_id_x 1
.end_amdhsa_kernel
```
